```python
import torch

def _softmax(x, axis=-1):
    return torch.softmax(x, dim=axis)
def _gelu(x):
    return torch.nn.functional.gelu(x, approximate="tanh")
def _silu(x):
    return torch.nn.functional.silu(x)
def _sigmoid(x):
    return torch.sigmoid(x)
def _layernorm(x, axis=-1, eps=1e-5):
    m = x.mean(dim=axis, keepdim=True)
    v = x.var(dim=axis, keepdim=True, unbiased=False)
    return (x - m) / torch.sqrt(v + eps)
def _scatter_add(tgt, idx, src, axis=0):
    return tgt.clone().index_add_(axis, idx, src)
def _segment_sum(src, seg, n):
    out = torch.zeros((n,) + src.shape[1:], dtype=src.dtype)
    return out.index_add_(0, seg, src)
def _pad(x, pw):
    flat = tuple(v for pair in reversed(pw) for v in pair)
    return torch.nn.functional.pad(x, flat)

kernel_name = 'parallel_sum__softmax_full_mha__dense_activation_gelu__prompt'

def setup_inputs():

    _w = (lambda a: (lambda t: t.to(torch.bfloat16) if t.is_floating_point() else t)(torch.as_tensor(a)))
    def _A_setup():
        B, S, D = 1, 2048, 1024
        return {
            "x": _w((lambda *s: torch.randn(*s, dtype=torch.bfloat16) * 0.05)(B, S, D)),
            "wqkv": _w((lambda *s: torch.randn(*s, dtype=torch.bfloat16) * 0.05)(D, 3 * D)),
            "wo": _w((lambda *s: torch.randn(*s, dtype=torch.bfloat16) * 0.05)(D, D)),
        }
    _A_in = _A_setup()

    def _B_setup():
        B, S, D, F = 1, 2048, 1024, 3584
        return {
            "x": _w((lambda *s: torch.randn(*s, dtype=torch.bfloat16) * 0.05)(B, S, D)),
            "w1": _w((lambda *s: torch.randn(*s, dtype=torch.bfloat16) * 3.2)(D, F) * (D ** -0.5)),
            "b1": _w((lambda *s: torch.randn(*s, dtype=torch.bfloat16) * 3.2)(F) * 0.01),
            "w2": _w((lambda *s: torch.randn(*s, dtype=torch.bfloat16) * 0.4)(F, D) * (F ** -0.5)),
            "b2": _w((lambda *s: torch.randn(*s, dtype=torch.bfloat16) * 0.4)(D) * 0.01),
        }
    _B_in = _B_setup()

    return {
        "A_x": _A_in["x"],
        "A_wqkv": _A_in["wqkv"],
        "A_wo": _A_in["wo"],
        "B_x": _B_in["x"],
        "B_w1": _B_in["w1"],
        "B_b1": _B_in["b1"],
        "B_w2": _B_in["w2"],
        "B_b2": _B_in["b2"],
    }

def reference(A_x, A_wqkv, A_wo, B_x, B_w1, B_b1, B_w2, B_b2):
    def _A_ref(x, wqkv, wo):
        B, S, D = x.shape
        H = 32; Dh = D // H
        qkv = (lambda x, *d: x.permute(*d))((x @ wqkv).reshape(B, S, 3, H, Dh), 2, 0, 3, 1, 4)
        q, k, v = qkv[0], qkv[1], qkv[2]
        scale = Dh ** -0.5
        scores = torch.einsum("bhqd,bhkd->bhqk", q, k) * scale
        p = _softmax(scores, axis=-1)
        o = torch.einsum("bhqk,bhkd->bhqd", p, v)
        return (lambda x, *d: x.permute(*d))(o, 0, 2, 1, 3).reshape(B, S, D) @ wo

    def _B_ref(x, w1, b1, w2, b2):
        h = torch.einsum("bsd,df->bsf", x, w1) + b1
        h = _gelu(h)
        return torch.einsum("bsf,fd->bsd", h, w2) + b2

    x = A_x
    xn = _layernorm(x, axis=-1)
    return x + _A_ref(xn, A_wqkv, A_wo) + _B_ref(xn, B_w1, B_b1, B_w2, B_b2)
```

```asm
; @launch grid=(256,1,1) block=(256,1,1) lds=163840
.amdgcn_target "amdgcn-amd-amdhsa--gfx950"
.text
.globl parallel_sum__softmax_full_mha__dense_activation_gelu__prompt_kernel
.p2align 8
.type parallel_sum__softmax_full_mha__dense_activation_gelu__prompt_kernel,@function
parallel_sum__softmax_full_mha__dense_activation_gelu__prompt_kernel:
    s_cmp_ge_u32 s2, 256
    s_cbranch_scc1 L_end
    s_load_dwordx4 s[4:7], s[0:1], 0
    s_load_dwordx2 s[28:29], s[0:1], 80
    s_load_dwordx4 s[12:15], s[0:1], 32
    s_load_dwordx4 s[40:43], s[0:1], 48
    s_load_dwordx2 s[88:89], s[0:1], 16
    s_load_dwordx2 s[30:31], s[0:1], 64

    s_getpc_b64 s[92:93]
L_pfa:
    s_lshr_b32 s64, s2, 3
    v_and_b32 v99, 15, v0
    v_lshl_add_u32 v99, s64, 4, v99
    v_lshlrev_b32 v99, 7, v99
    v_min_u32 v99, L_end-L_pfa, v99
    global_load_dword a122, v99, s[92:93]
    v_and_b32 v1, 63, v0
    v_lshrrev_b32 v24, 6, v0
    s_and_b32 s61, s2, 7
    s_lshr_b32 s33, s2, 3
    v_readfirstlane_b32 s34, v24
    s_and_b32 s35, s61, 1
    s_lshl_b32 s35, s35, 2
    s_and_b32 s36, s33, 3
    s_add_u32 s35, s35, s36
    s_lshr_b32 s36, s61, 1
    s_lshl_b32 s36, s36, 3
    s_lshr_b32 s37, s33, 2
    s_add_u32 s36, s36, s37
    s_lshl_b32 s38, s34, 10
    s_and_b32 s39, s36, 1
    v_lshlrev_b32 v252, 4, v1
    v_lshlrev_b32 v253, 4, v0

    v_and_b32 v90, 7, v0
    v_bfe_u32 v91, v0, 3, 3
    v_lshl_add_u32 v92, v24, 5, v91
    s_lshl_b32 s46, s35, 5
    s_add_u32 s46, s46, s36
    s_lshl_b32 s47, s46, 3
    v_add_u32 v93, s47, v91
    v_lshlrev_b32 v93, 11, v93
    v_lshl_add_u32 v94, v24, 5, v90
    v_lshl_add_u32 v93, v94, 4, v93
    s_waitcnt lgkmcnt(0)

    s_mov_b32 s20, s4
    s_mov_b32 s21, s5
    s_mov_b32 s22, 4194304
    s_mov_b32 s23, 0x20000
    buffer_load_dwordx4 v[100:103], v93, s[20:23], 0 offen offset:0
    buffer_load_dwordx4 v[104:107], v93, s[20:23], 0 offen offset:128
    buffer_load_dwordx4 v[108:111], v93, s[20:23], 0 offen offset:256
    buffer_load_dwordx4 v[112:115], v93, s[20:23], 0 offen offset:384
    v_and_b32 v99, 0xfffff800, v93
    buffer_load_ushort v86, v99, s[20:23], 0 offen
    s_mov_b32 s16, s28
    s_mov_b32 s17, s29
    s_mov_b32 s18, 51380224
    s_mov_b32 s19, 0x20000
    s_add_u32 s62, s28, 50331648
    s_addc_u32 s63, s29, 0
    s_load_dword s52, s[62:63], 0
    v_and_b32 v99, 3, v0
    v_lshlrev_b32 v99, 16, v99
    s_lshl_b32 s51, s2, 7
    s_add_u32 s51, s51, 50331648
    buffer_load_dword a123, v99, s[16:19], s51 offen sc1
    s_mov_b32 s68, s6
    s_mov_b32 s69, s7
    s_mov_b32 s70, 6291456
    s_mov_b32 s71, 0x20000
    s_mov_b32 s72, s12
    s_mov_b32 s73, s13
    s_mov_b32 s74, 7340032
    s_mov_b32 s75, 0x20000
    s_mov_b32 s76, s14
    s_mov_b32 s77, s15
    s_mov_b32 s78, 7168
    s_mov_b32 s79, 0x20000
    s_mov_b32 s80, s40
    s_mov_b32 s81, s41
    s_mov_b32 s82, 7340032
    s_mov_b32 s83, 0x20000
    s_mov_b32 s84, s88
    s_mov_b32 s85, s89
    s_mov_b32 s86, 2097152
    s_mov_b32 s87, 0x20000
    s_mov_b32 s8, s42
    s_mov_b32 s9, s43
    s_mov_b32 s10, 2048
    s_mov_b32 s11, 0x20000
    s_mov_b32 s24, s30
    s_mov_b32 s25, s31
    s_mov_b32 s26, 4194304
    s_mov_b32 s27, 0x20000
    s_mul_i32 s40, s36, 192
    s_mul_i32 s41, s36, 224
    s_movk_i32 s42, 6144
    s_movk_i32 s43, 7168
    s_mov_b32 s48, 0
    s_mov_b32 s49, 0
    s_mov_b32 s50, 0
    v_lshrrev_b32 v25, 4, v1
    v_lshlrev_b32 v25, 3, v25
    v_add_u32 v25, s41, v25
    s_lshl_b32 s54, s39, 5
    s_mul_i32 s55, s39, 192
    s_sub_u32 s55, 192, s55
    buffer_load_dwordx2 v[28:29], v25, s[76:79], s54 offen offset:0
    buffer_load_dwordx2 v[30:31], v25, s[76:79], s54 offen offset:32
    buffer_load_dwordx2 v[32:33], v25, s[76:79], s54 offen offset:64
    buffer_load_dwordx2 v[34:35], v25, s[76:79], s54 offen offset:96
    buffer_load_dwordx2 v[36:37], v25, s[76:79], s54 offen offset:128
    buffer_load_dwordx2 v[38:39], v25, s[76:79], s54 offen offset:160
    buffer_load_dwordx2 v[40:41], v25, s[76:79], s55 offen
    v_lshlrev_b32 v26, 5, v1
    buffer_load_dword a123, v26, s[8:11], 0 offen
    s_lshr_b32 s56, s46, 1
    s_lshl_b32 s56, s56, 15
    s_and_b32 s57, s46, 1
    s_lshl_b32 s57, s57, 7
    s_add_u32 s56, s56, s57
    v_lshlrev_b32 v96, 8, v92
    v_lshl_add_u32 v96, v90, 4, v96
    v_add_u32 v96, s56, v96
    v_lshlrev_b32 v98, 5, v91
    v_add_u32 v98, 106496, v98
    v_lshl_add_u32 v97, v24, 3, v98
    s_mul_i32 s57, s34, 4608
    s_add_u32 s57, s57, 114688
    v_mul_u32_u24 v94, 144, v90
    v_lshl_add_u32 v94, v91, 4, v94
    v_add_u32 v94, s57, v94
    v_mul_u32_u24 v95, 144, v91
    v_lshl_add_u32 v95, v90, 4, v95
    v_add_u32 v95, s57, v95
    s_waitcnt lgkmcnt(0)
    s_add_u32 s52, s52, 1
    s_xor_b32 s53, s52, 0x5a3c96e1
    v_mov_b32 v250, s52
    v_mov_b32 v251, s53

    s_waitcnt vmcnt(13)
    v_lshlrev_b32 v116, 16, v100
    v_and_b32 v117, 0xffff0000, v100
    v_lshlrev_b32 v118, 16, v101
    v_and_b32 v119, 0xffff0000, v101
    v_lshlrev_b32 v120, 16, v102
    v_and_b32 v121, 0xffff0000, v102
    v_lshlrev_b32 v122, 16, v103
    v_and_b32 v123, 0xffff0000, v103
    s_waitcnt vmcnt(12)
    v_lshlrev_b32 v124, 16, v104
    v_and_b32 v125, 0xffff0000, v104
    v_lshlrev_b32 v126, 16, v105
    v_and_b32 v127, 0xffff0000, v105
    v_lshlrev_b32 v128, 16, v106
    v_and_b32 v129, 0xffff0000, v106
    v_lshlrev_b32 v130, 16, v107
    v_and_b32 v131, 0xffff0000, v107
    s_waitcnt vmcnt(11)
    v_lshlrev_b32 v132, 16, v108
    v_and_b32 v133, 0xffff0000, v108
    v_lshlrev_b32 v134, 16, v109
    v_and_b32 v135, 0xffff0000, v109
    v_lshlrev_b32 v136, 16, v110
    v_and_b32 v137, 0xffff0000, v110
    v_lshlrev_b32 v138, 16, v111
    v_and_b32 v139, 0xffff0000, v111
    s_waitcnt vmcnt(10)
    v_lshlrev_b32 v140, 16, v112
    v_and_b32 v141, 0xffff0000, v112
    v_lshlrev_b32 v142, 16, v113
    v_and_b32 v143, 0xffff0000, v113
    v_lshlrev_b32 v144, 16, v114
    v_and_b32 v145, 0xffff0000, v114
    v_lshlrev_b32 v146, 16, v115
    v_and_b32 v147, 0xffff0000, v115
    s_waitcnt vmcnt(9)
    s_mul_i32 s51, s2, 6144
    v_lshlrev_b32 v25, 7, v0
    v_cmp_gt_u32 vcc, 48, v0
    s_add_u32 s51, s51, 0
    s_nop 0
    v_cndmask_b32 v25, -2.0, v25, vcc
    buffer_load_dword a120, v25, s[68:71], s51 offen
    s_mul_i32 s51, s2, 7168
    v_lshlrev_b32 v25, 7, v0
    v_cmp_gt_u32 vcc, 56, v0
    s_add_u32 s51, s51, 0
    s_nop 0
    v_cndmask_b32 v25, -2.0, v25, vcc
    buffer_load_dword a121, v25, s[72:75], s51 offen
    v_lshlrev_b32 v86, 16, v86
    v_sub_f32 v84, 0, v86
    v_mov_b32 v85, v84
    v_pk_add_f32 v[116:117], v[116:117], v[84:85]
    v_pk_add_f32 v[118:119], v[118:119], v[84:85]
    v_pk_add_f32 v[120:121], v[120:121], v[84:85]
    v_pk_add_f32 v[122:123], v[122:123], v[84:85]
    v_pk_add_f32 v[124:125], v[124:125], v[84:85]
    v_pk_add_f32 v[126:127], v[126:127], v[84:85]
    v_pk_add_f32 v[128:129], v[128:129], v[84:85]
    v_pk_add_f32 v[130:131], v[130:131], v[84:85]
    v_pk_add_f32 v[132:133], v[132:133], v[84:85]
    v_pk_add_f32 v[134:135], v[134:135], v[84:85]
    v_pk_add_f32 v[136:137], v[136:137], v[84:85]
    v_pk_add_f32 v[138:139], v[138:139], v[84:85]
    v_pk_add_f32 v[140:141], v[140:141], v[84:85]
    v_pk_add_f32 v[142:143], v[142:143], v[84:85]
    v_pk_add_f32 v[144:145], v[144:145], v[84:85]
    v_pk_add_f32 v[146:147], v[146:147], v[84:85]
    v_pk_add_f32 v[148:149], v[116:117], v[124:125]
    v_pk_mul_f32 v[156:157], v[116:117], v[116:117]
    v_pk_add_f32 v[150:151], v[118:119], v[126:127]
    v_pk_mul_f32 v[158:159], v[118:119], v[118:119]
    v_pk_add_f32 v[152:153], v[120:121], v[128:129]
    v_pk_mul_f32 v[160:161], v[120:121], v[120:121]
    v_pk_add_f32 v[154:155], v[122:123], v[130:131]
    v_pk_mul_f32 v[162:163], v[122:123], v[122:123]
    v_pk_fma_f32 v[156:157], v[124:125], v[124:125], v[156:157]
    v_pk_fma_f32 v[158:159], v[126:127], v[126:127], v[158:159]
    v_pk_fma_f32 v[160:161], v[128:129], v[128:129], v[160:161]
    v_pk_fma_f32 v[162:163], v[130:131], v[130:131], v[162:163]
    v_pk_add_f32 v[148:149], v[148:149], v[132:133]
    v_pk_fma_f32 v[156:157], v[132:133], v[132:133], v[156:157]
    v_pk_add_f32 v[150:151], v[150:151], v[134:135]
    v_pk_fma_f32 v[158:159], v[134:135], v[134:135], v[158:159]
    v_pk_add_f32 v[152:153], v[152:153], v[136:137]
    v_pk_fma_f32 v[160:161], v[136:137], v[136:137], v[160:161]
    v_pk_add_f32 v[154:155], v[154:155], v[138:139]
    v_pk_fma_f32 v[162:163], v[138:139], v[138:139], v[162:163]
    v_pk_add_f32 v[148:149], v[148:149], v[140:141]
    v_pk_fma_f32 v[156:157], v[140:141], v[140:141], v[156:157]
    v_pk_add_f32 v[150:151], v[150:151], v[142:143]
    v_pk_fma_f32 v[158:159], v[142:143], v[142:143], v[158:159]
    v_pk_add_f32 v[152:153], v[152:153], v[144:145]
    v_pk_fma_f32 v[160:161], v[144:145], v[144:145], v[160:161]
    v_pk_add_f32 v[154:155], v[154:155], v[146:147]
    v_pk_fma_f32 v[162:163], v[146:147], v[146:147], v[162:163]
    v_pk_add_f32 v[148:149], v[148:149], v[150:151]
    v_pk_add_f32 v[152:153], v[152:153], v[154:155]
    v_pk_add_f32 v[156:157], v[156:157], v[158:159]
    v_pk_add_f32 v[160:161], v[160:161], v[162:163]
    v_pk_add_f32 v[148:149], v[148:149], v[152:153]
    v_pk_add_f32 v[156:157], v[156:157], v[160:161]
    v_add_f32 v88, v148, v149
    v_add_f32 v89, v156, v157
    s_nop 0
    v_add_f32_dpp v88, v88, v88 quad_perm:[1,0,3,2] row_mask:0xf bank_mask:0xf
    v_add_f32_dpp v89, v89, v89 quad_perm:[1,0,3,2] row_mask:0xf bank_mask:0xf
    s_nop 0
    v_add_f32_dpp v88, v88, v88 quad_perm:[2,3,0,1] row_mask:0xf bank_mask:0xf
    v_add_f32_dpp v89, v89, v89 quad_perm:[2,3,0,1] row_mask:0xf bank_mask:0xf
    s_nop 0
    v_add_f32_dpp v88, v88, v88 row_half_mirror row_mask:0xf bank_mask:0xf
    v_add_f32_dpp v89, v89, v89 row_half_mirror row_mask:0xf bank_mask:0xf
    ds_write_b64 v97, v[88:89]
    s_waitcnt lgkmcnt(0)
    s_barrier
    ds_read_b128 v[148:151], v98 offset:0
    ds_read_b128 v[152:155], v98 offset:16
    s_waitcnt lgkmcnt(0)
    v_pk_add_f32 v[148:149], v[148:149], v[150:151]
    v_pk_add_f32 v[152:153], v[152:153], v[154:155]
    v_pk_add_f32 v[148:149], v[148:149], v[152:153]
    v_mul_f32 v88, 0x3a800000, v148
    v_mul_f32 v87, 0x3a800000, v149
    v_fma_f32 v87, -v88, v88, v87
    v_max_f32 v87, 0, v87
    v_add_f32 v89, v88, v86
    v_cvt_pk_bf16_f32 v89, v89, v87
    v_and_b32 v87, 0xffff0000, v89
    v_lshlrev_b32 v89, 16, v89
    v_add_f32 v87, 0x3727c5ac, v87
    v_cvt_pk_bf16_f32 v87, v87, v87
    v_and_b32 v87, 0xffff0000, v87
    v_sqrt_f32 v87, v87
    v_sub_f32 v89, v86, v89
    v_cvt_pk_bf16_f32 v87, v87, v87
    v_and_b32 v87, 0xffff0000, v87
    v_rcp_f32 v84, v87
    s_movk_i32 s56, 4096
    v_mov_b32 v85, v84
    v_mov_b32 v88, v89

    v_pk_add_f32 v[116:117], v[116:117], v[88:89]
    v_pk_add_f32 v[118:119], v[118:119], v[88:89]
    v_pk_add_f32 v[120:121], v[120:121], v[88:89]
    v_pk_add_f32 v[122:123], v[122:123], v[88:89]
    v_cvt_pk_bf16_f32 v100, v116, v117
    v_cvt_pk_bf16_f32 v101, v118, v119
    v_cvt_pk_bf16_f32 v102, v120, v121
    v_cvt_pk_bf16_f32 v103, v122, v123
    v_lshlrev_b32 v116, 16, v100
    v_and_b32 v117, 0xffff0000, v100
    v_lshlrev_b32 v118, 16, v101
    v_and_b32 v119, 0xffff0000, v101
    v_lshlrev_b32 v120, 16, v102
    v_and_b32 v121, 0xffff0000, v102
    v_lshlrev_b32 v122, 16, v103
    v_and_b32 v123, 0xffff0000, v103
    v_pk_mul_f32 v[116:117], v[116:117], v[84:85]
    v_pk_mul_f32 v[118:119], v[118:119], v[84:85]
    v_pk_mul_f32 v[120:121], v[120:121], v[84:85]
    v_pk_mul_f32 v[122:123], v[122:123], v[84:85]
    v_cvt_pk_bf16_f32 v100, v116, v117
    v_cvt_pk_bf16_f32 v101, v118, v119
    v_cvt_pk_bf16_f32 v102, v120, v121
    v_cvt_pk_bf16_f32 v103, v122, v123
    ds_write_b128 v94, v[100:103] offset:0
    v_pk_add_f32 v[124:125], v[124:125], v[88:89]
    v_pk_add_f32 v[126:127], v[126:127], v[88:89]
    v_pk_add_f32 v[128:129], v[128:129], v[88:89]
    v_pk_add_f32 v[130:131], v[130:131], v[88:89]
    v_cvt_pk_bf16_f32 v104, v124, v125
    v_cvt_pk_bf16_f32 v105, v126, v127
    v_cvt_pk_bf16_f32 v106, v128, v129
    v_cvt_pk_bf16_f32 v107, v130, v131
    v_lshlrev_b32 v124, 16, v104
    v_and_b32 v125, 0xffff0000, v104
    v_lshlrev_b32 v126, 16, v105
    v_and_b32 v127, 0xffff0000, v105
    v_lshlrev_b32 v128, 16, v106
    v_and_b32 v129, 0xffff0000, v106
    v_lshlrev_b32 v130, 16, v107
    v_and_b32 v131, 0xffff0000, v107
    v_pk_mul_f32 v[124:125], v[124:125], v[84:85]
    v_pk_mul_f32 v[126:127], v[126:127], v[84:85]
    v_pk_mul_f32 v[128:129], v[128:129], v[84:85]
    v_pk_mul_f32 v[130:131], v[130:131], v[84:85]
    v_cvt_pk_bf16_f32 v104, v124, v125
    v_cvt_pk_bf16_f32 v105, v126, v127
    v_cvt_pk_bf16_f32 v106, v128, v129
    v_cvt_pk_bf16_f32 v107, v130, v131
    ds_write_b128 v94, v[104:107] offset:1152
    v_pk_add_f32 v[132:133], v[132:133], v[88:89]
    v_pk_add_f32 v[134:135], v[134:135], v[88:89]
    v_pk_add_f32 v[136:137], v[136:137], v[88:89]
    v_pk_add_f32 v[138:139], v[138:139], v[88:89]
    v_cvt_pk_bf16_f32 v108, v132, v133
    v_cvt_pk_bf16_f32 v109, v134, v135
    v_cvt_pk_bf16_f32 v110, v136, v137
    v_cvt_pk_bf16_f32 v111, v138, v139
    v_lshlrev_b32 v132, 16, v108
    v_and_b32 v133, 0xffff0000, v108
    v_lshlrev_b32 v134, 16, v109
    v_and_b32 v135, 0xffff0000, v109
    v_lshlrev_b32 v136, 16, v110
    v_and_b32 v137, 0xffff0000, v110
    v_lshlrev_b32 v138, 16, v111
    v_and_b32 v139, 0xffff0000, v111
    v_pk_mul_f32 v[132:133], v[132:133], v[84:85]
    v_pk_mul_f32 v[134:135], v[134:135], v[84:85]
    v_pk_mul_f32 v[136:137], v[136:137], v[84:85]
    v_pk_mul_f32 v[138:139], v[138:139], v[84:85]
    v_cvt_pk_bf16_f32 v108, v132, v133
    v_cvt_pk_bf16_f32 v109, v134, v135
    v_cvt_pk_bf16_f32 v110, v136, v137
    v_cvt_pk_bf16_f32 v111, v138, v139
    ds_write_b128 v94, v[108:111] offset:2304
    v_pk_add_f32 v[140:141], v[140:141], v[88:89]
    v_pk_add_f32 v[142:143], v[142:143], v[88:89]
    v_pk_add_f32 v[144:145], v[144:145], v[88:89]
    v_pk_add_f32 v[146:147], v[146:147], v[88:89]
    v_cvt_pk_bf16_f32 v112, v140, v141
    v_cvt_pk_bf16_f32 v113, v142, v143
    v_cvt_pk_bf16_f32 v114, v144, v145
    v_cvt_pk_bf16_f32 v115, v146, v147
    v_lshlrev_b32 v140, 16, v112
    v_and_b32 v141, 0xffff0000, v112
    v_lshlrev_b32 v142, 16, v113
    v_and_b32 v143, 0xffff0000, v113
    v_lshlrev_b32 v144, 16, v114
    v_and_b32 v145, 0xffff0000, v114
    v_lshlrev_b32 v146, 16, v115
    v_and_b32 v147, 0xffff0000, v115
    v_pk_mul_f32 v[140:141], v[140:141], v[84:85]
    v_pk_mul_f32 v[142:143], v[142:143], v[84:85]
    v_pk_mul_f32 v[144:145], v[144:145], v[84:85]
    v_pk_mul_f32 v[146:147], v[146:147], v[84:85]
    v_cvt_pk_bf16_f32 v112, v140, v141
    v_cvt_pk_bf16_f32 v113, v142, v143
    v_cvt_pk_bf16_f32 v114, v144, v145
    v_cvt_pk_bf16_f32 v115, v146, v147
    ds_write_b128 v94, v[112:115] offset:3456
    s_waitcnt lgkmcnt(3)
    ds_read_b128 v[148:151], v95 offset:0
    s_waitcnt lgkmcnt(3)
    ds_read_b128 v[152:155], v95 offset:1152
    s_waitcnt lgkmcnt(3)
    ds_read_b128 v[156:159], v95 offset:2304
    s_waitcnt lgkmcnt(3)
    ds_read_b128 v[160:163], v95 offset:3456
    s_waitcnt lgkmcnt(3)
    buffer_store_dwordx4 v[148:151], v96, s[16:19], 0 offen offset:0 sc1
    s_waitcnt lgkmcnt(2)
    buffer_store_dwordx4 v[152:155], v96, s[16:19], 0 offen offset:2048 sc1
    s_waitcnt lgkmcnt(1)
    buffer_store_dwordx4 v[156:159], v96, s[16:19], s56 offen offset:0 sc1
    s_waitcnt lgkmcnt(0)
    buffer_store_dwordx4 v[160:163], v96, s[16:19], s56 offen offset:2048 sc1
    v_add_u32 v74, 0, v0
    v_mul_u32_u24 v75, 683, v74
    v_lshrrev_b32 v75, 13, v75
    v_mul_u32_u24 v76, 12, v75
    v_sub_u32 v76, v74, v76
    v_and_b32 v77, 0x63, v75
    v_bfe_u32 v78, v75, 2, 2
    v_lshl_add_u32 v77, v78, 3, v77
    v_bfe_u32 v79, v75, 4, 1
    v_lshl_add_u32 v77, v79, 2, v77
    v_and_b32 v78, 1, v78
    v_lshlrev_b32 v78, 1, v78
    v_xor_b32 v76, v76, v78
    v_mul_lo_u32 v77, v77, s42
    v_lshl_add_u32 v77, v76, 4, v77
    v_add_u32 v2, s40, v77
    v_add_u32 v74, 0, v0
    v_mul_u32_u24 v75, 2341, v74
    v_lshrrev_b32 v75, 15, v75
    v_mul_u32_u24 v76, 14, v75
    v_sub_u32 v76, v74, v76
    v_and_b32 v77, 0x63, v75
    v_bfe_u32 v78, v75, 2, 2
    v_lshl_add_u32 v77, v78, 3, v77
    v_bfe_u32 v79, v75, 4, 1
    v_lshl_add_u32 v77, v79, 2, v77
    v_lshl_add_u32 v76, s39, 1, v76
    v_subrev_u32 v78, 14, v76
    v_cmp_gt_u32 vcc, 14, v76
    v_mul_lo_u32 v77, v77, s43
    s_nop 0
    v_cndmask_b32 v76, v78, v76, vcc
    v_lshl_add_u32 v77, v76, 4, v77
    v_add_u32 v8, s41, v77
    v_add_u32 v74, 256, v0
    v_mul_u32_u24 v75, 683, v74
    v_lshrrev_b32 v75, 13, v75
    v_mul_u32_u24 v76, 12, v75
    v_sub_u32 v76, v74, v76
    v_and_b32 v77, 0x63, v75
    v_bfe_u32 v78, v75, 2, 2
    v_lshl_add_u32 v77, v78, 3, v77
    v_bfe_u32 v79, v75, 4, 1
    v_lshl_add_u32 v77, v79, 2, v77
    v_and_b32 v78, 1, v78
    v_lshlrev_b32 v78, 1, v78
    v_xor_b32 v76, v76, v78
    v_mul_lo_u32 v77, v77, s42
    v_lshl_add_u32 v77, v76, 4, v77
    v_add_u32 v3, s40, v77
    v_add_u32 v74, 256, v0
    v_mul_u32_u24 v75, 2341, v74
    v_lshrrev_b32 v75, 15, v75
    v_mul_u32_u24 v76, 14, v75
    v_sub_u32 v76, v74, v76
    v_and_b32 v77, 0x63, v75
    v_bfe_u32 v78, v75, 2, 2
    v_lshl_add_u32 v77, v78, 3, v77
    v_bfe_u32 v79, v75, 4, 1
    v_lshl_add_u32 v77, v79, 2, v77
    v_lshl_add_u32 v76, s39, 1, v76
    v_subrev_u32 v78, 14, v76
    v_cmp_gt_u32 vcc, 14, v76
    v_mul_lo_u32 v77, v77, s43
    s_nop 0
    v_cndmask_b32 v76, v78, v76, vcc
    v_lshl_add_u32 v77, v76, 4, v77
    v_add_u32 v9, s41, v77
    v_add_u32 v74, 512, v0
    v_mul_u32_u24 v75, 683, v74
    v_lshrrev_b32 v75, 13, v75
    v_mul_u32_u24 v76, 12, v75
    v_sub_u32 v76, v74, v76
    v_and_b32 v77, 0x63, v75
    v_bfe_u32 v78, v75, 2, 2
    v_lshl_add_u32 v77, v78, 3, v77
    v_bfe_u32 v79, v75, 4, 1
    v_lshl_add_u32 v77, v79, 2, v77
    v_and_b32 v78, 1, v78
    v_lshlrev_b32 v78, 1, v78
    v_xor_b32 v76, v76, v78
    v_mul_lo_u32 v77, v77, s42
    v_lshl_add_u32 v77, v76, 4, v77
    v_add_u32 v4, s40, v77
    v_add_u32 v74, 512, v0
    v_mul_u32_u24 v75, 2341, v74
    v_lshrrev_b32 v75, 15, v75
    v_mul_u32_u24 v76, 14, v75
    v_sub_u32 v76, v74, v76
    v_and_b32 v77, 0x63, v75
    v_bfe_u32 v78, v75, 2, 2
    v_lshl_add_u32 v77, v78, 3, v77
    v_bfe_u32 v79, v75, 4, 1
    v_lshl_add_u32 v77, v79, 2, v77
    v_lshl_add_u32 v76, s39, 1, v76
    v_subrev_u32 v78, 14, v76
    v_cmp_gt_u32 vcc, 14, v76
    v_mul_lo_u32 v77, v77, s43
    s_nop 0
    v_cndmask_b32 v76, v78, v76, vcc
    v_lshl_add_u32 v77, v76, 4, v77
    v_add_u32 v10, s41, v77
    v_add_u32 v74, 768, v0
    v_mul_u32_u24 v75, 2341, v74
    v_lshrrev_b32 v75, 15, v75
    v_mul_u32_u24 v76, 14, v75
    v_sub_u32 v76, v74, v76
    v_and_b32 v77, 0x63, v75
    v_bfe_u32 v78, v75, 2, 2
    v_lshl_add_u32 v77, v78, 3, v77
    v_bfe_u32 v79, v75, 4, 1
    v_lshl_add_u32 v77, v79, 2, v77
    v_lshl_add_u32 v76, s39, 1, v76
    v_subrev_u32 v78, 14, v76
    v_cmp_gt_u32 vcc, 14, v76
    v_mul_lo_u32 v77, v77, s43
    s_nop 0
    v_cndmask_b32 v76, v78, v76, vcc
    v_lshl_add_u32 v77, v76, 4, v77
    v_add_u32 v11, s41, v77
    v_add_u32 v74, 768, v0
    v_mul_u32_u24 v75, 683, v74
    v_lshrrev_b32 v75, 13, v75
    v_mul_u32_u24 v76, 12, v75
    v_sub_u32 v76, v74, v76
    v_and_b32 v77, 0x63, v75
    v_bfe_u32 v78, v75, 2, 2
    v_lshl_add_u32 v77, v78, 3, v77
    v_bfe_u32 v79, v75, 4, 1
    v_lshl_add_u32 v77, v79, 2, v77
    v_and_b32 v78, 1, v78
    v_lshlrev_b32 v78, 1, v78
    v_xor_b32 v76, v76, v78
    v_mul_lo_u32 v77, v77, s42
    v_lshl_add_u32 v77, v76, 4, v77
    v_add_u32 v5, s40, v77
    v_add_u32 v74, 1024, v0
    v_mul_u32_u24 v75, 2341, v74
    v_lshrrev_b32 v75, 15, v75
    v_mul_u32_u24 v76, 14, v75
    v_sub_u32 v76, v74, v76
    v_and_b32 v77, 0x63, v75
    v_bfe_u32 v78, v75, 2, 2
    v_lshl_add_u32 v77, v78, 3, v77
    v_bfe_u32 v79, v75, 4, 1
    v_lshl_add_u32 v77, v79, 2, v77
    v_lshl_add_u32 v76, s39, 1, v76
    v_subrev_u32 v78, 14, v76
    v_cmp_gt_u32 vcc, 14, v76
    v_mul_lo_u32 v77, v77, s43
    s_nop 0
    v_cndmask_b32 v76, v78, v76, vcc
    v_lshl_add_u32 v77, v76, 4, v77
    v_add_u32 v12, s41, v77
    v_add_u32 v74, 1024, v0
    v_mul_u32_u24 v75, 683, v74
    v_lshrrev_b32 v75, 13, v75
    v_mul_u32_u24 v76, 12, v75
    v_sub_u32 v76, v74, v76
    v_and_b32 v77, 0x63, v75
    v_bfe_u32 v78, v75, 2, 2
    v_lshl_add_u32 v77, v78, 3, v77
    v_bfe_u32 v79, v75, 4, 1
    v_lshl_add_u32 v77, v79, 2, v77
    v_and_b32 v78, 1, v78
    v_lshlrev_b32 v78, 1, v78
    v_xor_b32 v76, v76, v78
    v_mul_lo_u32 v77, v77, s42
    v_lshl_add_u32 v77, v76, 4, v77
    v_add_u32 v6, s40, v77
    v_add_u32 v74, 1280, v0
    v_mul_u32_u24 v75, 2341, v74
    v_lshrrev_b32 v75, 15, v75
    v_mul_u32_u24 v76, 14, v75
    v_sub_u32 v76, v74, v76
    v_and_b32 v77, 0x63, v75
    v_bfe_u32 v78, v75, 2, 2
    v_lshl_add_u32 v77, v78, 3, v77
    v_bfe_u32 v79, v75, 4, 1
    v_lshl_add_u32 v77, v79, 2, v77
    v_lshl_add_u32 v76, s39, 1, v76
    v_subrev_u32 v78, 14, v76
    v_cmp_gt_u32 vcc, 14, v76
    v_mul_lo_u32 v77, v77, s43
    s_nop 0
    v_cndmask_b32 v76, v78, v76, vcc
    v_lshl_add_u32 v77, v76, 4, v77
    v_add_u32 v13, s41, v77
    v_add_u32 v74, 1280, v0
    v_mul_u32_u24 v75, 683, v74
    v_lshrrev_b32 v75, 13, v75
    v_mul_u32_u24 v76, 12, v75
    v_sub_u32 v76, v74, v76
    v_and_b32 v77, 0x63, v75
    v_bfe_u32 v78, v75, 2, 2
    v_lshl_add_u32 v77, v78, 3, v77
    v_bfe_u32 v79, v75, 4, 1
    v_lshl_add_u32 v77, v79, 2, v77
    v_and_b32 v78, 1, v78
    v_lshlrev_b32 v78, 1, v78
    v_xor_b32 v76, v76, v78
    v_mul_lo_u32 v77, v77, s42
    v_lshl_add_u32 v77, v76, 4, v77
    v_add_u32 v7, s40, v77
    v_add_u32 v74, 1536, v0
    v_mul_u32_u24 v75, 2341, v74
    v_lshrrev_b32 v75, 15, v75
    v_mul_u32_u24 v76, 14, v75
    v_sub_u32 v76, v74, v76
    v_and_b32 v77, 0x63, v75
    v_bfe_u32 v78, v75, 2, 2
    v_lshl_add_u32 v77, v78, 3, v77
    v_bfe_u32 v79, v75, 4, 1
    v_lshl_add_u32 v77, v79, 2, v77
    v_lshl_add_u32 v76, s39, 1, v76
    v_subrev_u32 v78, 14, v76
    v_cmp_gt_u32 vcc, 14, v76
    v_mul_lo_u32 v77, v77, s43
    s_nop 0
    v_cndmask_b32 v76, v78, v76, vcc
    v_lshl_add_u32 v77, v76, 4, v77
    v_add_u32 v14, s41, v77
    s_lshr_b32 s64, s2, 3
    s_and_b32 s15, s61, 3
    s_lshl_b32 s15, s15, 2
    s_and_b32 s65, s64, 3
    s_add_u32 s15, s15, s65
    s_lshr_b32 s31, s64, 2
    s_lshl_b32 s31, s31, 1
    s_lshr_b32 s65, s61, 2
    s_add_u32 s31, s31, s65
    s_lshl_b32 s37, s15, 3
    s_lshl_b32 s65, s34, 1
    s_add_u32 s37, s37, s65

    s_lshl_b32 s44, s35, 4
    s_lshl_b32 s47, s34, 2
    s_add_u32 s44, s44, s47
    s_lshl_b32 s47, s44, 15
    v_add_u32 v15, s47, v252
    v_add_u32 v16, 32768, v15
    v_add_u32 v17, 65536, v15
    v_add_u32 v18, 98304, v15
    v_lshrrev_b32 v96, 4, v1
    v_lshrrev_b32 v97, 2, v1
    v_and_b32 v98, 3, v1
    v_lshlrev_b32 v98, 3, v98
    v_and_b32 v96, 1, v96
    v_lshlrev_b32 v96, 5, v96
    v_mul_u32_u24 v99, 192, v97
    v_add_u32 v99, v99, v98
    v_add_u32 v19, v99, v96
    v_sub_u32 v20, v99, v96
    v_mul_u32_u24 v99, 224, v97
    v_add_u32 v99, v99, v98
    v_add_u32 v21, 49152, v99

    v_lshlrev_b32 v96, 7, v0
    v_cmp_gt_u32 vcc, 24, v0
    s_mul_i32 s90, s2, 3072
    s_mul_i32 s91, s2, 3584
    v_cndmask_b32 v22, -2.0, v96, vcc
    v_cmp_gt_u32 vcc, 28, v0
    s_add_u32 s90, s90, 1572864
    s_add_u32 s91, s91, 1835008
    v_cndmask_b32 v23, -2.0, v96, vcc

    s_lshl_b32 s66, s35, 12
    s_add_u32 s66, s66, 50462720
    s_lshl_b32 s67, s36, 7
    s_add_u32 s67, s67, s66
    s_lshl_b32 s62, s34, 29
    s_add_u32 s67, s67, s62
    v_and_b32 v25, 31, v1
    v_lshlrev_b32 v25, 7, v25
    s_waitcnt vmcnt(0)
    s_barrier
    s_mov_b64 exec, 1
    buffer_store_dwordx2 v[250:251], off, s[16:19], s67 sc1
    s_mov_b64 exec, -1
    s_add_u32 m0, s38, 0
    s_nop 0
    buffer_load_dwordx4 v2, s[68:71], s48 offen lds
    s_add_u32 m0, s38, 49152
    s_nop 0
    buffer_load_dwordx4 v8, s[72:75], s49 offen lds
    s_add_u32 m0, s38, 4096
    s_nop 0
    buffer_load_dwordx4 v3, s[68:71], s48 offen lds
    s_add_u32 m0, s38, 53248
    s_nop 0
    buffer_load_dwordx4 v9, s[72:75], s49 offen lds
    s_add_u32 m0, s38, 8192
    s_nop 0
    buffer_load_dwordx4 v4, s[68:71], s48 offen lds
    s_add_u32 m0, s38, 57344
    s_nop 0
    buffer_load_dwordx4 v10, s[72:75], s49 offen lds
    s_add_u32 m0, s38, 61440
    s_nop 0
    buffer_load_dwordx4 v11, s[72:75], s49 offen lds
    v_lshlrev_b32 v138, 16, v28
    v_and_b32 v139, 0xffff0000, v28
    v_lshlrev_b32 v140, 16, v29
    v_and_b32 v141, 0xffff0000, v29
    v_lshlrev_b32 v142, 16, v28
    v_and_b32 v143, 0xffff0000, v28
    v_lshlrev_b32 v144, 16, v29
    v_and_b32 v145, 0xffff0000, v29
    v_lshlrev_b32 v146, 16, v28
    v_and_b32 v147, 0xffff0000, v28
    v_lshlrev_b32 v148, 16, v29
    v_and_b32 v149, 0xffff0000, v29
    v_lshlrev_b32 v150, 16, v28
    v_and_b32 v151, 0xffff0000, v28
    v_lshlrev_b32 v152, 16, v29
    v_and_b32 v153, 0xffff0000, v29
    v_lshlrev_b32 v154, 16, v30
    v_and_b32 v155, 0xffff0000, v30
    v_lshlrev_b32 v156, 16, v31
    v_and_b32 v157, 0xffff0000, v31
    v_lshlrev_b32 v158, 16, v30
    v_and_b32 v159, 0xffff0000, v30
    v_lshlrev_b32 v160, 16, v31
    v_and_b32 v161, 0xffff0000, v31
    v_lshlrev_b32 v162, 16, v30
    v_and_b32 v163, 0xffff0000, v30
    v_lshlrev_b32 v164, 16, v31
    v_and_b32 v165, 0xffff0000, v31
    v_lshlrev_b32 v166, 16, v30
    v_and_b32 v167, 0xffff0000, v30
    v_lshlrev_b32 v168, 16, v31
    v_and_b32 v169, 0xffff0000, v31
    v_lshlrev_b32 v170, 16, v32
    v_and_b32 v171, 0xffff0000, v32
    v_lshlrev_b32 v172, 16, v33
    v_and_b32 v173, 0xffff0000, v33
    v_lshlrev_b32 v174, 16, v32
    v_and_b32 v175, 0xffff0000, v32
    v_lshlrev_b32 v176, 16, v33
    v_and_b32 v177, 0xffff0000, v33
    v_lshlrev_b32 v178, 16, v32
    v_and_b32 v179, 0xffff0000, v32
    v_lshlrev_b32 v180, 16, v33
    v_and_b32 v181, 0xffff0000, v33
    v_lshlrev_b32 v182, 16, v32
    v_and_b32 v183, 0xffff0000, v32
    v_lshlrev_b32 v184, 16, v33
    v_and_b32 v185, 0xffff0000, v33
    v_lshlrev_b32 v186, 16, v34
    v_and_b32 v187, 0xffff0000, v34
    v_lshlrev_b32 v188, 16, v35
    v_and_b32 v189, 0xffff0000, v35
    v_lshlrev_b32 v190, 16, v34
    v_and_b32 v191, 0xffff0000, v34
    v_lshlrev_b32 v192, 16, v35
    v_and_b32 v193, 0xffff0000, v35
    v_lshlrev_b32 v194, 16, v34
    v_and_b32 v195, 0xffff0000, v34
    v_lshlrev_b32 v196, 16, v35
    v_and_b32 v197, 0xffff0000, v35
    v_lshlrev_b32 v198, 16, v34
    v_and_b32 v199, 0xffff0000, v34
    v_lshlrev_b32 v200, 16, v35
    v_and_b32 v201, 0xffff0000, v35
    v_lshlrev_b32 v202, 16, v36
    v_and_b32 v203, 0xffff0000, v36
    v_lshlrev_b32 v204, 16, v37
    v_and_b32 v205, 0xffff0000, v37
    v_lshlrev_b32 v206, 16, v36
    v_and_b32 v207, 0xffff0000, v36
    v_lshlrev_b32 v208, 16, v37
    v_and_b32 v209, 0xffff0000, v37
    v_lshlrev_b32 v210, 16, v36
    v_and_b32 v211, 0xffff0000, v36
    v_lshlrev_b32 v212, 16, v37
    v_and_b32 v213, 0xffff0000, v37
    v_lshlrev_b32 v214, 16, v36
    v_and_b32 v215, 0xffff0000, v36
    v_lshlrev_b32 v216, 16, v37
    v_and_b32 v217, 0xffff0000, v37
    v_lshlrev_b32 v218, 16, v38
    v_and_b32 v219, 0xffff0000, v38
    v_lshlrev_b32 v220, 16, v39
    v_and_b32 v221, 0xffff0000, v39
    v_lshlrev_b32 v222, 16, v38
    v_and_b32 v223, 0xffff0000, v38
    v_lshlrev_b32 v224, 16, v39
    v_and_b32 v225, 0xffff0000, v39
    v_lshlrev_b32 v226, 16, v38
    v_and_b32 v227, 0xffff0000, v38
    v_lshlrev_b32 v228, 16, v39
    v_and_b32 v229, 0xffff0000, v39
    v_lshlrev_b32 v230, 16, v38
    v_and_b32 v231, 0xffff0000, v38
    v_lshlrev_b32 v232, 16, v39
    v_and_b32 v233, 0xffff0000, v39
    v_lshlrev_b32 v234, 16, v40
    v_and_b32 v235, 0xffff0000, v40
    v_lshlrev_b32 v236, 16, v41
    v_and_b32 v237, 0xffff0000, v41
    v_lshlrev_b32 v238, 16, v40
    v_and_b32 v239, 0xffff0000, v40
    v_lshlrev_b32 v240, 16, v41
    v_and_b32 v241, 0xffff0000, v41
    v_lshlrev_b32 v242, 16, v40
    v_and_b32 v243, 0xffff0000, v40
    v_lshlrev_b32 v244, 16, v41
    v_and_b32 v245, 0xffff0000, v41
    v_lshlrev_b32 v246, 16, v40
    v_and_b32 v247, 0xffff0000, v40
    v_lshlrev_b32 v248, 16, v41
    v_and_b32 v249, 0xffff0000, v41
    v_mov_b32 v42, 0
    v_mov_b32 v43, 0
    v_mov_b32 v44, 0
    v_mov_b32 v45, 0
    v_mov_b32 v46, 0
    v_mov_b32 v47, 0
    v_mov_b32 v48, 0
    v_mov_b32 v49, 0
    v_mov_b32 v50, 0
    v_mov_b32 v51, 0
    v_mov_b32 v52, 0
    v_mov_b32 v53, 0
    v_mov_b32 v54, 0
    v_mov_b32 v55, 0
    v_mov_b32 v56, 0
    v_mov_b32 v57, 0
    v_mov_b32 v58, 0
    v_mov_b32 v59, 0
    v_mov_b32 v60, 0
    v_mov_b32 v61, 0
    v_mov_b32 v62, 0
    v_mov_b32 v63, 0
    v_mov_b32 v64, 0
    v_mov_b32 v65, 0
    v_mov_b32 v66, 0
    v_mov_b32 v67, 0
    v_mov_b32 v68, 0
    v_mov_b32 v69, 0
    v_mov_b32 v70, 0
    v_mov_b32 v71, 0
    v_mov_b32 v72, 0
    v_mov_b32 v73, 0
    v_mov_b32 v74, 0
    v_mov_b32 v75, 0
    v_mov_b32 v76, 0
    v_mov_b32 v77, 0
    v_mov_b32 v78, 0
    v_mov_b32 v79, 0
    v_mov_b32 v80, 0
    v_mov_b32 v81, 0
    v_mov_b32 v82, 0
    v_mov_b32 v83, 0
    v_mov_b32 v84, 0
    v_mov_b32 v85, 0
    v_mov_b32 v86, 0
    v_mov_b32 v87, 0
    v_mov_b32 v88, 0
    v_mov_b32 v89, 0
    v_mov_b32 v90, 0
    v_mov_b32 v91, 0
    v_mov_b32 v92, 0
    v_mov_b32 v93, 0
    v_mov_b32 v94, 0
    v_mov_b32 v95, 0
    v_mov_b32 v96, 0
    v_mov_b32 v97, 0
    v_mov_b32 v98, 0
    v_mov_b32 v99, 0
    v_mov_b32 v100, 0
    v_mov_b32 v101, 0
    v_mov_b32 v102, 0
    v_mov_b32 v103, 0
    v_mov_b32 v104, 0
    v_mov_b32 v105, 0
    v_mov_b32 v106, 0
    v_mov_b32 v107, 0
    v_mov_b32 v108, 0
    v_mov_b32 v109, 0
    v_mov_b32 v110, 0
    v_mov_b32 v111, 0
    v_mov_b32 v112, 0
    v_mov_b32 v113, 0
    v_mov_b32 v114, 0
    v_mov_b32 v115, 0
    v_mov_b32 v116, 0
    v_mov_b32 v117, 0
    v_mov_b32 v118, 0
    v_mov_b32 v119, 0
    v_mov_b32 v120, 0
    v_mov_b32 v121, 0
    v_mov_b32 v122, 0
    v_mov_b32 v123, 0
    v_mov_b32 v124, 0
    v_mov_b32 v125, 0
    v_mov_b32 v126, 0
    v_mov_b32 v127, 0
    v_mov_b32 v128, 0
    v_mov_b32 v129, 0
    v_mov_b32 v130, 0
    v_mov_b32 v131, 0
    v_mov_b32 v132, 0
    v_mov_b32 v133, 0
    v_mov_b32 v134, 0
    v_mov_b32 v135, 0
    v_mov_b32 v136, 0
    v_mov_b32 v137, 0
    v_lshrrev_b32 v28, 4, v1
    v_and_b32 v29, 15, v1
    s_mul_i32 s54, s36, 3
    s_lshl_b32 s55, s35, 3
    s_lshl_b32 s56, s34, 1
    s_add_u32 s55, s55, s56
    s_lshl_b32 s55, s55, 11
    s_add_u32 s55, s55, 4194304
    s_add_u32 s56, s54, 0
    s_lshl_b32 s12, s56, 17
    s_add_u32 s12, s12, s55
    s_cmp_lt_u32 s56, 32
    s_cselect_b32 s4, 0x3e8293ee, 1.0
    s_cmp_lt_u32 s56, 64
    s_cselect_b32 s58, 0, 12
    v_lshlrev_b32 v30, 2, v28
    v_and_b32 v30, s58, v30
    v_xor_b32 v30, v30, v29
    v_lshlrev_b32 v30, 4, v30
    v_lshl_add_u32 v39, v28, 9, v30
    s_add_u32 s56, s54, 1
    s_lshl_b32 s13, s56, 17
    s_add_u32 s13, s13, s55
    s_cmp_lt_u32 s56, 32
    s_cselect_b32 s5, 0x3e8293ee, 1.0
    s_cmp_lt_u32 s56, 64
    s_cselect_b32 s58, 0, 12
    v_lshlrev_b32 v30, 2, v28
    v_and_b32 v30, s58, v30
    v_xor_b32 v30, v30, v29
    v_lshlrev_b32 v30, 4, v30
    v_lshl_add_u32 v40, v28, 9, v30
    s_add_u32 s56, s54, 2
    s_lshl_b32 s14, s56, 17
    s_add_u32 s14, s14, s55
    s_cmp_lt_u32 s56, 32
    s_cselect_b32 s6, 0x3e8293ee, 1.0
    s_cmp_lt_u32 s56, 64
    s_cselect_b32 s58, 0, 12
    v_lshlrev_b32 v30, 2, v28
    v_and_b32 v30, s58, v30
    v_xor_b32 v30, v30, v29
    v_lshlrev_b32 v30, 4, v30
    v_lshl_add_u32 v41, v28, 9, v30
    s_lshl_b32 s7, s36, 10
    s_lshl_b32 s56, s35, 7
    s_add_u32 s7, s7, s56
    s_add_u32 s7, s7, 50528256
    s_lshl_b32 s62, s34, 29
    s_add_u32 s7, s7, s62
    s_cmp_lg_u32 s34, 0
    s_cbranch_scc1 L_xn_ok
    buffer_load_dwordx2 v[26:27], v25, s[16:19], s66 offen sc1
    s_waitcnt vmcnt(0)
    v_cmp_ne_u32 vcc, s52, v26
    v_cmp_ne_u32 s[64:65], s53, v27
    s_nop 1
    s_or_b64 s[64:65], vcc, s[64:65]
    s_and_b32 s64, s64, 0xffffffff
    s_cbranch_scc0 L_xn_ok
L_xn_slow:
    s_mov_b32 s62, 20000
L_xn_spin:
    s_sub_u32 s62, s62, 1
    s_cmp_eq_u32 s62, 0
    s_cbranch_scc1 L_xn_ok
    s_sleep 1
    buffer_load_dwordx2 v[26:27], v25, s[16:19], s66 offen sc1
    s_waitcnt vmcnt(0)
    v_cmp_ne_u32 vcc, s52, v26
    v_cmp_ne_u32 s[64:65], s53, v27
    s_nop 1
    s_or_b64 s[64:65], vcc, s[64:65]
    s_and_b32 s64, s64, 0xffffffff
    s_cbranch_scc1 L_xn_spin
L_xn_ok:
    s_waitcnt vmcnt(0)
    s_barrier
    buffer_load_dwordx4 a[0:3], v15, s[16:19], s50 offen offset:0 sc1
    buffer_load_dwordx4 a[4:7], v16, s[16:19], s50 offen offset:0 sc1
    buffer_load_dwordx4 a[8:11], v17, s[16:19], s50 offen offset:0 sc1
    buffer_load_dwordx4 a[12:15], v18, s[16:19], s50 offen offset:0 sc1
    s_add_u32 m0, s38, 12288
    s_nop 0
    buffer_load_dwordx4 v5, s[68:71], s48 offen lds
    s_add_u32 m0, s38, 65536
    s_nop 0
    buffer_load_dwordx4 v12, s[72:75], s49 offen lds
    s_add_u32 m0, s38, 16384
    s_nop 0
    buffer_load_dwordx4 v6, s[68:71], s48 offen lds
    s_add_u32 m0, s38, 69632
    s_nop 0
    buffer_load_dwordx4 v13, s[72:75], s49 offen lds
    s_add_u32 m0, s38, 20480
    s_nop 0
    buffer_load_dwordx4 v7, s[68:71], s48 offen lds
    s_add_u32 m0, s38, 73728
    s_nop 0
    buffer_load_dwordx4 v14, s[72:75], s49 offen lds
    buffer_load_dwordx4 a[16:19], v15, s[16:19], s50 offen offset:1024 sc1
    buffer_load_dwordx4 a[20:23], v16, s[16:19], s50 offen offset:1024 sc1
    buffer_load_dwordx4 a[24:27], v17, s[16:19], s50 offen offset:1024 sc1
    buffer_load_dwordx4 a[28:31], v18, s[16:19], s50 offen offset:1024 sc1
    buffer_load_dwordx4 a[32:35], v15, s[16:19], s50 offen offset:2048 sc1
    buffer_load_dwordx4 a[36:39], v16, s[16:19], s50 offen offset:2048 sc1
    buffer_load_dwordx4 a[40:43], v17, s[16:19], s50 offen offset:2048 sc1
    buffer_load_dwordx4 a[44:47], v18, s[16:19], s50 offen offset:2048 sc1
    s_add_u32 s48, s48, 786432
    s_add_u32 s49, s49, 917504
    ds_read_b64_tr_b16 a[64:65], v19 offset:0
    ds_read_b64_tr_b16 a[66:67], v19 offset:3072
    ds_read_b64_tr_b16 a[68:69], v20 offset:32
    ds_read_b64_tr_b16 a[70:71], v20 offset:3104
    ds_read_b64_tr_b16 a[72:73], v19 offset:64
    ds_read_b64_tr_b16 a[74:75], v19 offset:3136
    ds_read_b64_tr_b16 a[76:77], v20 offset:96
    ds_read_b64_tr_b16 a[78:79], v20 offset:3168
    s_mov_b32 s45, 0
    s_lshr_b32 s64, s2, 3
    v_and_b32 v36, 15, v0
    v_lshl_add_u32 v36, s64, 4, v36
    v_lshlrev_b32 v36, 7, v36
    v_min_u32 v36, L_end-L_pfa, v36
    .p2align 6
L_g1_loop:
    s_waitcnt lgkmcnt(6)
    s_waitcnt vmcnt(14)
    v_mfma_f32_16x16x32_bf16 v[42:45], a[64:67], a[0:3], v[42:45]
    ds_read_b64_tr_b16 a[80:81], v19 offset:128
    v_mfma_f32_16x16x32_bf16 v[46:49], a[64:67], a[4:7], v[46:49]
    ds_read_b64_tr_b16 a[82:83], v19 offset:3200
    s_add_u32 m0, s38, 24576
    v_mfma_f32_16x16x32_bf16 v[50:53], a[64:67], a[8:11], v[50:53]
    buffer_load_dwordx4 v2, s[68:71], s48 offen lds
    v_mfma_f32_16x16x32_bf16 v[54:57], a[64:67], a[12:15], v[54:57]
    s_waitcnt lgkmcnt(6)
    v_mfma_f32_16x16x32_bf16 v[70:73], a[68:71], a[12:15], v[70:73]
    ds_read_b64_tr_b16 a[84:85], v20 offset:160
    v_mfma_f32_16x16x32_bf16 v[66:69], a[68:71], a[8:11], v[66:69]
    ds_read_b64_tr_b16 a[86:87], v20 offset:3232
    s_add_u32 m0, s38, 77824
    v_mfma_f32_16x16x32_bf16 v[62:65], a[68:71], a[4:7], v[62:65]
    buffer_load_dwordx4 v8, s[72:75], s49 offen lds
    v_mfma_f32_16x16x32_bf16 v[58:61], a[68:71], a[0:3], v[58:61]
    s_waitcnt lgkmcnt(6)
    v_mfma_f32_16x16x32_bf16 v[74:77], a[72:75], a[0:3], v[74:77]
    ds_read_b64_tr_b16 a[88:89], v21 offset:0
    v_mfma_f32_16x16x32_bf16 v[78:81], a[72:75], a[4:7], v[78:81]
    ds_read_b64_tr_b16 a[90:91], v21 offset:3584
    s_add_u32 m0, s38, 28672
    v_mfma_f32_16x16x32_bf16 v[82:85], a[72:75], a[8:11], v[82:85]
    buffer_load_dwordx4 v3, s[68:71], s48 offen lds
    v_mfma_f32_16x16x32_bf16 v[86:89], a[72:75], a[12:15], v[86:89]
    s_waitcnt lgkmcnt(6)
    v_mfma_f32_16x16x32_bf16 v[102:105], a[76:79], a[12:15], v[102:105]
    ds_read_b64_tr_b16 a[92:93], v21 offset:32
    v_mfma_f32_16x16x32_bf16 v[98:101], a[76:79], a[8:11], v[98:101]
    ds_read_b64_tr_b16 a[94:95], v21 offset:3616
    s_add_u32 m0, s38, 81920
    v_mfma_f32_16x16x32_bf16 v[94:97], a[76:79], a[4:7], v[94:97]
    buffer_load_dwordx4 v9, s[72:75], s49 offen lds
    v_mfma_f32_16x16x32_bf16 v[90:93], a[76:79], a[0:3], v[90:93]
    s_waitcnt lgkmcnt(6)
    v_mfma_f32_16x16x32_bf16 v[106:109], a[80:83], a[0:3], v[106:109]
    ds_read_b64_tr_b16 a[96:97], v21 offset:64
    v_mfma_f32_16x16x32_bf16 v[110:113], a[80:83], a[4:7], v[110:113]
    ds_read_b64_tr_b16 a[98:99], v21 offset:3648
    s_add_u32 m0, s38, 32768
    v_mfma_f32_16x16x32_bf16 v[114:117], a[80:83], a[8:11], v[114:117]
    buffer_load_dwordx4 v4, s[68:71], s48 offen lds
    v_mfma_f32_16x16x32_bf16 v[118:121], a[80:83], a[12:15], v[118:121]
    s_waitcnt lgkmcnt(6)
    v_mfma_f32_16x16x32_bf16 v[134:137], a[84:87], a[12:15], v[134:137]
    ds_read_b64_tr_b16 a[100:101], v21 offset:96
    v_mfma_f32_16x16x32_bf16 v[130:133], a[84:87], a[8:11], v[130:133]
    ds_read_b64_tr_b16 a[102:103], v21 offset:3680
    s_add_u32 m0, s38, 86016
    v_mfma_f32_16x16x32_bf16 v[126:129], a[84:87], a[4:7], v[126:129]
    buffer_load_dwordx4 v10, s[72:75], s49 offen lds
    v_mfma_f32_16x16x32_bf16 v[122:125], a[84:87], a[0:3], v[122:125]
    s_waitcnt lgkmcnt(6)
    v_mfma_f32_16x16x32_bf16 v[138:141], a[88:91], a[0:3], v[138:141]
    ds_read_b64_tr_b16 a[104:105], v21 offset:128
    v_mfma_f32_16x16x32_bf16 v[142:145], a[88:91], a[4:7], v[142:145]
    ds_read_b64_tr_b16 a[106:107], v21 offset:3712
    s_add_u32 m0, s38, 90112
    v_mfma_f32_16x16x32_bf16 v[146:149], a[88:91], a[8:11], v[146:149]
    buffer_load_dwordx4 v11, s[72:75], s49 offen lds
    v_mfma_f32_16x16x32_bf16 v[150:153], a[88:91], a[12:15], v[150:153]
    s_waitcnt lgkmcnt(6)
    v_mfma_f32_16x16x32_bf16 v[166:169], a[92:95], a[12:15], v[166:169]
    ds_read_b64_tr_b16 a[108:109], v21 offset:160
    v_mfma_f32_16x16x32_bf16 v[162:165], a[92:95], a[8:11], v[162:165]
    ds_read_b64_tr_b16 a[110:111], v21 offset:3744
    v_mfma_f32_16x16x32_bf16 v[158:161], a[92:95], a[4:7], v[158:161]
    buffer_load_dwordx4 a[48:51], v15, s[16:19], s50 offen offset:3072 sc1
    v_mfma_f32_16x16x32_bf16 v[154:157], a[92:95], a[0:3], v[154:157]
    s_waitcnt lgkmcnt(6)
    v_mfma_f32_16x16x32_bf16 v[170:173], a[96:99], a[0:3], v[170:173]
    ds_read_b64_tr_b16 a[112:113], v21 offset:192
    v_mfma_f32_16x16x32_bf16 v[174:177], a[96:99], a[4:7], v[174:177]
    ds_read_b64_tr_b16 a[114:115], v21 offset:3776
    v_mfma_f32_16x16x32_bf16 v[178:181], a[96:99], a[8:11], v[178:181]
    buffer_load_dwordx4 a[52:55], v16, s[16:19], s50 offen offset:3072 sc1
    v_mfma_f32_16x16x32_bf16 v[182:185], a[96:99], a[12:15], v[182:185]
    s_waitcnt lgkmcnt(6)
    v_mfma_f32_16x16x32_bf16 v[198:201], a[100:103], a[12:15], v[198:201]
    ds_read_b64_tr_b16 a[64:65], v19 offset:6144
    v_mfma_f32_16x16x32_bf16 v[194:197], a[100:103], a[8:11], v[194:197]
    ds_read_b64_tr_b16 a[66:67], v19 offset:9216
    v_mfma_f32_16x16x32_bf16 v[190:193], a[100:103], a[4:7], v[190:193]
    buffer_load_dwordx4 a[56:59], v17, s[16:19], s50 offen offset:3072 sc1
    v_mfma_f32_16x16x32_bf16 v[186:189], a[100:103], a[0:3], v[186:189]
    s_waitcnt lgkmcnt(6)
    v_mfma_f32_16x16x32_bf16 v[202:205], a[104:107], a[0:3], v[202:205]
    ds_read_b64_tr_b16 a[68:69], v20 offset:6176
    v_mfma_f32_16x16x32_bf16 v[206:209], a[104:107], a[4:7], v[206:209]
    ds_read_b64_tr_b16 a[70:71], v20 offset:9248
    v_mfma_f32_16x16x32_bf16 v[210:213], a[104:107], a[8:11], v[210:213]
    buffer_load_dwordx4 a[60:63], v18, s[16:19], s50 offen offset:3072 sc1
    v_mfma_f32_16x16x32_bf16 v[214:217], a[104:107], a[12:15], v[214:217]
    s_waitcnt lgkmcnt(6)
    v_mfma_f32_16x16x32_bf16 v[230:233], a[108:111], a[12:15], v[230:233]
    ds_read_b64_tr_b16 a[72:73], v19 offset:6208
    v_mfma_f32_16x16x32_bf16 v[226:229], a[108:111], a[8:11], v[226:229]
    ds_read_b64_tr_b16 a[74:75], v19 offset:9280
    v_mfma_f32_16x16x32_bf16 v[222:225], a[108:111], a[4:7], v[222:225]
    buffer_load_dword a120, v22, s[68:71], s90 offen
    v_mfma_f32_16x16x32_bf16 v[218:221], a[108:111], a[0:3], v[218:221]
    s_waitcnt lgkmcnt(6)
    v_mfma_f32_16x16x32_bf16 v[234:237], a[112:115], a[0:3], v[234:237]
    ds_read_b64_tr_b16 a[76:77], v20 offset:6240
    v_mfma_f32_16x16x32_bf16 v[238:241], a[112:115], a[4:7], v[238:241]
    ds_read_b64_tr_b16 a[78:79], v20 offset:9312
    v_mfma_f32_16x16x32_bf16 v[242:245], a[112:115], a[8:11], v[242:245]
    buffer_load_dword a121, v23, s[72:75], s91 offen
    v_mfma_f32_16x16x32_bf16 v[246:249], a[112:115], a[12:15], v[246:249]
    s_waitcnt lgkmcnt(6)
    s_waitcnt vmcnt(17)
    v_mfma_f32_16x16x32_bf16 v[42:45], a[64:67], a[16:19], v[42:45]
    ds_read_b64_tr_b16 a[80:81], v19 offset:6272
    s_add_u32 s50, s50, 4096
    v_mfma_f32_16x16x32_bf16 v[46:49], a[64:67], a[20:23], v[46:49]
    ds_read_b64_tr_b16 a[82:83], v19 offset:9344
    v_mfma_f32_16x16x32_bf16 v[50:53], a[64:67], a[24:27], v[50:53]
    buffer_load_dwordx4 a[0:3], v15, s[16:19], s50 offen offset:0 sc1
    v_mfma_f32_16x16x32_bf16 v[54:57], a[64:67], a[28:31], v[54:57]
    s_waitcnt lgkmcnt(6)
    v_mfma_f32_16x16x32_bf16 v[70:73], a[68:71], a[28:31], v[70:73]
    ds_read_b64_tr_b16 a[84:85], v20 offset:6304
    v_mfma_f32_16x16x32_bf16 v[66:69], a[68:71], a[24:27], v[66:69]
    ds_read_b64_tr_b16 a[86:87], v20 offset:9376
    v_mfma_f32_16x16x32_bf16 v[62:65], a[68:71], a[20:23], v[62:65]
    buffer_load_dwordx4 a[4:7], v16, s[16:19], s50 offen offset:0 sc1
    v_mfma_f32_16x16x32_bf16 v[58:61], a[68:71], a[16:19], v[58:61]
    s_add_u32 s90, s90, 786432
    s_waitcnt lgkmcnt(6)
    v_mfma_f32_16x16x32_bf16 v[74:77], a[72:75], a[16:19], v[74:77]
    ds_read_b64_tr_b16 a[88:89], v21 offset:7168
    v_mfma_f32_16x16x32_bf16 v[78:81], a[72:75], a[20:23], v[78:81]
    ds_read_b64_tr_b16 a[90:91], v21 offset:10752
    v_mfma_f32_16x16x32_bf16 v[82:85], a[72:75], a[24:27], v[82:85]
    buffer_load_dwordx4 a[8:11], v17, s[16:19], s50 offen offset:0 sc1
    v_mfma_f32_16x16x32_bf16 v[86:89], a[72:75], a[28:31], v[86:89]
    s_add_u32 s91, s91, 917504
    s_waitcnt lgkmcnt(6)
    v_mfma_f32_16x16x32_bf16 v[102:105], a[76:79], a[28:31], v[102:105]
    ds_read_b64_tr_b16 a[92:93], v21 offset:7200
    v_mfma_f32_16x16x32_bf16 v[98:101], a[76:79], a[24:27], v[98:101]
    ds_read_b64_tr_b16 a[94:95], v21 offset:10784
    v_mfma_f32_16x16x32_bf16 v[94:97], a[76:79], a[20:23], v[94:97]
    buffer_load_dwordx4 a[12:15], v18, s[16:19], s50 offen offset:0 sc1
    v_mfma_f32_16x16x32_bf16 v[90:93], a[76:79], a[16:19], v[90:93]
    s_waitcnt lgkmcnt(6)
    v_mfma_f32_16x16x32_bf16 v[106:109], a[80:83], a[16:19], v[106:109]
    ds_read_b64_tr_b16 a[96:97], v21 offset:7232
    v_mfma_f32_16x16x32_bf16 v[110:113], a[80:83], a[20:23], v[110:113]
    ds_read_b64_tr_b16 a[98:99], v21 offset:10816
    v_mfma_f32_16x16x32_bf16 v[114:117], a[80:83], a[24:27], v[114:117]
    v_mfma_f32_16x16x32_bf16 v[118:121], a[80:83], a[28:31], v[118:121]
    s_waitcnt lgkmcnt(6)
    v_mfma_f32_16x16x32_bf16 v[134:137], a[84:87], a[28:31], v[134:137]
    ds_read_b64_tr_b16 a[100:101], v21 offset:7264
    v_mfma_f32_16x16x32_bf16 v[130:133], a[84:87], a[24:27], v[130:133]
    ds_read_b64_tr_b16 a[102:103], v21 offset:10848
    v_mfma_f32_16x16x32_bf16 v[126:129], a[84:87], a[20:23], v[126:129]
    v_mfma_f32_16x16x32_bf16 v[122:125], a[84:87], a[16:19], v[122:125]
    s_waitcnt lgkmcnt(6)
    v_mfma_f32_16x16x32_bf16 v[138:141], a[88:91], a[16:19], v[138:141]
    ds_read_b64_tr_b16 a[104:105], v21 offset:7296
    v_mfma_f32_16x16x32_bf16 v[142:145], a[88:91], a[20:23], v[142:145]
    ds_read_b64_tr_b16 a[106:107], v21 offset:10880
    v_mfma_f32_16x16x32_bf16 v[146:149], a[88:91], a[24:27], v[146:149]
    v_mfma_f32_16x16x32_bf16 v[150:153], a[88:91], a[28:31], v[150:153]
    s_waitcnt lgkmcnt(6)
    v_mfma_f32_16x16x32_bf16 v[166:169], a[92:95], a[28:31], v[166:169]
    ds_read_b64_tr_b16 a[108:109], v21 offset:7328
    v_mfma_f32_16x16x32_bf16 v[162:165], a[92:95], a[24:27], v[162:165]
    ds_read_b64_tr_b16 a[110:111], v21 offset:10912
    v_mfma_f32_16x16x32_bf16 v[158:161], a[92:95], a[20:23], v[158:161]
    v_mfma_f32_16x16x32_bf16 v[154:157], a[92:95], a[16:19], v[154:157]
    s_waitcnt lgkmcnt(6)
    v_mfma_f32_16x16x32_bf16 v[170:173], a[96:99], a[16:19], v[170:173]
    ds_read_b64_tr_b16 a[112:113], v21 offset:7360
    v_mfma_f32_16x16x32_bf16 v[174:177], a[96:99], a[20:23], v[174:177]
    ds_read_b64_tr_b16 a[114:115], v21 offset:10944
    v_mfma_f32_16x16x32_bf16 v[178:181], a[96:99], a[24:27], v[178:181]
    v_mfma_f32_16x16x32_bf16 v[182:185], a[96:99], a[28:31], v[182:185]
    s_barrier
    s_waitcnt lgkmcnt(6)
    v_mfma_f32_16x16x32_bf16 v[198:201], a[100:103], a[28:31], v[198:201]
    ds_read_b64_tr_b16 a[64:65], v19 offset:12288
    v_mfma_f32_16x16x32_bf16 v[194:197], a[100:103], a[24:27], v[194:197]
    ds_read_b64_tr_b16 a[66:67], v19 offset:15360
    v_mfma_f32_16x16x32_bf16 v[190:193], a[100:103], a[20:23], v[190:193]
    v_mfma_f32_16x16x32_bf16 v[186:189], a[100:103], a[16:19], v[186:189]
    s_waitcnt lgkmcnt(6)
    v_mfma_f32_16x16x32_bf16 v[202:205], a[104:107], a[16:19], v[202:205]
    ds_read_b64_tr_b16 a[68:69], v20 offset:12320
    v_mfma_f32_16x16x32_bf16 v[206:209], a[104:107], a[20:23], v[206:209]
    ds_read_b64_tr_b16 a[70:71], v20 offset:15392
    v_mfma_f32_16x16x32_bf16 v[210:213], a[104:107], a[24:27], v[210:213]
    v_mfma_f32_16x16x32_bf16 v[214:217], a[104:107], a[28:31], v[214:217]
    s_waitcnt lgkmcnt(6)
    v_mfma_f32_16x16x32_bf16 v[230:233], a[108:111], a[28:31], v[230:233]
    ds_read_b64_tr_b16 a[72:73], v19 offset:12352
    v_mfma_f32_16x16x32_bf16 v[226:229], a[108:111], a[24:27], v[226:229]
    ds_read_b64_tr_b16 a[74:75], v19 offset:15424
    v_mfma_f32_16x16x32_bf16 v[222:225], a[108:111], a[20:23], v[222:225]
    v_mfma_f32_16x16x32_bf16 v[218:221], a[108:111], a[16:19], v[218:221]
    s_waitcnt lgkmcnt(6)
    v_mfma_f32_16x16x32_bf16 v[234:237], a[112:115], a[16:19], v[234:237]
    ds_read_b64_tr_b16 a[76:77], v20 offset:12384
    v_mfma_f32_16x16x32_bf16 v[238:241], a[112:115], a[20:23], v[238:241]
    ds_read_b64_tr_b16 a[78:79], v20 offset:15456
    v_mfma_f32_16x16x32_bf16 v[242:245], a[112:115], a[24:27], v[242:245]
    v_mfma_f32_16x16x32_bf16 v[246:249], a[112:115], a[28:31], v[246:249]
    s_waitcnt lgkmcnt(6)
    s_waitcnt vmcnt(17)
    v_mfma_f32_16x16x32_bf16 v[42:45], a[64:67], a[32:35], v[42:45]
    ds_read_b64_tr_b16 a[80:81], v19 offset:12416
    v_mfma_f32_16x16x32_bf16 v[46:49], a[64:67], a[36:39], v[46:49]
    ds_read_b64_tr_b16 a[82:83], v19 offset:15488
    s_add_u32 m0, s38, 36864
    v_mfma_f32_16x16x32_bf16 v[50:53], a[64:67], a[40:43], v[50:53]
    buffer_load_dwordx4 v5, s[68:71], s48 offen lds
    v_mfma_f32_16x16x32_bf16 v[54:57], a[64:67], a[44:47], v[54:57]
    s_waitcnt lgkmcnt(6)
    v_mfma_f32_16x16x32_bf16 v[70:73], a[68:71], a[44:47], v[70:73]
    ds_read_b64_tr_b16 a[84:85], v20 offset:12448
    v_mfma_f32_16x16x32_bf16 v[66:69], a[68:71], a[40:43], v[66:69]
    ds_read_b64_tr_b16 a[86:87], v20 offset:15520
    s_add_u32 m0, s38, 94208
    v_mfma_f32_16x16x32_bf16 v[62:65], a[68:71], a[36:39], v[62:65]
    buffer_load_dwordx4 v12, s[72:75], s49 offen lds
    v_mfma_f32_16x16x32_bf16 v[58:61], a[68:71], a[32:35], v[58:61]
    s_waitcnt lgkmcnt(6)
    v_mfma_f32_16x16x32_bf16 v[74:77], a[72:75], a[32:35], v[74:77]
    ds_read_b64_tr_b16 a[88:89], v21 offset:14336
    v_mfma_f32_16x16x32_bf16 v[78:81], a[72:75], a[36:39], v[78:81]
    ds_read_b64_tr_b16 a[90:91], v21 offset:17920
    s_add_u32 m0, s38, 40960
    v_mfma_f32_16x16x32_bf16 v[82:85], a[72:75], a[40:43], v[82:85]
    buffer_load_dwordx4 v6, s[68:71], s48 offen lds
    v_mfma_f32_16x16x32_bf16 v[86:89], a[72:75], a[44:47], v[86:89]
    s_waitcnt lgkmcnt(6)
    v_mfma_f32_16x16x32_bf16 v[102:105], a[76:79], a[44:47], v[102:105]
    ds_read_b64_tr_b16 a[92:93], v21 offset:14368
    v_mfma_f32_16x16x32_bf16 v[98:101], a[76:79], a[40:43], v[98:101]
    ds_read_b64_tr_b16 a[94:95], v21 offset:17952
    s_add_u32 m0, s38, 98304
    v_mfma_f32_16x16x32_bf16 v[94:97], a[76:79], a[36:39], v[94:97]
    buffer_load_dwordx4 v13, s[72:75], s49 offen lds
    v_mfma_f32_16x16x32_bf16 v[90:93], a[76:79], a[32:35], v[90:93]
    s_waitcnt lgkmcnt(6)
    v_mfma_f32_16x16x32_bf16 v[106:109], a[80:83], a[32:35], v[106:109]
    ds_read_b64_tr_b16 a[96:97], v21 offset:14400
    v_mfma_f32_16x16x32_bf16 v[110:113], a[80:83], a[36:39], v[110:113]
    ds_read_b64_tr_b16 a[98:99], v21 offset:17984
    s_add_u32 m0, s38, 45056
    v_mfma_f32_16x16x32_bf16 v[114:117], a[80:83], a[40:43], v[114:117]
    buffer_load_dwordx4 v7, s[68:71], s48 offen lds
    v_mfma_f32_16x16x32_bf16 v[118:121], a[80:83], a[44:47], v[118:121]
    s_waitcnt lgkmcnt(6)
    v_mfma_f32_16x16x32_bf16 v[134:137], a[84:87], a[44:47], v[134:137]
    ds_read_b64_tr_b16 a[100:101], v21 offset:14432
    v_mfma_f32_16x16x32_bf16 v[130:133], a[84:87], a[40:43], v[130:133]
    ds_read_b64_tr_b16 a[102:103], v21 offset:18016
    s_add_u32 m0, s38, 102400
    v_mfma_f32_16x16x32_bf16 v[126:129], a[84:87], a[36:39], v[126:129]
    buffer_load_dwordx4 v14, s[72:75], s49 offen lds
    v_mfma_f32_16x16x32_bf16 v[122:125], a[84:87], a[32:35], v[122:125]
    s_waitcnt lgkmcnt(6)
    v_mfma_f32_16x16x32_bf16 v[138:141], a[88:91], a[32:35], v[138:141]
    ds_read_b64_tr_b16 a[104:105], v21 offset:14464
    v_mfma_f32_16x16x32_bf16 v[142:145], a[88:91], a[36:39], v[142:145]
    ds_read_b64_tr_b16 a[106:107], v21 offset:18048
    v_mfma_f32_16x16x32_bf16 v[146:149], a[88:91], a[40:43], v[146:149]
    buffer_load_dwordx4 a[16:19], v15, s[16:19], s50 offen offset:1024 sc1
    v_mfma_f32_16x16x32_bf16 v[150:153], a[88:91], a[44:47], v[150:153]
    s_waitcnt lgkmcnt(6)
    v_mfma_f32_16x16x32_bf16 v[166:169], a[92:95], a[44:47], v[166:169]
    ds_read_b64_tr_b16 a[108:109], v21 offset:14496
    v_mfma_f32_16x16x32_bf16 v[162:165], a[92:95], a[40:43], v[162:165]
    ds_read_b64_tr_b16 a[110:111], v21 offset:18080
    v_mfma_f32_16x16x32_bf16 v[158:161], a[92:95], a[36:39], v[158:161]
    buffer_load_dwordx4 a[20:23], v16, s[16:19], s50 offen offset:1024 sc1
    v_mfma_f32_16x16x32_bf16 v[154:157], a[92:95], a[32:35], v[154:157]
    s_waitcnt lgkmcnt(6)
    v_mfma_f32_16x16x32_bf16 v[170:173], a[96:99], a[32:35], v[170:173]
    ds_read_b64_tr_b16 a[112:113], v21 offset:14528
    v_mfma_f32_16x16x32_bf16 v[174:177], a[96:99], a[36:39], v[174:177]
    ds_read_b64_tr_b16 a[114:115], v21 offset:18112
    v_mfma_f32_16x16x32_bf16 v[178:181], a[96:99], a[40:43], v[178:181]
    buffer_load_dwordx4 a[24:27], v17, s[16:19], s50 offen offset:1024 sc1
    v_mfma_f32_16x16x32_bf16 v[182:185], a[96:99], a[44:47], v[182:185]
    s_waitcnt lgkmcnt(6)
    v_mfma_f32_16x16x32_bf16 v[198:201], a[100:103], a[44:47], v[198:201]
    ds_read_b64_tr_b16 a[64:65], v19 offset:18432
    v_mfma_f32_16x16x32_bf16 v[194:197], a[100:103], a[40:43], v[194:197]
    ds_read_b64_tr_b16 a[66:67], v19 offset:21504
    v_mfma_f32_16x16x32_bf16 v[190:193], a[100:103], a[36:39], v[190:193]
    buffer_load_dwordx4 a[28:31], v18, s[16:19], s50 offen offset:1024 sc1
    v_mfma_f32_16x16x32_bf16 v[186:189], a[100:103], a[32:35], v[186:189]
    s_waitcnt lgkmcnt(6)
    v_mfma_f32_16x16x32_bf16 v[202:205], a[104:107], a[32:35], v[202:205]
    ds_read_b64_tr_b16 a[68:69], v20 offset:18464
    v_mfma_f32_16x16x32_bf16 v[206:209], a[104:107], a[36:39], v[206:209]
    ds_read_b64_tr_b16 a[70:71], v20 offset:21536
    v_mfma_f32_16x16x32_bf16 v[210:213], a[104:107], a[40:43], v[210:213]
    v_mfma_f32_16x16x32_bf16 v[214:217], a[104:107], a[44:47], v[214:217]
    s_waitcnt lgkmcnt(6)
    v_mfma_f32_16x16x32_bf16 v[230:233], a[108:111], a[44:47], v[230:233]
    ds_read_b64_tr_b16 a[72:73], v19 offset:18496
    v_mfma_f32_16x16x32_bf16 v[226:229], a[108:111], a[40:43], v[226:229]
    ds_read_b64_tr_b16 a[74:75], v19 offset:21568
    v_mfma_f32_16x16x32_bf16 v[222:225], a[108:111], a[36:39], v[222:225]
    v_mfma_f32_16x16x32_bf16 v[218:221], a[108:111], a[32:35], v[218:221]
    s_add_u32 s48, s48, 786432
    s_waitcnt lgkmcnt(6)
    v_mfma_f32_16x16x32_bf16 v[234:237], a[112:115], a[32:35], v[234:237]
    ds_read_b64_tr_b16 a[76:77], v20 offset:18528
    v_mfma_f32_16x16x32_bf16 v[238:241], a[112:115], a[36:39], v[238:241]
    ds_read_b64_tr_b16 a[78:79], v20 offset:21600
    v_mfma_f32_16x16x32_bf16 v[242:245], a[112:115], a[40:43], v[242:245]
    v_mfma_f32_16x16x32_bf16 v[246:249], a[112:115], a[44:47], v[246:249]
    s_add_u32 s49, s49, 917504
    s_waitcnt lgkmcnt(6)
    s_waitcnt vmcnt(16)
    v_mfma_f32_16x16x32_bf16 v[42:45], a[64:67], a[48:51], v[42:45]
    ds_read_b64_tr_b16 a[80:81], v19 offset:18560
    v_mfma_f32_16x16x32_bf16 v[46:49], a[64:67], a[52:55], v[46:49]
    ds_read_b64_tr_b16 a[82:83], v19 offset:21632
    v_mfma_f32_16x16x32_bf16 v[50:53], a[64:67], a[56:59], v[50:53]
    buffer_load_dwordx4 a[32:35], v15, s[16:19], s50 offen offset:2048 sc1
    v_mfma_f32_16x16x32_bf16 v[54:57], a[64:67], a[60:63], v[54:57]
    s_waitcnt lgkmcnt(6)
    v_mfma_f32_16x16x32_bf16 v[70:73], a[68:71], a[60:63], v[70:73]
    ds_read_b64_tr_b16 a[84:85], v20 offset:18592
    v_mfma_f32_16x16x32_bf16 v[66:69], a[68:71], a[56:59], v[66:69]
    ds_read_b64_tr_b16 a[86:87], v20 offset:21664
    v_mfma_f32_16x16x32_bf16 v[62:65], a[68:71], a[52:55], v[62:65]
    buffer_load_dwordx4 a[36:39], v16, s[16:19], s50 offen offset:2048 sc1
    v_mfma_f32_16x16x32_bf16 v[58:61], a[68:71], a[48:51], v[58:61]
    s_waitcnt lgkmcnt(6)
    v_mfma_f32_16x16x32_bf16 v[74:77], a[72:75], a[48:51], v[74:77]
    ds_read_b64_tr_b16 a[88:89], v21 offset:21504
    v_mfma_f32_16x16x32_bf16 v[78:81], a[72:75], a[52:55], v[78:81]
    ds_read_b64_tr_b16 a[90:91], v21 offset:25088
    v_mfma_f32_16x16x32_bf16 v[82:85], a[72:75], a[56:59], v[82:85]
    buffer_load_dwordx4 a[40:43], v17, s[16:19], s50 offen offset:2048 sc1
    v_mfma_f32_16x16x32_bf16 v[86:89], a[72:75], a[60:63], v[86:89]
    s_waitcnt lgkmcnt(6)
    v_mfma_f32_16x16x32_bf16 v[102:105], a[76:79], a[60:63], v[102:105]
    ds_read_b64_tr_b16 a[92:93], v21 offset:21536
    v_mfma_f32_16x16x32_bf16 v[98:101], a[76:79], a[56:59], v[98:101]
    ds_read_b64_tr_b16 a[94:95], v21 offset:25120
    v_mfma_f32_16x16x32_bf16 v[94:97], a[76:79], a[52:55], v[94:97]
    buffer_load_dwordx4 a[44:47], v18, s[16:19], s50 offen offset:2048 sc1
    v_mfma_f32_16x16x32_bf16 v[90:93], a[76:79], a[48:51], v[90:93]
    s_waitcnt lgkmcnt(6)
    v_mfma_f32_16x16x32_bf16 v[106:109], a[80:83], a[48:51], v[106:109]
    ds_read_b64_tr_b16 a[96:97], v21 offset:21568
    v_mfma_f32_16x16x32_bf16 v[110:113], a[80:83], a[52:55], v[110:113]
    ds_read_b64_tr_b16 a[98:99], v21 offset:25152
    v_mfma_f32_16x16x32_bf16 v[114:117], a[80:83], a[56:59], v[114:117]
    global_load_dword a122, v36, s[92:93]
    v_mfma_f32_16x16x32_bf16 v[118:121], a[80:83], a[60:63], v[118:121]
    s_waitcnt lgkmcnt(6)
    v_mfma_f32_16x16x32_bf16 v[134:137], a[84:87], a[60:63], v[134:137]
    ds_read_b64_tr_b16 a[100:101], v21 offset:21600
    v_mfma_f32_16x16x32_bf16 v[130:133], a[84:87], a[56:59], v[130:133]
    ds_read_b64_tr_b16 a[102:103], v21 offset:25184
    v_mfma_f32_16x16x32_bf16 v[126:129], a[84:87], a[52:55], v[126:129]
    v_mfma_f32_16x16x32_bf16 v[122:125], a[84:87], a[48:51], v[122:125]
    s_waitcnt lgkmcnt(6)
    v_mfma_f32_16x16x32_bf16 v[138:141], a[88:91], a[48:51], v[138:141]
    ds_read_b64_tr_b16 a[104:105], v21 offset:21632
    v_mfma_f32_16x16x32_bf16 v[142:145], a[88:91], a[52:55], v[142:145]
    ds_read_b64_tr_b16 a[106:107], v21 offset:25216
    v_mfma_f32_16x16x32_bf16 v[146:149], a[88:91], a[56:59], v[146:149]
    v_mfma_f32_16x16x32_bf16 v[150:153], a[88:91], a[60:63], v[150:153]
    s_waitcnt lgkmcnt(6)
    v_mfma_f32_16x16x32_bf16 v[166:169], a[92:95], a[60:63], v[166:169]
    ds_read_b64_tr_b16 a[108:109], v21 offset:21664
    v_mfma_f32_16x16x32_bf16 v[162:165], a[92:95], a[56:59], v[162:165]
    ds_read_b64_tr_b16 a[110:111], v21 offset:25248
    v_mfma_f32_16x16x32_bf16 v[158:161], a[92:95], a[52:55], v[158:161]
    v_mfma_f32_16x16x32_bf16 v[154:157], a[92:95], a[48:51], v[154:157]
    s_waitcnt lgkmcnt(6)
    v_mfma_f32_16x16x32_bf16 v[170:173], a[96:99], a[48:51], v[170:173]
    ds_read_b64_tr_b16 a[112:113], v21 offset:21696
    v_mfma_f32_16x16x32_bf16 v[174:177], a[96:99], a[52:55], v[174:177]
    ds_read_b64_tr_b16 a[114:115], v21 offset:25280
    v_mfma_f32_16x16x32_bf16 v[178:181], a[96:99], a[56:59], v[178:181]
    v_mfma_f32_16x16x32_bf16 v[182:185], a[96:99], a[60:63], v[182:185]
    s_barrier
    s_waitcnt lgkmcnt(6)
    v_mfma_f32_16x16x32_bf16 v[198:201], a[100:103], a[60:63], v[198:201]
    ds_read_b64_tr_b16 a[64:65], v19 offset:24576
    v_mfma_f32_16x16x32_bf16 v[194:197], a[100:103], a[56:59], v[194:197]
    ds_read_b64_tr_b16 a[66:67], v19 offset:27648
    v_mfma_f32_16x16x32_bf16 v[190:193], a[100:103], a[52:55], v[190:193]
    v_mfma_f32_16x16x32_bf16 v[186:189], a[100:103], a[48:51], v[186:189]
    s_waitcnt lgkmcnt(6)
    v_mfma_f32_16x16x32_bf16 v[202:205], a[104:107], a[48:51], v[202:205]
    ds_read_b64_tr_b16 a[68:69], v20 offset:24608
    v_mfma_f32_16x16x32_bf16 v[206:209], a[104:107], a[52:55], v[206:209]
    ds_read_b64_tr_b16 a[70:71], v20 offset:27680
    v_mfma_f32_16x16x32_bf16 v[210:213], a[104:107], a[56:59], v[210:213]
    v_mfma_f32_16x16x32_bf16 v[214:217], a[104:107], a[60:63], v[214:217]
    s_waitcnt lgkmcnt(6)
    v_mfma_f32_16x16x32_bf16 v[230:233], a[108:111], a[60:63], v[230:233]
    ds_read_b64_tr_b16 a[72:73], v19 offset:24640
    v_mfma_f32_16x16x32_bf16 v[226:229], a[108:111], a[56:59], v[226:229]
    ds_read_b64_tr_b16 a[74:75], v19 offset:27712
    v_mfma_f32_16x16x32_bf16 v[222:225], a[108:111], a[52:55], v[222:225]
    v_mfma_f32_16x16x32_bf16 v[218:221], a[108:111], a[48:51], v[218:221]
    s_waitcnt lgkmcnt(6)
    v_mfma_f32_16x16x32_bf16 v[234:237], a[112:115], a[48:51], v[234:237]
    ds_read_b64_tr_b16 a[76:77], v20 offset:24672
    v_mfma_f32_16x16x32_bf16 v[238:241], a[112:115], a[52:55], v[238:241]
    ds_read_b64_tr_b16 a[78:79], v20 offset:27744
    v_mfma_f32_16x16x32_bf16 v[242:245], a[112:115], a[56:59], v[242:245]
    v_mfma_f32_16x16x32_bf16 v[246:249], a[112:115], a[60:63], v[246:249]
    s_waitcnt lgkmcnt(6)
    s_waitcnt vmcnt(15)
    v_mfma_f32_16x16x32_bf16 v[42:45], a[64:67], a[0:3], v[42:45]
    ds_read_b64_tr_b16 a[80:81], v19 offset:24704
    v_mfma_f32_16x16x32_bf16 v[46:49], a[64:67], a[4:7], v[46:49]
    ds_read_b64_tr_b16 a[82:83], v19 offset:27776
    s_add_u32 m0, s38, 0
    v_mfma_f32_16x16x32_bf16 v[50:53], a[64:67], a[8:11], v[50:53]
    buffer_load_dwordx4 v2, s[68:71], s48 offen lds
    v_mfma_f32_16x16x32_bf16 v[54:57], a[64:67], a[12:15], v[54:57]
    s_waitcnt lgkmcnt(6)
    v_mfma_f32_16x16x32_bf16 v[70:73], a[68:71], a[12:15], v[70:73]
    ds_read_b64_tr_b16 a[84:85], v20 offset:24736
    v_mfma_f32_16x16x32_bf16 v[66:69], a[68:71], a[8:11], v[66:69]
    ds_read_b64_tr_b16 a[86:87], v20 offset:27808
    s_add_u32 m0, s38, 49152
    v_mfma_f32_16x16x32_bf16 v[62:65], a[68:71], a[4:7], v[62:65]
    buffer_load_dwordx4 v8, s[72:75], s49 offen lds
    v_mfma_f32_16x16x32_bf16 v[58:61], a[68:71], a[0:3], v[58:61]
    s_waitcnt lgkmcnt(6)
    v_mfma_f32_16x16x32_bf16 v[74:77], a[72:75], a[0:3], v[74:77]
    ds_read_b64_tr_b16 a[88:89], v21 offset:28672
    v_mfma_f32_16x16x32_bf16 v[78:81], a[72:75], a[4:7], v[78:81]
    ds_read_b64_tr_b16 a[90:91], v21 offset:32256
    s_add_u32 m0, s38, 4096
    v_mfma_f32_16x16x32_bf16 v[82:85], a[72:75], a[8:11], v[82:85]
    buffer_load_dwordx4 v3, s[68:71], s48 offen lds
    v_mfma_f32_16x16x32_bf16 v[86:89], a[72:75], a[12:15], v[86:89]
    s_waitcnt lgkmcnt(6)
    v_mfma_f32_16x16x32_bf16 v[102:105], a[76:79], a[12:15], v[102:105]
    ds_read_b64_tr_b16 a[92:93], v21 offset:28704
    v_mfma_f32_16x16x32_bf16 v[98:101], a[76:79], a[8:11], v[98:101]
    ds_read_b64_tr_b16 a[94:95], v21 offset:32288
    s_add_u32 m0, s38, 53248
    v_mfma_f32_16x16x32_bf16 v[94:97], a[76:79], a[4:7], v[94:97]
    buffer_load_dwordx4 v9, s[72:75], s49 offen lds
    v_mfma_f32_16x16x32_bf16 v[90:93], a[76:79], a[0:3], v[90:93]
    s_waitcnt lgkmcnt(6)
    v_mfma_f32_16x16x32_bf16 v[106:109], a[80:83], a[0:3], v[106:109]
    ds_read_b64_tr_b16 a[96:97], v21 offset:28736
    v_mfma_f32_16x16x32_bf16 v[110:113], a[80:83], a[4:7], v[110:113]
    ds_read_b64_tr_b16 a[98:99], v21 offset:32320
    s_add_u32 m0, s38, 8192
    v_mfma_f32_16x16x32_bf16 v[114:117], a[80:83], a[8:11], v[114:117]
    buffer_load_dwordx4 v4, s[68:71], s48 offen lds
    v_mfma_f32_16x16x32_bf16 v[118:121], a[80:83], a[12:15], v[118:121]
    s_waitcnt lgkmcnt(6)
    v_mfma_f32_16x16x32_bf16 v[134:137], a[84:87], a[12:15], v[134:137]
    ds_read_b64_tr_b16 a[100:101], v21 offset:28768
    v_mfma_f32_16x16x32_bf16 v[130:133], a[84:87], a[8:11], v[130:133]
    ds_read_b64_tr_b16 a[102:103], v21 offset:32352
    s_add_u32 m0, s38, 57344
    v_mfma_f32_16x16x32_bf16 v[126:129], a[84:87], a[4:7], v[126:129]
    buffer_load_dwordx4 v10, s[72:75], s49 offen lds
    v_mfma_f32_16x16x32_bf16 v[122:125], a[84:87], a[0:3], v[122:125]
    s_waitcnt lgkmcnt(6)
    v_mfma_f32_16x16x32_bf16 v[138:141], a[88:91], a[0:3], v[138:141]
    ds_read_b64_tr_b16 a[104:105], v21 offset:28800
    v_mfma_f32_16x16x32_bf16 v[142:145], a[88:91], a[4:7], v[142:145]
    ds_read_b64_tr_b16 a[106:107], v21 offset:32384
    s_add_u32 m0, s38, 61440
    v_mfma_f32_16x16x32_bf16 v[146:149], a[88:91], a[8:11], v[146:149]
    buffer_load_dwordx4 v11, s[72:75], s49 offen lds
    v_mfma_f32_16x16x32_bf16 v[150:153], a[88:91], a[12:15], v[150:153]
    s_waitcnt lgkmcnt(6)
    v_mfma_f32_16x16x32_bf16 v[166:169], a[92:95], a[12:15], v[166:169]
    ds_read_b64_tr_b16 a[108:109], v21 offset:28832
    v_mfma_f32_16x16x32_bf16 v[162:165], a[92:95], a[8:11], v[162:165]
    ds_read_b64_tr_b16 a[110:111], v21 offset:32416
    v_mfma_f32_16x16x32_bf16 v[158:161], a[92:95], a[4:7], v[158:161]
    buffer_load_dwordx4 a[48:51], v15, s[16:19], s50 offen offset:3072 sc1
    v_mfma_f32_16x16x32_bf16 v[154:157], a[92:95], a[0:3], v[154:157]
    s_waitcnt lgkmcnt(6)
    v_mfma_f32_16x16x32_bf16 v[170:173], a[96:99], a[0:3], v[170:173]
    ds_read_b64_tr_b16 a[112:113], v21 offset:28864
    v_mfma_f32_16x16x32_bf16 v[174:177], a[96:99], a[4:7], v[174:177]
    ds_read_b64_tr_b16 a[114:115], v21 offset:32448
    v_mfma_f32_16x16x32_bf16 v[178:181], a[96:99], a[8:11], v[178:181]
    buffer_load_dwordx4 a[52:55], v16, s[16:19], s50 offen offset:3072 sc1
    v_mfma_f32_16x16x32_bf16 v[182:185], a[96:99], a[12:15], v[182:185]
    s_waitcnt lgkmcnt(6)
    v_mfma_f32_16x16x32_bf16 v[198:201], a[100:103], a[12:15], v[198:201]
    ds_read_b64_tr_b16 a[64:65], v19 offset:30720
    v_mfma_f32_16x16x32_bf16 v[194:197], a[100:103], a[8:11], v[194:197]
    ds_read_b64_tr_b16 a[66:67], v19 offset:33792
    v_mfma_f32_16x16x32_bf16 v[190:193], a[100:103], a[4:7], v[190:193]
    buffer_load_dwordx4 a[56:59], v17, s[16:19], s50 offen offset:3072 sc1
    v_mfma_f32_16x16x32_bf16 v[186:189], a[100:103], a[0:3], v[186:189]
    s_waitcnt lgkmcnt(6)
    v_mfma_f32_16x16x32_bf16 v[202:205], a[104:107], a[0:3], v[202:205]
    ds_read_b64_tr_b16 a[68:69], v20 offset:30752
    v_mfma_f32_16x16x32_bf16 v[206:209], a[104:107], a[4:7], v[206:209]
    ds_read_b64_tr_b16 a[70:71], v20 offset:33824
    v_mfma_f32_16x16x32_bf16 v[210:213], a[104:107], a[8:11], v[210:213]
    buffer_load_dwordx4 a[60:63], v18, s[16:19], s50 offen offset:3072 sc1
    v_mfma_f32_16x16x32_bf16 v[214:217], a[104:107], a[12:15], v[214:217]
    s_waitcnt lgkmcnt(6)
    v_mfma_f32_16x16x32_bf16 v[230:233], a[108:111], a[12:15], v[230:233]
    ds_read_b64_tr_b16 a[72:73], v19 offset:30784
    v_mfma_f32_16x16x32_bf16 v[226:229], a[108:111], a[8:11], v[226:229]
    ds_read_b64_tr_b16 a[74:75], v19 offset:33856
    v_mfma_f32_16x16x32_bf16 v[222:225], a[108:111], a[4:7], v[222:225]
    buffer_load_dword a120, v22, s[68:71], s90 offen
    v_mfma_f32_16x16x32_bf16 v[218:221], a[108:111], a[0:3], v[218:221]
    s_waitcnt lgkmcnt(6)
    v_mfma_f32_16x16x32_bf16 v[234:237], a[112:115], a[0:3], v[234:237]
    ds_read_b64_tr_b16 a[76:77], v20 offset:30816
    v_mfma_f32_16x16x32_bf16 v[238:241], a[112:115], a[4:7], v[238:241]
    ds_read_b64_tr_b16 a[78:79], v20 offset:33888
    v_mfma_f32_16x16x32_bf16 v[242:245], a[112:115], a[8:11], v[242:245]
    buffer_load_dword a121, v23, s[72:75], s91 offen
    v_mfma_f32_16x16x32_bf16 v[246:249], a[112:115], a[12:15], v[246:249]
    s_waitcnt lgkmcnt(6)
    s_waitcnt vmcnt(18)
    v_mfma_f32_16x16x32_bf16 v[42:45], a[64:67], a[16:19], v[42:45]
    ds_read_b64_tr_b16 a[80:81], v19 offset:30848
    s_add_u32 s50, s50, 4096
    v_mfma_f32_16x16x32_bf16 v[46:49], a[64:67], a[20:23], v[46:49]
    ds_read_b64_tr_b16 a[82:83], v19 offset:33920
    v_mfma_f32_16x16x32_bf16 v[50:53], a[64:67], a[24:27], v[50:53]
    buffer_load_dwordx4 a[0:3], v15, s[16:19], s50 offen offset:0 sc1
    v_mfma_f32_16x16x32_bf16 v[54:57], a[64:67], a[28:31], v[54:57]
    s_waitcnt lgkmcnt(6)
    v_mfma_f32_16x16x32_bf16 v[70:73], a[68:71], a[28:31], v[70:73]
    ds_read_b64_tr_b16 a[84:85], v20 offset:30880
    v_mfma_f32_16x16x32_bf16 v[66:69], a[68:71], a[24:27], v[66:69]
    ds_read_b64_tr_b16 a[86:87], v20 offset:33952
    v_mfma_f32_16x16x32_bf16 v[62:65], a[68:71], a[20:23], v[62:65]
    buffer_load_dwordx4 a[4:7], v16, s[16:19], s50 offen offset:0 sc1
    v_mfma_f32_16x16x32_bf16 v[58:61], a[68:71], a[16:19], v[58:61]
    s_add_u32 s90, s90, 786432
    s_waitcnt lgkmcnt(6)
    v_mfma_f32_16x16x32_bf16 v[74:77], a[72:75], a[16:19], v[74:77]
    ds_read_b64_tr_b16 a[88:89], v21 offset:35840
    v_mfma_f32_16x16x32_bf16 v[78:81], a[72:75], a[20:23], v[78:81]
    ds_read_b64_tr_b16 a[90:91], v21 offset:39424
    v_mfma_f32_16x16x32_bf16 v[82:85], a[72:75], a[24:27], v[82:85]
    buffer_load_dwordx4 a[8:11], v17, s[16:19], s50 offen offset:0 sc1
    v_mfma_f32_16x16x32_bf16 v[86:89], a[72:75], a[28:31], v[86:89]
    s_add_u32 s91, s91, 917504
    s_waitcnt lgkmcnt(6)
    v_mfma_f32_16x16x32_bf16 v[102:105], a[76:79], a[28:31], v[102:105]
    ds_read_b64_tr_b16 a[92:93], v21 offset:35872
    v_mfma_f32_16x16x32_bf16 v[98:101], a[76:79], a[24:27], v[98:101]
    ds_read_b64_tr_b16 a[94:95], v21 offset:39456
    v_mfma_f32_16x16x32_bf16 v[94:97], a[76:79], a[20:23], v[94:97]
    buffer_load_dwordx4 a[12:15], v18, s[16:19], s50 offen offset:0 sc1
    v_mfma_f32_16x16x32_bf16 v[90:93], a[76:79], a[16:19], v[90:93]
    s_waitcnt lgkmcnt(6)
    v_mfma_f32_16x16x32_bf16 v[106:109], a[80:83], a[16:19], v[106:109]
    ds_read_b64_tr_b16 a[96:97], v21 offset:35904
    v_mfma_f32_16x16x32_bf16 v[110:113], a[80:83], a[20:23], v[110:113]
    ds_read_b64_tr_b16 a[98:99], v21 offset:39488
    v_mfma_f32_16x16x32_bf16 v[114:117], a[80:83], a[24:27], v[114:117]
    v_mfma_f32_16x16x32_bf16 v[118:121], a[80:83], a[28:31], v[118:121]
    s_waitcnt lgkmcnt(6)
    v_mfma_f32_16x16x32_bf16 v[134:137], a[84:87], a[28:31], v[134:137]
    ds_read_b64_tr_b16 a[100:101], v21 offset:35936
    v_mfma_f32_16x16x32_bf16 v[130:133], a[84:87], a[24:27], v[130:133]
    ds_read_b64_tr_b16 a[102:103], v21 offset:39520
    v_mfma_f32_16x16x32_bf16 v[126:129], a[84:87], a[20:23], v[126:129]
    v_mfma_f32_16x16x32_bf16 v[122:125], a[84:87], a[16:19], v[122:125]
    s_waitcnt lgkmcnt(6)
    v_mfma_f32_16x16x32_bf16 v[138:141], a[88:91], a[16:19], v[138:141]
    ds_read_b64_tr_b16 a[104:105], v21 offset:35968
    v_mfma_f32_16x16x32_bf16 v[142:145], a[88:91], a[20:23], v[142:145]
    ds_read_b64_tr_b16 a[106:107], v21 offset:39552
    v_mfma_f32_16x16x32_bf16 v[146:149], a[88:91], a[24:27], v[146:149]
    v_mfma_f32_16x16x32_bf16 v[150:153], a[88:91], a[28:31], v[150:153]
    s_waitcnt lgkmcnt(6)
    v_mfma_f32_16x16x32_bf16 v[166:169], a[92:95], a[28:31], v[166:169]
    ds_read_b64_tr_b16 a[108:109], v21 offset:36000
    v_mfma_f32_16x16x32_bf16 v[162:165], a[92:95], a[24:27], v[162:165]
    ds_read_b64_tr_b16 a[110:111], v21 offset:39584
    v_mfma_f32_16x16x32_bf16 v[158:161], a[92:95], a[20:23], v[158:161]
    v_mfma_f32_16x16x32_bf16 v[154:157], a[92:95], a[16:19], v[154:157]
    s_waitcnt lgkmcnt(6)
    v_mfma_f32_16x16x32_bf16 v[170:173], a[96:99], a[16:19], v[170:173]
    ds_read_b64_tr_b16 a[112:113], v21 offset:36032
    v_mfma_f32_16x16x32_bf16 v[174:177], a[96:99], a[20:23], v[174:177]
    ds_read_b64_tr_b16 a[114:115], v21 offset:39616
    v_mfma_f32_16x16x32_bf16 v[178:181], a[96:99], a[24:27], v[178:181]
    v_mfma_f32_16x16x32_bf16 v[182:185], a[96:99], a[28:31], v[182:185]
    s_barrier
    s_waitcnt lgkmcnt(6)
    v_mfma_f32_16x16x32_bf16 v[198:201], a[100:103], a[28:31], v[198:201]
    ds_read_b64_tr_b16 a[64:65], v19 offset:36864
    v_mfma_f32_16x16x32_bf16 v[194:197], a[100:103], a[24:27], v[194:197]
    ds_read_b64_tr_b16 a[66:67], v19 offset:39936
    v_mfma_f32_16x16x32_bf16 v[190:193], a[100:103], a[20:23], v[190:193]
    v_mfma_f32_16x16x32_bf16 v[186:189], a[100:103], a[16:19], v[186:189]
    s_waitcnt lgkmcnt(6)
    v_mfma_f32_16x16x32_bf16 v[202:205], a[104:107], a[16:19], v[202:205]
    ds_read_b64_tr_b16 a[68:69], v20 offset:36896
    v_mfma_f32_16x16x32_bf16 v[206:209], a[104:107], a[20:23], v[206:209]
    ds_read_b64_tr_b16 a[70:71], v20 offset:39968
    v_mfma_f32_16x16x32_bf16 v[210:213], a[104:107], a[24:27], v[210:213]
    v_mfma_f32_16x16x32_bf16 v[214:217], a[104:107], a[28:31], v[214:217]
    s_waitcnt lgkmcnt(6)
    v_mfma_f32_16x16x32_bf16 v[230:233], a[108:111], a[28:31], v[230:233]
    ds_read_b64_tr_b16 a[72:73], v19 offset:36928
    v_mfma_f32_16x16x32_bf16 v[226:229], a[108:111], a[24:27], v[226:229]
    ds_read_b64_tr_b16 a[74:75], v19 offset:40000
    v_mfma_f32_16x16x32_bf16 v[222:225], a[108:111], a[20:23], v[222:225]
    v_mfma_f32_16x16x32_bf16 v[218:221], a[108:111], a[16:19], v[218:221]
    s_waitcnt lgkmcnt(6)
    v_mfma_f32_16x16x32_bf16 v[234:237], a[112:115], a[16:19], v[234:237]
    ds_read_b64_tr_b16 a[76:77], v20 offset:36960
    v_mfma_f32_16x16x32_bf16 v[238:241], a[112:115], a[20:23], v[238:241]
    ds_read_b64_tr_b16 a[78:79], v20 offset:40032
    v_mfma_f32_16x16x32_bf16 v[242:245], a[112:115], a[24:27], v[242:245]
    v_mfma_f32_16x16x32_bf16 v[246:249], a[112:115], a[28:31], v[246:249]
    s_waitcnt lgkmcnt(6)
    s_waitcnt vmcnt(18)
    v_mfma_f32_16x16x32_bf16 v[42:45], a[64:67], a[32:35], v[42:45]
    ds_read_b64_tr_b16 a[80:81], v19 offset:36992
    v_mfma_f32_16x16x32_bf16 v[46:49], a[64:67], a[36:39], v[46:49]
    ds_read_b64_tr_b16 a[82:83], v19 offset:40064
    s_add_u32 m0, s38, 12288
    v_mfma_f32_16x16x32_bf16 v[50:53], a[64:67], a[40:43], v[50:53]
    buffer_load_dwordx4 v5, s[68:71], s48 offen lds
    v_mfma_f32_16x16x32_bf16 v[54:57], a[64:67], a[44:47], v[54:57]
    s_waitcnt lgkmcnt(6)
    v_mfma_f32_16x16x32_bf16 v[70:73], a[68:71], a[44:47], v[70:73]
    ds_read_b64_tr_b16 a[84:85], v20 offset:37024
    v_mfma_f32_16x16x32_bf16 v[66:69], a[68:71], a[40:43], v[66:69]
    ds_read_b64_tr_b16 a[86:87], v20 offset:40096
    s_add_u32 m0, s38, 65536
    v_mfma_f32_16x16x32_bf16 v[62:65], a[68:71], a[36:39], v[62:65]
    buffer_load_dwordx4 v12, s[72:75], s49 offen lds
    v_mfma_f32_16x16x32_bf16 v[58:61], a[68:71], a[32:35], v[58:61]
    s_waitcnt lgkmcnt(6)
    v_mfma_f32_16x16x32_bf16 v[74:77], a[72:75], a[32:35], v[74:77]
    ds_read_b64_tr_b16 a[88:89], v21 offset:43008
    v_mfma_f32_16x16x32_bf16 v[78:81], a[72:75], a[36:39], v[78:81]
    ds_read_b64_tr_b16 a[90:91], v21 offset:46592
    s_add_u32 m0, s38, 16384
    v_mfma_f32_16x16x32_bf16 v[82:85], a[72:75], a[40:43], v[82:85]
    buffer_load_dwordx4 v6, s[68:71], s48 offen lds
    v_mfma_f32_16x16x32_bf16 v[86:89], a[72:75], a[44:47], v[86:89]
    s_waitcnt lgkmcnt(6)
    v_mfma_f32_16x16x32_bf16 v[102:105], a[76:79], a[44:47], v[102:105]
    ds_read_b64_tr_b16 a[92:93], v21 offset:43040
    v_mfma_f32_16x16x32_bf16 v[98:101], a[76:79], a[40:43], v[98:101]
    ds_read_b64_tr_b16 a[94:95], v21 offset:46624
    s_add_u32 m0, s38, 69632
    v_mfma_f32_16x16x32_bf16 v[94:97], a[76:79], a[36:39], v[94:97]
    buffer_load_dwordx4 v13, s[72:75], s49 offen lds
    v_mfma_f32_16x16x32_bf16 v[90:93], a[76:79], a[32:35], v[90:93]
    s_waitcnt lgkmcnt(6)
    v_mfma_f32_16x16x32_bf16 v[106:109], a[80:83], a[32:35], v[106:109]
    ds_read_b64_tr_b16 a[96:97], v21 offset:43072
    v_mfma_f32_16x16x32_bf16 v[110:113], a[80:83], a[36:39], v[110:113]
    ds_read_b64_tr_b16 a[98:99], v21 offset:46656
    s_add_u32 m0, s38, 20480
    v_mfma_f32_16x16x32_bf16 v[114:117], a[80:83], a[40:43], v[114:117]
    buffer_load_dwordx4 v7, s[68:71], s48 offen lds
    v_mfma_f32_16x16x32_bf16 v[118:121], a[80:83], a[44:47], v[118:121]
    s_waitcnt lgkmcnt(6)
    v_mfma_f32_16x16x32_bf16 v[134:137], a[84:87], a[44:47], v[134:137]
    ds_read_b64_tr_b16 a[100:101], v21 offset:43104
    v_mfma_f32_16x16x32_bf16 v[130:133], a[84:87], a[40:43], v[130:133]
    ds_read_b64_tr_b16 a[102:103], v21 offset:46688
    s_add_u32 m0, s38, 73728
    v_mfma_f32_16x16x32_bf16 v[126:129], a[84:87], a[36:39], v[126:129]
    buffer_load_dwordx4 v14, s[72:75], s49 offen lds
    v_mfma_f32_16x16x32_bf16 v[122:125], a[84:87], a[32:35], v[122:125]
    s_waitcnt lgkmcnt(6)
    v_mfma_f32_16x16x32_bf16 v[138:141], a[88:91], a[32:35], v[138:141]
    ds_read_b64_tr_b16 a[104:105], v21 offset:43136
    v_mfma_f32_16x16x32_bf16 v[142:145], a[88:91], a[36:39], v[142:145]
    ds_read_b64_tr_b16 a[106:107], v21 offset:46720
    v_mfma_f32_16x16x32_bf16 v[146:149], a[88:91], a[40:43], v[146:149]
    buffer_load_dwordx4 a[16:19], v15, s[16:19], s50 offen offset:1024 sc1
    v_mfma_f32_16x16x32_bf16 v[150:153], a[88:91], a[44:47], v[150:153]
    s_waitcnt lgkmcnt(6)
    v_mfma_f32_16x16x32_bf16 v[166:169], a[92:95], a[44:47], v[166:169]
    ds_read_b64_tr_b16 a[108:109], v21 offset:43168
    v_mfma_f32_16x16x32_bf16 v[162:165], a[92:95], a[40:43], v[162:165]
    ds_read_b64_tr_b16 a[110:111], v21 offset:46752
    v_mfma_f32_16x16x32_bf16 v[158:161], a[92:95], a[36:39], v[158:161]
    buffer_load_dwordx4 a[20:23], v16, s[16:19], s50 offen offset:1024 sc1
    v_mfma_f32_16x16x32_bf16 v[154:157], a[92:95], a[32:35], v[154:157]
    s_waitcnt lgkmcnt(6)
    v_mfma_f32_16x16x32_bf16 v[170:173], a[96:99], a[32:35], v[170:173]
    ds_read_b64_tr_b16 a[112:113], v21 offset:43200
    v_mfma_f32_16x16x32_bf16 v[174:177], a[96:99], a[36:39], v[174:177]
    ds_read_b64_tr_b16 a[114:115], v21 offset:46784
    v_mfma_f32_16x16x32_bf16 v[178:181], a[96:99], a[40:43], v[178:181]
    buffer_load_dwordx4 a[24:27], v17, s[16:19], s50 offen offset:1024 sc1
    v_mfma_f32_16x16x32_bf16 v[182:185], a[96:99], a[44:47], v[182:185]
    s_waitcnt lgkmcnt(6)
    v_mfma_f32_16x16x32_bf16 v[198:201], a[100:103], a[44:47], v[198:201]
    ds_read_b64_tr_b16 a[64:65], v19 offset:43008
    v_mfma_f32_16x16x32_bf16 v[194:197], a[100:103], a[40:43], v[194:197]
    ds_read_b64_tr_b16 a[66:67], v19 offset:46080
    v_mfma_f32_16x16x32_bf16 v[190:193], a[100:103], a[36:39], v[190:193]
    buffer_load_dwordx4 a[28:31], v18, s[16:19], s50 offen offset:1024 sc1
    v_mfma_f32_16x16x32_bf16 v[186:189], a[100:103], a[32:35], v[186:189]
    s_waitcnt lgkmcnt(6)
    v_mfma_f32_16x16x32_bf16 v[202:205], a[104:107], a[32:35], v[202:205]
    ds_read_b64_tr_b16 a[68:69], v20 offset:43040
    v_mfma_f32_16x16x32_bf16 v[206:209], a[104:107], a[36:39], v[206:209]
    ds_read_b64_tr_b16 a[70:71], v20 offset:46112
    v_mfma_f32_16x16x32_bf16 v[210:213], a[104:107], a[40:43], v[210:213]
    v_mfma_f32_16x16x32_bf16 v[214:217], a[104:107], a[44:47], v[214:217]
    s_waitcnt lgkmcnt(6)
    v_mfma_f32_16x16x32_bf16 v[230:233], a[108:111], a[44:47], v[230:233]
    ds_read_b64_tr_b16 a[72:73], v19 offset:43072
    v_mfma_f32_16x16x32_bf16 v[226:229], a[108:111], a[40:43], v[226:229]
    ds_read_b64_tr_b16 a[74:75], v19 offset:46144
    v_mfma_f32_16x16x32_bf16 v[222:225], a[108:111], a[36:39], v[222:225]
    v_mfma_f32_16x16x32_bf16 v[218:221], a[108:111], a[32:35], v[218:221]
    s_add_u32 s48, s48, 786432
    s_waitcnt lgkmcnt(6)
    v_mfma_f32_16x16x32_bf16 v[234:237], a[112:115], a[32:35], v[234:237]
    ds_read_b64_tr_b16 a[76:77], v20 offset:43104
    v_mfma_f32_16x16x32_bf16 v[238:241], a[112:115], a[36:39], v[238:241]
    ds_read_b64_tr_b16 a[78:79], v20 offset:46176
    v_mfma_f32_16x16x32_bf16 v[242:245], a[112:115], a[40:43], v[242:245]
    v_mfma_f32_16x16x32_bf16 v[246:249], a[112:115], a[44:47], v[246:249]
    s_add_u32 s49, s49, 917504
    s_waitcnt lgkmcnt(6)
    s_waitcnt vmcnt(16)
    v_mfma_f32_16x16x32_bf16 v[42:45], a[64:67], a[48:51], v[42:45]
    ds_read_b64_tr_b16 a[80:81], v19 offset:43136
    v_mfma_f32_16x16x32_bf16 v[46:49], a[64:67], a[52:55], v[46:49]
    ds_read_b64_tr_b16 a[82:83], v19 offset:46208
    v_mfma_f32_16x16x32_bf16 v[50:53], a[64:67], a[56:59], v[50:53]
    buffer_load_dwordx4 a[32:35], v15, s[16:19], s50 offen offset:2048 sc1
    v_mfma_f32_16x16x32_bf16 v[54:57], a[64:67], a[60:63], v[54:57]
    s_waitcnt lgkmcnt(6)
    v_mfma_f32_16x16x32_bf16 v[70:73], a[68:71], a[60:63], v[70:73]
    ds_read_b64_tr_b16 a[84:85], v20 offset:43168
    v_mfma_f32_16x16x32_bf16 v[66:69], a[68:71], a[56:59], v[66:69]
    ds_read_b64_tr_b16 a[86:87], v20 offset:46240
    v_mfma_f32_16x16x32_bf16 v[62:65], a[68:71], a[52:55], v[62:65]
    buffer_load_dwordx4 a[36:39], v16, s[16:19], s50 offen offset:2048 sc1
    v_mfma_f32_16x16x32_bf16 v[58:61], a[68:71], a[48:51], v[58:61]
    s_waitcnt lgkmcnt(6)
    v_mfma_f32_16x16x32_bf16 v[74:77], a[72:75], a[48:51], v[74:77]
    ds_read_b64_tr_b16 a[88:89], v21 offset:50176
    v_mfma_f32_16x16x32_bf16 v[78:81], a[72:75], a[52:55], v[78:81]
    ds_read_b64_tr_b16 a[90:91], v21 offset:53760
    v_mfma_f32_16x16x32_bf16 v[82:85], a[72:75], a[56:59], v[82:85]
    buffer_load_dwordx4 a[40:43], v17, s[16:19], s50 offen offset:2048 sc1
    v_mfma_f32_16x16x32_bf16 v[86:89], a[72:75], a[60:63], v[86:89]
    s_waitcnt lgkmcnt(6)
    v_mfma_f32_16x16x32_bf16 v[102:105], a[76:79], a[60:63], v[102:105]
    ds_read_b64_tr_b16 a[92:93], v21 offset:50208
    v_mfma_f32_16x16x32_bf16 v[98:101], a[76:79], a[56:59], v[98:101]
    ds_read_b64_tr_b16 a[94:95], v21 offset:53792
    v_mfma_f32_16x16x32_bf16 v[94:97], a[76:79], a[52:55], v[94:97]
    buffer_load_dwordx4 a[44:47], v18, s[16:19], s50 offen offset:2048 sc1
    v_mfma_f32_16x16x32_bf16 v[90:93], a[76:79], a[48:51], v[90:93]
    s_waitcnt lgkmcnt(6)
    v_mfma_f32_16x16x32_bf16 v[106:109], a[80:83], a[48:51], v[106:109]
    ds_read_b64_tr_b16 a[96:97], v21 offset:50240
    v_mfma_f32_16x16x32_bf16 v[110:113], a[80:83], a[52:55], v[110:113]
    ds_read_b64_tr_b16 a[98:99], v21 offset:53824
    v_mfma_f32_16x16x32_bf16 v[114:117], a[80:83], a[56:59], v[114:117]
    v_mfma_f32_16x16x32_bf16 v[118:121], a[80:83], a[60:63], v[118:121]
    s_waitcnt lgkmcnt(6)
    v_mfma_f32_16x16x32_bf16 v[134:137], a[84:87], a[60:63], v[134:137]
    ds_read_b64_tr_b16 a[100:101], v21 offset:50272
    v_mfma_f32_16x16x32_bf16 v[130:133], a[84:87], a[56:59], v[130:133]
    ds_read_b64_tr_b16 a[102:103], v21 offset:53856
    v_mfma_f32_16x16x32_bf16 v[126:129], a[84:87], a[52:55], v[126:129]
    v_mfma_f32_16x16x32_bf16 v[122:125], a[84:87], a[48:51], v[122:125]
    s_waitcnt lgkmcnt(6)
    v_mfma_f32_16x16x32_bf16 v[138:141], a[88:91], a[48:51], v[138:141]
    ds_read_b64_tr_b16 a[104:105], v21 offset:50304
    v_mfma_f32_16x16x32_bf16 v[142:145], a[88:91], a[52:55], v[142:145]
    ds_read_b64_tr_b16 a[106:107], v21 offset:53888
    v_mfma_f32_16x16x32_bf16 v[146:149], a[88:91], a[56:59], v[146:149]
    v_mfma_f32_16x16x32_bf16 v[150:153], a[88:91], a[60:63], v[150:153]
    s_waitcnt lgkmcnt(6)
    v_mfma_f32_16x16x32_bf16 v[166:169], a[92:95], a[60:63], v[166:169]
    ds_read_b64_tr_b16 a[108:109], v21 offset:50336
    v_mfma_f32_16x16x32_bf16 v[162:165], a[92:95], a[56:59], v[162:165]
    ds_read_b64_tr_b16 a[110:111], v21 offset:53920
    v_mfma_f32_16x16x32_bf16 v[158:161], a[92:95], a[52:55], v[158:161]
    v_mfma_f32_16x16x32_bf16 v[154:157], a[92:95], a[48:51], v[154:157]
    s_waitcnt lgkmcnt(6)
    v_mfma_f32_16x16x32_bf16 v[170:173], a[96:99], a[48:51], v[170:173]
    ds_read_b64_tr_b16 a[112:113], v21 offset:50368
    v_mfma_f32_16x16x32_bf16 v[174:177], a[96:99], a[52:55], v[174:177]
    ds_read_b64_tr_b16 a[114:115], v21 offset:53952
    v_mfma_f32_16x16x32_bf16 v[178:181], a[96:99], a[56:59], v[178:181]
    v_mfma_f32_16x16x32_bf16 v[182:185], a[96:99], a[60:63], v[182:185]
    s_barrier
    s_waitcnt lgkmcnt(6)
    v_mfma_f32_16x16x32_bf16 v[198:201], a[100:103], a[60:63], v[198:201]
    ds_read_b64_tr_b16 a[64:65], v19 offset:0
    v_mfma_f32_16x16x32_bf16 v[194:197], a[100:103], a[56:59], v[194:197]
    ds_read_b64_tr_b16 a[66:67], v19 offset:3072
    v_mfma_f32_16x16x32_bf16 v[190:193], a[100:103], a[52:55], v[190:193]
    v_mfma_f32_16x16x32_bf16 v[186:189], a[100:103], a[48:51], v[186:189]
    s_waitcnt lgkmcnt(6)
    v_mfma_f32_16x16x32_bf16 v[202:205], a[104:107], a[48:51], v[202:205]
    ds_read_b64_tr_b16 a[68:69], v20 offset:32
    v_mfma_f32_16x16x32_bf16 v[206:209], a[104:107], a[52:55], v[206:209]
    ds_read_b64_tr_b16 a[70:71], v20 offset:3104
    v_mfma_f32_16x16x32_bf16 v[210:213], a[104:107], a[56:59], v[210:213]
    v_mfma_f32_16x16x32_bf16 v[214:217], a[104:107], a[60:63], v[214:217]
    s_waitcnt lgkmcnt(6)
    v_mfma_f32_16x16x32_bf16 v[230:233], a[108:111], a[60:63], v[230:233]
    ds_read_b64_tr_b16 a[72:73], v19 offset:64
    v_mfma_f32_16x16x32_bf16 v[226:229], a[108:111], a[56:59], v[226:229]
    ds_read_b64_tr_b16 a[74:75], v19 offset:3136
    v_mfma_f32_16x16x32_bf16 v[222:225], a[108:111], a[52:55], v[222:225]
    v_mfma_f32_16x16x32_bf16 v[218:221], a[108:111], a[48:51], v[218:221]
    s_waitcnt lgkmcnt(6)
    v_mfma_f32_16x16x32_bf16 v[234:237], a[112:115], a[48:51], v[234:237]
    ds_read_b64_tr_b16 a[76:77], v20 offset:96
    v_mfma_f32_16x16x32_bf16 v[238:241], a[112:115], a[52:55], v[238:241]
    ds_read_b64_tr_b16 a[78:79], v20 offset:3168
    v_mfma_f32_16x16x32_bf16 v[242:245], a[112:115], a[56:59], v[242:245]
    v_mfma_f32_16x16x32_bf16 v[246:249], a[112:115], a[60:63], v[246:249]
    s_add_u32 s45, s45, 1
    s_cmp_lg_u32 s45, 3
    s_cbranch_scc1 L_g1_loop
    s_add_u32 s51, s50, 4096
    s_waitcnt lgkmcnt(6)
    s_waitcnt vmcnt(14)
    v_mfma_f32_16x16x32_bf16 v[42:45], a[64:67], a[0:3], v[42:45]
    ds_read_b64_tr_b16 a[80:81], v19 offset:128
    v_mfma_f32_16x16x32_bf16 v[46:49], a[64:67], a[4:7], v[46:49]
    ds_read_b64_tr_b16 a[82:83], v19 offset:3200
    v_mfma_f32_16x16x32_bf16 v[50:53], a[64:67], a[8:11], v[50:53]
    buffer_load_dwordx4 a[48:51], v15, s[16:19], s50 offen offset:3072 sc1
    v_mfma_f32_16x16x32_bf16 v[54:57], a[64:67], a[12:15], v[54:57]
    s_waitcnt lgkmcnt(6)
    v_mfma_f32_16x16x32_bf16 v[70:73], a[68:71], a[12:15], v[70:73]
    ds_read_b64_tr_b16 a[84:85], v20 offset:160
    v_mfma_f32_16x16x32_bf16 v[66:69], a[68:71], a[8:11], v[66:69]
    ds_read_b64_tr_b16 a[86:87], v20 offset:3232
    v_mfma_f32_16x16x32_bf16 v[62:65], a[68:71], a[4:7], v[62:65]
    buffer_load_dwordx4 a[52:55], v16, s[16:19], s50 offen offset:3072 sc1
    v_mfma_f32_16x16x32_bf16 v[58:61], a[68:71], a[0:3], v[58:61]
    s_waitcnt lgkmcnt(6)
    v_mfma_f32_16x16x32_bf16 v[74:77], a[72:75], a[0:3], v[74:77]
    ds_read_b64_tr_b16 a[64:65], v19 offset:6144
    v_mfma_f32_16x16x32_bf16 v[78:81], a[72:75], a[4:7], v[78:81]
    ds_read_b64_tr_b16 a[66:67], v19 offset:9216
    v_mfma_f32_16x16x32_bf16 v[82:85], a[72:75], a[8:11], v[82:85]
    buffer_load_dwordx4 a[56:59], v17, s[16:19], s50 offen offset:3072 sc1
    v_mfma_f32_16x16x32_bf16 v[86:89], a[72:75], a[12:15], v[86:89]
    s_waitcnt lgkmcnt(6)
    v_mfma_f32_16x16x32_bf16 v[102:105], a[76:79], a[12:15], v[102:105]
    ds_read_b64_tr_b16 a[68:69], v20 offset:6176
    v_mfma_f32_16x16x32_bf16 v[98:101], a[76:79], a[8:11], v[98:101]
    ds_read_b64_tr_b16 a[70:71], v20 offset:9248
    v_mfma_f32_16x16x32_bf16 v[94:97], a[76:79], a[4:7], v[94:97]
    buffer_load_dwordx4 a[60:63], v18, s[16:19], s50 offen offset:3072 sc1
    v_mfma_f32_16x16x32_bf16 v[90:93], a[76:79], a[0:3], v[90:93]
    s_waitcnt lgkmcnt(6)
    v_mfma_f32_16x16x32_bf16 v[106:109], a[80:83], a[0:3], v[106:109]
    ds_read_b64_tr_b16 a[72:73], v19 offset:6208
    v_mfma_f32_16x16x32_bf16 v[110:113], a[80:83], a[4:7], v[110:113]
    ds_read_b64_tr_b16 a[74:75], v19 offset:9280
    s_add_u32 m0, s38, 24576
    v_mfma_f32_16x16x32_bf16 v[114:117], a[80:83], a[8:11], v[114:117]
    buffer_load_dwordx4 v2, s[68:71], s48 offen lds
    v_mfma_f32_16x16x32_bf16 v[118:121], a[80:83], a[12:15], v[118:121]
    s_waitcnt lgkmcnt(6)
    v_mfma_f32_16x16x32_bf16 v[134:137], a[84:87], a[12:15], v[134:137]
    ds_read_b64_tr_b16 a[76:77], v20 offset:6240
    v_mfma_f32_16x16x32_bf16 v[130:133], a[84:87], a[8:11], v[130:133]
    ds_read_b64_tr_b16 a[78:79], v20 offset:9312
    s_add_u32 m0, s38, 28672
    v_mfma_f32_16x16x32_bf16 v[126:129], a[84:87], a[4:7], v[126:129]
    buffer_load_dwordx4 v3, s[68:71], s48 offen lds
    v_mfma_f32_16x16x32_bf16 v[122:125], a[84:87], a[0:3], v[122:125]
    s_waitcnt lgkmcnt(6)
    s_waitcnt vmcnt(10)
    v_mfma_f32_16x16x32_bf16 v[42:45], a[64:67], a[16:19], v[42:45]
    ds_read_b64_tr_b16 a[80:81], v19 offset:6272
    v_mfma_f32_16x16x32_bf16 v[46:49], a[64:67], a[20:23], v[46:49]
    ds_read_b64_tr_b16 a[82:83], v19 offset:9344
    s_add_u32 m0, s38, 32768
    v_mfma_f32_16x16x32_bf16 v[50:53], a[64:67], a[24:27], v[50:53]
    buffer_load_dwordx4 v4, s[68:71], s48 offen lds
    v_mfma_f32_16x16x32_bf16 v[54:57], a[64:67], a[28:31], v[54:57]
    s_waitcnt lgkmcnt(6)
    v_mfma_f32_16x16x32_bf16 v[70:73], a[68:71], a[28:31], v[70:73]
    ds_read_b64_tr_b16 a[84:85], v20 offset:6304
    v_mfma_f32_16x16x32_bf16 v[66:69], a[68:71], a[24:27], v[66:69]
    ds_read_b64_tr_b16 a[86:87], v20 offset:9376
    v_mfma_f32_16x16x32_bf16 v[62:65], a[68:71], a[20:23], v[62:65]
    buffer_load_dwordx4 a[132:135], v15, s[16:19], s51 offen offset:0 sc1
    v_mfma_f32_16x16x32_bf16 v[58:61], a[68:71], a[16:19], v[58:61]
    s_barrier
    s_waitcnt lgkmcnt(6)
    v_mfma_f32_16x16x32_bf16 v[74:77], a[72:75], a[16:19], v[74:77]
    ds_read_b64_tr_b16 a[64:65], v19 offset:12288
    v_mfma_f32_16x16x32_bf16 v[78:81], a[72:75], a[20:23], v[78:81]
    ds_read_b64_tr_b16 a[66:67], v19 offset:15360
    v_mfma_f32_16x16x32_bf16 v[82:85], a[72:75], a[24:27], v[82:85]
    buffer_load_dwordx4 a[136:139], v16, s[16:19], s51 offen offset:0 sc1
    v_mfma_f32_16x16x32_bf16 v[86:89], a[72:75], a[28:31], v[86:89]
    s_waitcnt lgkmcnt(6)
    v_mfma_f32_16x16x32_bf16 v[102:105], a[76:79], a[28:31], v[102:105]
    ds_read_b64_tr_b16 a[68:69], v20 offset:12320
    v_mfma_f32_16x16x32_bf16 v[98:101], a[76:79], a[24:27], v[98:101]
    ds_read_b64_tr_b16 a[70:71], v20 offset:15392
    v_mfma_f32_16x16x32_bf16 v[94:97], a[76:79], a[20:23], v[94:97]
    buffer_load_dwordx4 a[140:143], v17, s[16:19], s51 offen offset:0 sc1
    v_mfma_f32_16x16x32_bf16 v[90:93], a[76:79], a[16:19], v[90:93]
    s_waitcnt lgkmcnt(6)
    v_mfma_f32_16x16x32_bf16 v[106:109], a[80:83], a[16:19], v[106:109]
    ds_read_b64_tr_b16 a[72:73], v19 offset:12352
    v_mfma_f32_16x16x32_bf16 v[110:113], a[80:83], a[20:23], v[110:113]
    ds_read_b64_tr_b16 a[74:75], v19 offset:15424
    v_mfma_f32_16x16x32_bf16 v[114:117], a[80:83], a[24:27], v[114:117]
    buffer_load_dwordx4 a[144:147], v18, s[16:19], s51 offen offset:0 sc1
    v_mfma_f32_16x16x32_bf16 v[118:121], a[80:83], a[28:31], v[118:121]
    s_waitcnt lgkmcnt(6)
    v_mfma_f32_16x16x32_bf16 v[134:137], a[84:87], a[28:31], v[134:137]
    ds_read_b64_tr_b16 a[76:77], v20 offset:12384
    v_mfma_f32_16x16x32_bf16 v[130:133], a[84:87], a[24:27], v[130:133]
    ds_read_b64_tr_b16 a[78:79], v20 offset:15456
    s_add_u32 m0, s38, 36864
    v_mfma_f32_16x16x32_bf16 v[126:129], a[84:87], a[20:23], v[126:129]
    buffer_load_dwordx4 v5, s[68:71], s48 offen lds
    v_mfma_f32_16x16x32_bf16 v[122:125], a[84:87], a[16:19], v[122:125]
    s_waitcnt lgkmcnt(6)
    s_waitcnt vmcnt(12)
    v_mfma_f32_16x16x32_bf16 v[42:45], a[64:67], a[32:35], v[42:45]
    ds_read_b64_tr_b16 a[80:81], v19 offset:12416
    v_mfma_f32_16x16x32_bf16 v[46:49], a[64:67], a[36:39], v[46:49]
    ds_read_b64_tr_b16 a[82:83], v19 offset:15488
    v_mfma_f32_16x16x32_bf16 v[50:53], a[64:67], a[40:43], v[50:53]
    buffer_load_dwordx4 a[148:151], v15, s[16:19], s51 offen offset:1024 sc1
    v_mfma_f32_16x16x32_bf16 v[54:57], a[64:67], a[44:47], v[54:57]
    s_waitcnt lgkmcnt(6)
    v_mfma_f32_16x16x32_bf16 v[70:73], a[68:71], a[44:47], v[70:73]
    ds_read_b64_tr_b16 a[84:85], v20 offset:12448
    v_mfma_f32_16x16x32_bf16 v[66:69], a[68:71], a[40:43], v[66:69]
    ds_read_b64_tr_b16 a[86:87], v20 offset:15520
    v_mfma_f32_16x16x32_bf16 v[62:65], a[68:71], a[36:39], v[62:65]
    buffer_load_dwordx4 a[152:155], v16, s[16:19], s51 offen offset:1024 sc1
    v_mfma_f32_16x16x32_bf16 v[58:61], a[68:71], a[32:35], v[58:61]
    s_waitcnt lgkmcnt(6)
    v_mfma_f32_16x16x32_bf16 v[74:77], a[72:75], a[32:35], v[74:77]
    ds_read_b64_tr_b16 a[64:65], v19 offset:18432
    v_mfma_f32_16x16x32_bf16 v[78:81], a[72:75], a[36:39], v[78:81]
    ds_read_b64_tr_b16 a[66:67], v19 offset:21504
    v_mfma_f32_16x16x32_bf16 v[82:85], a[72:75], a[40:43], v[82:85]
    buffer_load_dwordx4 a[156:159], v17, s[16:19], s51 offen offset:1024 sc1
    v_mfma_f32_16x16x32_bf16 v[86:89], a[72:75], a[44:47], v[86:89]
    s_waitcnt lgkmcnt(6)
    v_mfma_f32_16x16x32_bf16 v[102:105], a[76:79], a[44:47], v[102:105]
    ds_read_b64_tr_b16 a[68:69], v20 offset:18464
    v_mfma_f32_16x16x32_bf16 v[98:101], a[76:79], a[40:43], v[98:101]
    ds_read_b64_tr_b16 a[70:71], v20 offset:21536
    v_mfma_f32_16x16x32_bf16 v[94:97], a[76:79], a[36:39], v[94:97]
    buffer_load_dwordx4 a[160:163], v18, s[16:19], s51 offen offset:1024 sc1
    v_mfma_f32_16x16x32_bf16 v[90:93], a[76:79], a[32:35], v[90:93]
    s_waitcnt lgkmcnt(6)
    v_mfma_f32_16x16x32_bf16 v[106:109], a[80:83], a[32:35], v[106:109]
    ds_read_b64_tr_b16 a[72:73], v19 offset:18496
    v_mfma_f32_16x16x32_bf16 v[110:113], a[80:83], a[36:39], v[110:113]
    ds_read_b64_tr_b16 a[74:75], v19 offset:21568
    s_add_u32 m0, s38, 40960
    v_mfma_f32_16x16x32_bf16 v[114:117], a[80:83], a[40:43], v[114:117]
    buffer_load_dwordx4 v6, s[68:71], s48 offen lds
    v_mfma_f32_16x16x32_bf16 v[118:121], a[80:83], a[44:47], v[118:121]
    s_waitcnt lgkmcnt(6)
    v_mfma_f32_16x16x32_bf16 v[134:137], a[84:87], a[44:47], v[134:137]
    ds_read_b64_tr_b16 a[76:77], v20 offset:18528
    v_mfma_f32_16x16x32_bf16 v[130:133], a[84:87], a[40:43], v[130:133]
    ds_read_b64_tr_b16 a[78:79], v20 offset:21600
    s_add_u32 m0, s38, 45056
    v_mfma_f32_16x16x32_bf16 v[126:129], a[84:87], a[36:39], v[126:129]
    buffer_load_dwordx4 v7, s[68:71], s48 offen lds
    v_mfma_f32_16x16x32_bf16 v[122:125], a[84:87], a[32:35], v[122:125]
    s_waitcnt lgkmcnt(6)
    s_waitcnt vmcnt(14)
    v_mfma_f32_16x16x32_bf16 v[42:45], a[64:67], a[48:51], v[42:45]
    ds_read_b64_tr_b16 a[80:81], v19 offset:18560
    v_mfma_f32_16x16x32_bf16 v[46:49], a[64:67], a[52:55], v[46:49]
    ds_read_b64_tr_b16 a[82:83], v19 offset:21632
    v_mfma_f32_16x16x32_bf16 v[50:53], a[64:67], a[56:59], v[50:53]
    buffer_load_dwordx4 a[164:167], v15, s[16:19], s51 offen offset:2048 sc1
    v_mfma_f32_16x16x32_bf16 v[54:57], a[64:67], a[60:63], v[54:57]
    s_waitcnt lgkmcnt(6)
    v_mfma_f32_16x16x32_bf16 v[70:73], a[68:71], a[60:63], v[70:73]
    ds_read_b64_tr_b16 a[84:85], v20 offset:18592
    v_mfma_f32_16x16x32_bf16 v[66:69], a[68:71], a[56:59], v[66:69]
    ds_read_b64_tr_b16 a[86:87], v20 offset:21664
    v_mfma_f32_16x16x32_bf16 v[62:65], a[68:71], a[52:55], v[62:65]
    buffer_load_dwordx4 a[168:171], v16, s[16:19], s51 offen offset:2048 sc1
    v_mfma_f32_16x16x32_bf16 v[58:61], a[68:71], a[48:51], v[58:61]
    s_waitcnt vmcnt(13)
    s_barrier
    s_waitcnt lgkmcnt(6)
    v_mfma_f32_16x16x32_bf16 v[74:77], a[72:75], a[48:51], v[74:77]
    ds_read_b64_tr_b16 a[64:65], v19 offset:24576
    v_mfma_f32_16x16x32_bf16 v[78:81], a[72:75], a[52:55], v[78:81]
    ds_read_b64_tr_b16 a[66:67], v19 offset:27648
    v_mfma_f32_16x16x32_bf16 v[82:85], a[72:75], a[56:59], v[82:85]
    buffer_load_dwordx4 a[172:175], v17, s[16:19], s51 offen offset:2048 sc1
    v_mfma_f32_16x16x32_bf16 v[86:89], a[72:75], a[60:63], v[86:89]
    s_waitcnt lgkmcnt(6)
    v_mfma_f32_16x16x32_bf16 v[102:105], a[76:79], a[60:63], v[102:105]
    ds_read_b64_tr_b16 a[68:69], v20 offset:24608
    v_mfma_f32_16x16x32_bf16 v[98:101], a[76:79], a[56:59], v[98:101]
    ds_read_b64_tr_b16 a[70:71], v20 offset:27680
    v_mfma_f32_16x16x32_bf16 v[94:97], a[76:79], a[52:55], v[94:97]
    buffer_load_dwordx4 a[176:179], v18, s[16:19], s51 offen offset:2048 sc1
    v_mfma_f32_16x16x32_bf16 v[90:93], a[76:79], a[48:51], v[90:93]
    s_waitcnt lgkmcnt(6)
    v_mfma_f32_16x16x32_bf16 v[106:109], a[80:83], a[48:51], v[106:109]
    ds_read_b64_tr_b16 a[72:73], v19 offset:24640
    v_mfma_f32_16x16x32_bf16 v[110:113], a[80:83], a[52:55], v[110:113]
    ds_read_b64_tr_b16 a[74:75], v19 offset:27712
    v_mfma_f32_16x16x32_bf16 v[114:117], a[80:83], a[56:59], v[114:117]
    buffer_load_dwordx4 a[180:183], v15, s[16:19], s51 offen offset:3072 sc1
    v_mfma_f32_16x16x32_bf16 v[118:121], a[80:83], a[60:63], v[118:121]
    s_waitcnt lgkmcnt(6)
    v_mfma_f32_16x16x32_bf16 v[134:137], a[84:87], a[60:63], v[134:137]
    ds_read_b64_tr_b16 a[76:77], v20 offset:24672
    v_mfma_f32_16x16x32_bf16 v[130:133], a[84:87], a[56:59], v[130:133]
    ds_read_b64_tr_b16 a[78:79], v20 offset:27744
    v_mfma_f32_16x16x32_bf16 v[126:129], a[84:87], a[52:55], v[126:129]
    buffer_load_dwordx4 a[184:187], v16, s[16:19], s51 offen offset:3072 sc1
    v_mfma_f32_16x16x32_bf16 v[122:125], a[84:87], a[48:51], v[122:125]
    s_waitcnt lgkmcnt(6)
    s_waitcnt vmcnt(13)
    v_mfma_f32_16x16x32_bf16 v[42:45], a[64:67], a[132:135], v[42:45]
    ds_read_b64_tr_b16 a[80:81], v19 offset:24704
    v_mfma_f32_16x16x32_bf16 v[46:49], a[64:67], a[136:139], v[46:49]
    ds_read_b64_tr_b16 a[82:83], v19 offset:27776
    v_mfma_f32_16x16x32_bf16 v[50:53], a[64:67], a[140:143], v[50:53]
    buffer_load_dwordx4 a[188:191], v17, s[16:19], s51 offen offset:3072 sc1
    v_mfma_f32_16x16x32_bf16 v[54:57], a[64:67], a[144:147], v[54:57]
    s_waitcnt lgkmcnt(6)
    v_mfma_f32_16x16x32_bf16 v[70:73], a[68:71], a[144:147], v[70:73]
    ds_read_b64_tr_b16 a[84:85], v20 offset:24736
    v_mfma_f32_16x16x32_bf16 v[66:69], a[68:71], a[140:143], v[66:69]
    ds_read_b64_tr_b16 a[86:87], v20 offset:27808
    v_mfma_f32_16x16x32_bf16 v[62:65], a[68:71], a[136:139], v[62:65]
    buffer_load_dwordx4 a[192:195], v18, s[16:19], s51 offen offset:3072 sc1
    v_mfma_f32_16x16x32_bf16 v[58:61], a[68:71], a[132:135], v[58:61]
    s_waitcnt lgkmcnt(6)
    v_mfma_f32_16x16x32_bf16 v[74:77], a[72:75], a[132:135], v[74:77]
    ds_read_b64_tr_b16 a[64:65], v19 offset:30720
    v_mfma_f32_16x16x32_bf16 v[78:81], a[72:75], a[136:139], v[78:81]
    ds_read_b64_tr_b16 a[66:67], v19 offset:33792
    s_add_u32 m0, s38, 77824
    v_mfma_f32_16x16x32_bf16 v[82:85], a[72:75], a[140:143], v[82:85]
    buffer_load_dwordx4 v8, s[72:75], s49 offen lds
    v_mfma_f32_16x16x32_bf16 v[86:89], a[72:75], a[144:147], v[86:89]
    s_waitcnt lgkmcnt(6)
    v_mfma_f32_16x16x32_bf16 v[102:105], a[76:79], a[144:147], v[102:105]
    ds_read_b64_tr_b16 a[68:69], v20 offset:30752
    v_mfma_f32_16x16x32_bf16 v[98:101], a[76:79], a[140:143], v[98:101]
    ds_read_b64_tr_b16 a[70:71], v20 offset:33824
    s_add_u32 m0, s38, 81920
    v_mfma_f32_16x16x32_bf16 v[94:97], a[76:79], a[136:139], v[94:97]
    buffer_load_dwordx4 v9, s[72:75], s49 offen lds
    v_mfma_f32_16x16x32_bf16 v[90:93], a[76:79], a[132:135], v[90:93]
    s_waitcnt lgkmcnt(6)
    v_mfma_f32_16x16x32_bf16 v[106:109], a[80:83], a[132:135], v[106:109]
    ds_read_b64_tr_b16 a[72:73], v19 offset:30784
    v_mfma_f32_16x16x32_bf16 v[110:113], a[80:83], a[136:139], v[110:113]
    ds_read_b64_tr_b16 a[74:75], v19 offset:33856
    s_add_u32 m0, s38, 86016
    v_mfma_f32_16x16x32_bf16 v[114:117], a[80:83], a[140:143], v[114:117]
    buffer_load_dwordx4 v10, s[72:75], s49 offen lds
    v_mfma_f32_16x16x32_bf16 v[118:121], a[80:83], a[144:147], v[118:121]
    s_waitcnt lgkmcnt(6)
    v_mfma_f32_16x16x32_bf16 v[134:137], a[84:87], a[144:147], v[134:137]
    ds_read_b64_tr_b16 a[76:77], v20 offset:30816
    v_mfma_f32_16x16x32_bf16 v[130:133], a[84:87], a[140:143], v[130:133]
    ds_read_b64_tr_b16 a[78:79], v20 offset:33888
    s_add_u32 m0, s38, 90112
    v_mfma_f32_16x16x32_bf16 v[126:129], a[84:87], a[136:139], v[126:129]
    buffer_load_dwordx4 v11, s[72:75], s49 offen lds
    v_mfma_f32_16x16x32_bf16 v[122:125], a[84:87], a[132:135], v[122:125]
    s_waitcnt lgkmcnt(6)
    s_waitcnt vmcnt(14)
    v_mfma_f32_16x16x32_bf16 v[42:45], a[64:67], a[148:151], v[42:45]
    ds_read_b64_tr_b16 a[80:81], v19 offset:30848
    v_mfma_f32_16x16x32_bf16 v[46:49], a[64:67], a[152:155], v[46:49]
    ds_read_b64_tr_b16 a[82:83], v19 offset:33920
    s_add_u32 m0, s38, 94208
    v_mfma_f32_16x16x32_bf16 v[50:53], a[64:67], a[156:159], v[50:53]
    buffer_load_dwordx4 v12, s[72:75], s49 offen lds
    v_mfma_f32_16x16x32_bf16 v[54:57], a[64:67], a[160:163], v[54:57]
    s_waitcnt lgkmcnt(6)
    v_mfma_f32_16x16x32_bf16 v[70:73], a[68:71], a[160:163], v[70:73]
    ds_read_b64_tr_b16 a[84:85], v20 offset:30880
    v_mfma_f32_16x16x32_bf16 v[66:69], a[68:71], a[156:159], v[66:69]
    ds_read_b64_tr_b16 a[86:87], v20 offset:33952
    s_add_u32 m0, s38, 98304
    v_mfma_f32_16x16x32_bf16 v[62:65], a[68:71], a[152:155], v[62:65]
    buffer_load_dwordx4 v13, s[72:75], s49 offen lds
    v_mfma_f32_16x16x32_bf16 v[58:61], a[68:71], a[148:151], v[58:61]
    s_waitcnt vmcnt(14)
    s_barrier
    s_waitcnt lgkmcnt(6)
    v_mfma_f32_16x16x32_bf16 v[74:77], a[72:75], a[148:151], v[74:77]
    ds_read_b64_tr_b16 a[64:65], v19 offset:36864
    v_mfma_f32_16x16x32_bf16 v[78:81], a[72:75], a[152:155], v[78:81]
    ds_read_b64_tr_b16 a[66:67], v19 offset:39936
    s_add_u32 m0, s38, 102400
    v_mfma_f32_16x16x32_bf16 v[82:85], a[72:75], a[156:159], v[82:85]
    buffer_load_dwordx4 v14, s[72:75], s49 offen lds
    v_mfma_f32_16x16x32_bf16 v[86:89], a[72:75], a[160:163], v[86:89]
    s_waitcnt lgkmcnt(6)
    v_mfma_f32_16x16x32_bf16 v[102:105], a[76:79], a[160:163], v[102:105]
    ds_read_b64_tr_b16 a[68:69], v20 offset:36896
    v_mfma_f32_16x16x32_bf16 v[98:101], a[76:79], a[156:159], v[98:101]
    ds_read_b64_tr_b16 a[70:71], v20 offset:39968
    v_mfma_f32_16x16x32_bf16 v[94:97], a[76:79], a[152:155], v[94:97]
    v_mfma_f32_16x16x32_bf16 v[90:93], a[76:79], a[148:151], v[90:93]
    s_waitcnt lgkmcnt(6)
    v_mfma_f32_16x16x32_bf16 v[106:109], a[80:83], a[148:151], v[106:109]
    ds_read_b64_tr_b16 a[72:73], v19 offset:36928
    v_mfma_f32_16x16x32_bf16 v[110:113], a[80:83], a[152:155], v[110:113]
    ds_read_b64_tr_b16 a[74:75], v19 offset:40000
    v_mfma_f32_16x16x32_bf16 v[114:117], a[80:83], a[156:159], v[114:117]
    v_mfma_f32_16x16x32_bf16 v[118:121], a[80:83], a[160:163], v[118:121]
    s_waitcnt lgkmcnt(6)
    v_mfma_f32_16x16x32_bf16 v[134:137], a[84:87], a[160:163], v[134:137]
    ds_read_b64_tr_b16 a[76:77], v20 offset:36960
    v_mfma_f32_16x16x32_bf16 v[130:133], a[84:87], a[156:159], v[130:133]
    ds_read_b64_tr_b16 a[78:79], v20 offset:40032
    v_mfma_f32_16x16x32_bf16 v[126:129], a[84:87], a[152:155], v[126:129]
    v_mfma_f32_16x16x32_bf16 v[122:125], a[84:87], a[148:151], v[122:125]
    s_waitcnt lgkmcnt(6)
    s_waitcnt vmcnt(11)
    v_mfma_f32_16x16x32_bf16 v[42:45], a[64:67], a[164:167], v[42:45]
    ds_read_b64_tr_b16 a[80:81], v19 offset:36992
    v_mfma_f32_16x16x32_bf16 v[46:49], a[64:67], a[168:171], v[46:49]
    ds_read_b64_tr_b16 a[82:83], v19 offset:40064
    v_mfma_f32_16x16x32_bf16 v[50:53], a[64:67], a[172:175], v[50:53]
    v_mfma_f32_16x16x32_bf16 v[54:57], a[64:67], a[176:179], v[54:57]
    s_waitcnt lgkmcnt(6)
    v_mfma_f32_16x16x32_bf16 v[70:73], a[68:71], a[176:179], v[70:73]
    ds_read_b64_tr_b16 a[84:85], v20 offset:37024
    v_mfma_f32_16x16x32_bf16 v[66:69], a[68:71], a[172:175], v[66:69]
    ds_read_b64_tr_b16 a[86:87], v20 offset:40096
    v_mfma_f32_16x16x32_bf16 v[62:65], a[68:71], a[168:171], v[62:65]
    v_mfma_f32_16x16x32_bf16 v[58:61], a[68:71], a[164:167], v[58:61]
    s_waitcnt lgkmcnt(6)
    v_mfma_f32_16x16x32_bf16 v[74:77], a[72:75], a[164:167], v[74:77]
    ds_read_b64_tr_b16 a[64:65], v19 offset:43008
    v_mfma_f32_16x16x32_bf16 v[78:81], a[72:75], a[168:171], v[78:81]
    ds_read_b64_tr_b16 a[66:67], v19 offset:46080
    v_mfma_f32_16x16x32_bf16 v[82:85], a[72:75], a[172:175], v[82:85]
    v_mfma_f32_16x16x32_bf16 v[86:89], a[72:75], a[176:179], v[86:89]
    s_waitcnt lgkmcnt(6)
    v_mfma_f32_16x16x32_bf16 v[102:105], a[76:79], a[176:179], v[102:105]
    ds_read_b64_tr_b16 a[68:69], v20 offset:43040
    v_mfma_f32_16x16x32_bf16 v[98:101], a[76:79], a[172:175], v[98:101]
    ds_read_b64_tr_b16 a[70:71], v20 offset:46112
    v_mfma_f32_16x16x32_bf16 v[94:97], a[76:79], a[168:171], v[94:97]
    v_mfma_f32_16x16x32_bf16 v[90:93], a[76:79], a[164:167], v[90:93]
    s_waitcnt lgkmcnt(6)
    v_mfma_f32_16x16x32_bf16 v[106:109], a[80:83], a[164:167], v[106:109]
    ds_read_b64_tr_b16 a[72:73], v19 offset:43072
    v_mfma_f32_16x16x32_bf16 v[110:113], a[80:83], a[168:171], v[110:113]
    ds_read_b64_tr_b16 a[74:75], v19 offset:46144
    v_mfma_f32_16x16x32_bf16 v[114:117], a[80:83], a[172:175], v[114:117]
    v_mfma_f32_16x16x32_bf16 v[118:121], a[80:83], a[176:179], v[118:121]
    s_waitcnt lgkmcnt(6)
    v_mfma_f32_16x16x32_bf16 v[134:137], a[84:87], a[176:179], v[134:137]
    ds_read_b64_tr_b16 a[76:77], v20 offset:43104
    v_mfma_f32_16x16x32_bf16 v[130:133], a[84:87], a[172:175], v[130:133]
    ds_read_b64_tr_b16 a[78:79], v20 offset:46176
    v_mfma_f32_16x16x32_bf16 v[126:129], a[84:87], a[168:171], v[126:129]
    v_mfma_f32_16x16x32_bf16 v[122:125], a[84:87], a[164:167], v[122:125]
    s_waitcnt lgkmcnt(6)
    s_waitcnt vmcnt(7)
    v_mfma_f32_16x16x32_bf16 v[42:45], a[64:67], a[180:183], v[42:45]
    ds_read_b64_tr_b16 a[80:81], v19 offset:43136
    v_mfma_f32_16x16x32_bf16 v[46:49], a[64:67], a[184:187], v[46:49]
    ds_read_b64_tr_b16 a[82:83], v19 offset:46208
    v_mfma_f32_16x16x32_bf16 v[50:53], a[64:67], a[188:191], v[50:53]
    v_mfma_f32_16x16x32_bf16 v[54:57], a[64:67], a[192:195], v[54:57]
    s_waitcnt lgkmcnt(6)
    v_mfma_f32_16x16x32_bf16 v[70:73], a[68:71], a[192:195], v[70:73]
    ds_read_b64_tr_b16 a[84:85], v20 offset:43168
    v_mfma_f32_16x16x32_bf16 v[66:69], a[68:71], a[188:191], v[66:69]
    ds_read_b64_tr_b16 a[86:87], v20 offset:46240
    v_mfma_f32_16x16x32_bf16 v[62:65], a[68:71], a[184:187], v[62:65]
    v_mfma_f32_16x16x32_bf16 v[58:61], a[68:71], a[180:183], v[58:61]
    s_waitcnt lgkmcnt(6)
    v_mfma_f32_16x16x32_bf16 v[74:77], a[72:75], a[180:183], v[74:77]
    ds_read_b64_tr_b16 a[88:89], v21 offset:0
    v_mfma_f32_16x16x32_bf16 v[78:81], a[72:75], a[184:187], v[78:81]
    ds_read_b64_tr_b16 a[90:91], v21 offset:3584
    v_mfma_f32_16x16x32_bf16 v[82:85], a[72:75], a[188:191], v[82:85]
    v_mfma_f32_16x16x32_bf16 v[86:89], a[72:75], a[192:195], v[86:89]
    s_waitcnt lgkmcnt(6)
    v_mfma_f32_16x16x32_bf16 v[102:105], a[76:79], a[192:195], v[102:105]
    ds_read_b64_tr_b16 a[92:93], v21 offset:32
    v_mfma_f32_16x16x32_bf16 v[98:101], a[76:79], a[188:191], v[98:101]
    ds_read_b64_tr_b16 a[94:95], v21 offset:3616
    v_mfma_f32_16x16x32_bf16 v[94:97], a[76:79], a[184:187], v[94:97]
    v_mfma_f32_16x16x32_bf16 v[90:93], a[76:79], a[180:183], v[90:93]
    s_waitcnt lgkmcnt(6)
    v_mfma_f32_16x16x32_bf16 v[106:109], a[80:83], a[180:183], v[106:109]
    ds_read_b64_tr_b16 a[96:97], v21 offset:64
    v_mfma_f32_16x16x32_bf16 v[110:113], a[80:83], a[184:187], v[110:113]
    ds_read_b64_tr_b16 a[98:99], v21 offset:3648
    v_mfma_f32_16x16x32_bf16 v[114:117], a[80:83], a[188:191], v[114:117]
    v_mfma_f32_16x16x32_bf16 v[118:121], a[80:83], a[192:195], v[118:121]
    s_waitcnt lgkmcnt(6)
    v_mfma_f32_16x16x32_bf16 v[134:137], a[84:87], a[192:195], v[134:137]
    ds_read_b64_tr_b16 a[100:101], v21 offset:96
    v_mfma_f32_16x16x32_bf16 v[130:133], a[84:87], a[188:191], v[130:133]
    ds_read_b64_tr_b16 a[102:103], v21 offset:3680
    v_mfma_f32_16x16x32_bf16 v[126:129], a[84:87], a[184:187], v[126:129]
    v_mfma_f32_16x16x32_bf16 v[122:125], a[84:87], a[180:183], v[122:125]
    s_waitcnt lgkmcnt(6)
    v_mfma_f32_16x16x32_bf16 v[138:141], a[88:91], a[0:3], v[138:141]
    ds_read_b64_tr_b16 a[104:105], v21 offset:128
    v_mfma_f32_16x16x32_bf16 v[142:145], a[88:91], a[4:7], v[142:145]
    ds_read_b64_tr_b16 a[106:107], v21 offset:3712
    v_mfma_f32_16x16x32_bf16 v[146:149], a[88:91], a[8:11], v[146:149]
    v_mfma_f32_16x16x32_bf16 v[150:153], a[88:91], a[12:15], v[150:153]
    s_waitcnt lgkmcnt(6)
    v_mfma_f32_16x16x32_bf16 v[166:169], a[92:95], a[12:15], v[166:169]
    ds_read_b64_tr_b16 a[108:109], v21 offset:160
    v_mul_f32 v42, s4, v42
    v_mfma_f32_16x16x32_bf16 v[162:165], a[92:95], a[8:11], v[162:165]
    ds_read_b64_tr_b16 a[110:111], v21 offset:3744
    v_mul_f32 v43, s4, v43
    v_mfma_f32_16x16x32_bf16 v[158:161], a[92:95], a[4:7], v[158:161]
    v_mul_f32 v44, s4, v44
    v_mul_f32 v45, s4, v45
    v_mfma_f32_16x16x32_bf16 v[154:157], a[92:95], a[0:3], v[154:157]
    v_cvt_pk_bf16_f32 v24, v42, v43
    v_cvt_pk_bf16_f32 v25, v44, v45
    s_waitcnt lgkmcnt(6)
    v_mfma_f32_16x16x32_bf16 v[170:173], a[96:99], a[0:3], v[170:173]
    ds_read_b64_tr_b16 a[112:113], v21 offset:192
    v_mul_f32 v58, s4, v58
    v_mfma_f32_16x16x32_bf16 v[174:177], a[96:99], a[4:7], v[174:177]
    ds_read_b64_tr_b16 a[114:115], v21 offset:3776
    v_mul_f32 v59, s4, v59
    v_mfma_f32_16x16x32_bf16 v[178:181], a[96:99], a[8:11], v[178:181]
    v_mul_f32 v60, s4, v60
    v_mul_f32 v61, s4, v61
    v_mfma_f32_16x16x32_bf16 v[182:185], a[96:99], a[12:15], v[182:185]
    v_cvt_pk_bf16_f32 v26, v58, v59
    v_cvt_pk_bf16_f32 v27, v60, v61
    s_waitcnt lgkmcnt(6)
    v_mfma_f32_16x16x32_bf16 v[198:201], a[100:103], a[12:15], v[198:201]
    ds_read_b64_tr_b16 a[88:89], v21 offset:7168
    v_mfma_f32_16x16x32_bf16 v[194:197], a[100:103], a[8:11], v[194:197]
    ds_read_b64_tr_b16 a[90:91], v21 offset:10752
    v_mfma_f32_16x16x32_bf16 v[190:193], a[100:103], a[4:7], v[190:193]
    buffer_store_dwordx4 v[24:27], v39, s[16:19], s12 offen offset:0 sc1
    v_mfma_f32_16x16x32_bf16 v[186:189], a[100:103], a[0:3], v[186:189]
    v_mul_f32 v46, s4, v46
    v_mul_f32 v47, s4, v47
    s_waitcnt lgkmcnt(6)
    v_mfma_f32_16x16x32_bf16 v[202:205], a[104:107], a[0:3], v[202:205]
    ds_read_b64_tr_b16 a[92:93], v21 offset:7200
    v_mul_f32 v48, s4, v48
    v_mfma_f32_16x16x32_bf16 v[206:209], a[104:107], a[4:7], v[206:209]
    ds_read_b64_tr_b16 a[94:95], v21 offset:10784
    v_mul_f32 v49, s4, v49
    v_mfma_f32_16x16x32_bf16 v[210:213], a[104:107], a[8:11], v[210:213]
    v_cvt_pk_bf16_f32 v28, v46, v47
    v_cvt_pk_bf16_f32 v29, v48, v49
    v_mfma_f32_16x16x32_bf16 v[214:217], a[104:107], a[12:15], v[214:217]
    v_mul_f32 v62, s4, v62
    v_mul_f32 v63, s4, v63
    s_waitcnt lgkmcnt(6)
    v_mfma_f32_16x16x32_bf16 v[230:233], a[108:111], a[12:15], v[230:233]
    ds_read_b64_tr_b16 a[96:97], v21 offset:7232
    v_mul_f32 v64, s4, v64
    v_mfma_f32_16x16x32_bf16 v[226:229], a[108:111], a[8:11], v[226:229]
    ds_read_b64_tr_b16 a[98:99], v21 offset:10816
    v_mul_f32 v65, s4, v65
    v_mfma_f32_16x16x32_bf16 v[222:225], a[108:111], a[4:7], v[222:225]
    v_cvt_pk_bf16_f32 v30, v62, v63
    v_cvt_pk_bf16_f32 v31, v64, v65
    v_mfma_f32_16x16x32_bf16 v[218:221], a[108:111], a[0:3], v[218:221]
    buffer_store_dwordx4 v[28:31], v39, s[16:19], s12 offen offset:256 sc1
    s_waitcnt lgkmcnt(6)
    v_mfma_f32_16x16x32_bf16 v[234:237], a[112:115], a[0:3], v[234:237]
    ds_read_b64_tr_b16 a[100:101], v21 offset:7264
    v_mul_f32 v50, s4, v50
    v_mfma_f32_16x16x32_bf16 v[238:241], a[112:115], a[4:7], v[238:241]
    ds_read_b64_tr_b16 a[102:103], v21 offset:10848
    v_mul_f32 v51, s4, v51
    v_mfma_f32_16x16x32_bf16 v[242:245], a[112:115], a[8:11], v[242:245]
    v_mul_f32 v52, s4, v52
    v_mul_f32 v53, s4, v53
    v_mfma_f32_16x16x32_bf16 v[246:249], a[112:115], a[12:15], v[246:249]
    v_cvt_pk_bf16_f32 v32, v50, v51
    v_cvt_pk_bf16_f32 v33, v52, v53
    s_waitcnt lgkmcnt(6)
    v_mfma_f32_16x16x32_bf16 v[138:141], a[88:91], a[16:19], v[138:141]
    ds_read_b64_tr_b16 a[104:105], v21 offset:7296
    v_mul_f32 v66, s4, v66
    v_mfma_f32_16x16x32_bf16 v[142:145], a[88:91], a[20:23], v[142:145]
    ds_read_b64_tr_b16 a[106:107], v21 offset:10880
    v_mul_f32 v67, s4, v67
    v_mfma_f32_16x16x32_bf16 v[146:149], a[88:91], a[24:27], v[146:149]
    v_mul_f32 v68, s4, v68
    v_mul_f32 v69, s4, v69
    v_mfma_f32_16x16x32_bf16 v[150:153], a[88:91], a[28:31], v[150:153]
    v_cvt_pk_bf16_f32 v34, v66, v67
    v_cvt_pk_bf16_f32 v35, v68, v69
    s_waitcnt lgkmcnt(6)
    v_mfma_f32_16x16x32_bf16 v[166:169], a[92:95], a[28:31], v[166:169]
    ds_read_b64_tr_b16 a[108:109], v21 offset:7328
    v_mfma_f32_16x16x32_bf16 v[162:165], a[92:95], a[24:27], v[162:165]
    ds_read_b64_tr_b16 a[110:111], v21 offset:10912
    v_mfma_f32_16x16x32_bf16 v[158:161], a[92:95], a[20:23], v[158:161]
    buffer_store_dwordx4 v[32:35], v39, s[16:19], s12 offen offset:2048 sc1
    v_mfma_f32_16x16x32_bf16 v[154:157], a[92:95], a[16:19], v[154:157]
    v_mul_f32 v54, s4, v54
    v_mul_f32 v55, s4, v55
    s_waitcnt lgkmcnt(6)
    v_mfma_f32_16x16x32_bf16 v[170:173], a[96:99], a[16:19], v[170:173]
    ds_read_b64_tr_b16 a[112:113], v21 offset:7360
    v_mul_f32 v56, s4, v56
    v_mfma_f32_16x16x32_bf16 v[174:177], a[96:99], a[20:23], v[174:177]
    ds_read_b64_tr_b16 a[114:115], v21 offset:10944
    v_mul_f32 v57, s4, v57
    v_mfma_f32_16x16x32_bf16 v[178:181], a[96:99], a[24:27], v[178:181]
    v_cvt_pk_bf16_f32 v24, v54, v55
    v_cvt_pk_bf16_f32 v25, v56, v57
    v_mfma_f32_16x16x32_bf16 v[182:185], a[96:99], a[28:31], v[182:185]
    v_mul_f32 v70, s4, v70
    v_mul_f32 v71, s4, v71
    s_waitcnt lgkmcnt(6)
    v_mfma_f32_16x16x32_bf16 v[198:201], a[100:103], a[28:31], v[198:201]
    ds_read_b64_tr_b16 a[88:89], v21 offset:14336
    v_mul_f32 v72, s4, v72
    v_mfma_f32_16x16x32_bf16 v[194:197], a[100:103], a[24:27], v[194:197]
    ds_read_b64_tr_b16 a[90:91], v21 offset:17920
    v_mul_f32 v73, s4, v73
    v_mfma_f32_16x16x32_bf16 v[190:193], a[100:103], a[20:23], v[190:193]
    v_cvt_pk_bf16_f32 v26, v70, v71
    v_cvt_pk_bf16_f32 v27, v72, v73
    v_mfma_f32_16x16x32_bf16 v[186:189], a[100:103], a[16:19], v[186:189]
    buffer_store_dwordx4 v[24:27], v39, s[16:19], s12 offen offset:2304 sc1
    s_waitcnt lgkmcnt(6)
    v_mfma_f32_16x16x32_bf16 v[202:205], a[104:107], a[16:19], v[202:205]
    ds_read_b64_tr_b16 a[92:93], v21 offset:14368
    v_mul_f32 v74, s5, v74
    v_mfma_f32_16x16x32_bf16 v[206:209], a[104:107], a[20:23], v[206:209]
    ds_read_b64_tr_b16 a[94:95], v21 offset:17952
    v_mul_f32 v75, s5, v75
    v_mfma_f32_16x16x32_bf16 v[210:213], a[104:107], a[24:27], v[210:213]
    v_mul_f32 v76, s5, v76
    v_mul_f32 v77, s5, v77
    v_mfma_f32_16x16x32_bf16 v[214:217], a[104:107], a[28:31], v[214:217]
    v_cvt_pk_bf16_f32 v28, v74, v75
    v_cvt_pk_bf16_f32 v29, v76, v77
    s_waitcnt lgkmcnt(6)
    v_mfma_f32_16x16x32_bf16 v[230:233], a[108:111], a[28:31], v[230:233]
    ds_read_b64_tr_b16 a[96:97], v21 offset:14400
    v_mul_f32 v90, s5, v90
    v_mfma_f32_16x16x32_bf16 v[226:229], a[108:111], a[24:27], v[226:229]
    ds_read_b64_tr_b16 a[98:99], v21 offset:17984
    v_mul_f32 v91, s5, v91
    v_mfma_f32_16x16x32_bf16 v[222:225], a[108:111], a[20:23], v[222:225]
    v_mul_f32 v92, s5, v92
    v_mul_f32 v93, s5, v93
    v_mfma_f32_16x16x32_bf16 v[218:221], a[108:111], a[16:19], v[218:221]
    v_cvt_pk_bf16_f32 v30, v90, v91
    v_cvt_pk_bf16_f32 v31, v92, v93
    s_waitcnt lgkmcnt(6)
    v_mfma_f32_16x16x32_bf16 v[234:237], a[112:115], a[16:19], v[234:237]
    ds_read_b64_tr_b16 a[100:101], v21 offset:14432
    v_mfma_f32_16x16x32_bf16 v[238:241], a[112:115], a[20:23], v[238:241]
    ds_read_b64_tr_b16 a[102:103], v21 offset:18016
    v_mfma_f32_16x16x32_bf16 v[242:245], a[112:115], a[24:27], v[242:245]
    buffer_store_dwordx4 v[28:31], v40, s[16:19], s13 offen offset:0 sc1
    v_mfma_f32_16x16x32_bf16 v[246:249], a[112:115], a[28:31], v[246:249]
    v_mul_f32 v78, s5, v78
    v_mul_f32 v79, s5, v79
    s_waitcnt lgkmcnt(6)
    v_mfma_f32_16x16x32_bf16 v[138:141], a[88:91], a[32:35], v[138:141]
    ds_read_b64_tr_b16 a[104:105], v21 offset:14464
    v_mul_f32 v80, s5, v80
    v_mfma_f32_16x16x32_bf16 v[142:145], a[88:91], a[36:39], v[142:145]
    ds_read_b64_tr_b16 a[106:107], v21 offset:18048
    v_mul_f32 v81, s5, v81
    v_mfma_f32_16x16x32_bf16 v[146:149], a[88:91], a[40:43], v[146:149]
    v_cvt_pk_bf16_f32 v32, v78, v79
    v_cvt_pk_bf16_f32 v33, v80, v81
    v_mfma_f32_16x16x32_bf16 v[150:153], a[88:91], a[44:47], v[150:153]
    v_mul_f32 v94, s5, v94
    v_mul_f32 v95, s5, v95
    s_waitcnt lgkmcnt(6)
    v_mfma_f32_16x16x32_bf16 v[166:169], a[92:95], a[44:47], v[166:169]
    ds_read_b64_tr_b16 a[108:109], v21 offset:14496
    v_mul_f32 v96, s5, v96
    v_mfma_f32_16x16x32_bf16 v[162:165], a[92:95], a[40:43], v[162:165]
    ds_read_b64_tr_b16 a[110:111], v21 offset:18080
    v_mul_f32 v97, s5, v97
    v_mfma_f32_16x16x32_bf16 v[158:161], a[92:95], a[36:39], v[158:161]
    v_cvt_pk_bf16_f32 v34, v94, v95
    v_cvt_pk_bf16_f32 v35, v96, v97
    v_mfma_f32_16x16x32_bf16 v[154:157], a[92:95], a[32:35], v[154:157]
    buffer_store_dwordx4 v[32:35], v40, s[16:19], s13 offen offset:256 sc1
    s_waitcnt lgkmcnt(6)
    v_mfma_f32_16x16x32_bf16 v[170:173], a[96:99], a[32:35], v[170:173]
    ds_read_b64_tr_b16 a[112:113], v21 offset:14528
    v_mul_f32 v82, s5, v82
    v_mfma_f32_16x16x32_bf16 v[174:177], a[96:99], a[36:39], v[174:177]
    ds_read_b64_tr_b16 a[114:115], v21 offset:18112
    v_mul_f32 v83, s5, v83
    v_mfma_f32_16x16x32_bf16 v[178:181], a[96:99], a[40:43], v[178:181]
    v_mul_f32 v84, s5, v84
    v_mul_f32 v85, s5, v85
    v_mfma_f32_16x16x32_bf16 v[182:185], a[96:99], a[44:47], v[182:185]
    v_cvt_pk_bf16_f32 v24, v82, v83
    v_cvt_pk_bf16_f32 v25, v84, v85
    s_waitcnt lgkmcnt(6)
    v_mfma_f32_16x16x32_bf16 v[198:201], a[100:103], a[44:47], v[198:201]
    ds_read_b64_tr_b16 a[88:89], v21 offset:21504
    v_mul_f32 v98, s5, v98
    v_mfma_f32_16x16x32_bf16 v[194:197], a[100:103], a[40:43], v[194:197]
    ds_read_b64_tr_b16 a[90:91], v21 offset:25088
    v_mul_f32 v99, s5, v99
    v_mfma_f32_16x16x32_bf16 v[190:193], a[100:103], a[36:39], v[190:193]
    v_mul_f32 v100, s5, v100
    v_mul_f32 v101, s5, v101
    v_mfma_f32_16x16x32_bf16 v[186:189], a[100:103], a[32:35], v[186:189]
    v_cvt_pk_bf16_f32 v26, v98, v99
    v_cvt_pk_bf16_f32 v27, v100, v101
    s_waitcnt lgkmcnt(6)
    v_mfma_f32_16x16x32_bf16 v[202:205], a[104:107], a[32:35], v[202:205]
    ds_read_b64_tr_b16 a[92:93], v21 offset:21536
    v_mfma_f32_16x16x32_bf16 v[206:209], a[104:107], a[36:39], v[206:209]
    ds_read_b64_tr_b16 a[94:95], v21 offset:25120
    v_mfma_f32_16x16x32_bf16 v[210:213], a[104:107], a[40:43], v[210:213]
    buffer_store_dwordx4 v[24:27], v40, s[16:19], s13 offen offset:2048 sc1
    v_mfma_f32_16x16x32_bf16 v[214:217], a[104:107], a[44:47], v[214:217]
    v_mul_f32 v86, s5, v86
    v_mul_f32 v87, s5, v87
    s_waitcnt lgkmcnt(6)
    v_mfma_f32_16x16x32_bf16 v[230:233], a[108:111], a[44:47], v[230:233]
    ds_read_b64_tr_b16 a[96:97], v21 offset:21568
    v_mul_f32 v88, s5, v88
    v_mfma_f32_16x16x32_bf16 v[226:229], a[108:111], a[40:43], v[226:229]
    ds_read_b64_tr_b16 a[98:99], v21 offset:25152
    v_mul_f32 v89, s5, v89
    v_mfma_f32_16x16x32_bf16 v[222:225], a[108:111], a[36:39], v[222:225]
    v_cvt_pk_bf16_f32 v28, v86, v87
    v_cvt_pk_bf16_f32 v29, v88, v89
    v_mfma_f32_16x16x32_bf16 v[218:221], a[108:111], a[32:35], v[218:221]
    v_mul_f32 v102, s5, v102
    v_mul_f32 v103, s5, v103
    s_waitcnt lgkmcnt(6)
    v_mfma_f32_16x16x32_bf16 v[234:237], a[112:115], a[32:35], v[234:237]
    ds_read_b64_tr_b16 a[100:101], v21 offset:21600
    v_mul_f32 v104, s5, v104
    v_mfma_f32_16x16x32_bf16 v[238:241], a[112:115], a[36:39], v[238:241]
    ds_read_b64_tr_b16 a[102:103], v21 offset:25184
    v_mul_f32 v105, s5, v105
    v_mfma_f32_16x16x32_bf16 v[242:245], a[112:115], a[40:43], v[242:245]
    v_cvt_pk_bf16_f32 v30, v102, v103
    v_cvt_pk_bf16_f32 v31, v104, v105
    v_mfma_f32_16x16x32_bf16 v[246:249], a[112:115], a[44:47], v[246:249]
    buffer_store_dwordx4 v[28:31], v40, s[16:19], s13 offen offset:2304 sc1
    s_waitcnt lgkmcnt(6)
    v_mfma_f32_16x16x32_bf16 v[138:141], a[88:91], a[48:51], v[138:141]
    ds_read_b64_tr_b16 a[104:105], v21 offset:21632
    v_mul_f32 v106, s6, v106
    v_mfma_f32_16x16x32_bf16 v[142:145], a[88:91], a[52:55], v[142:145]
    ds_read_b64_tr_b16 a[106:107], v21 offset:25216
    v_mul_f32 v107, s6, v107
    v_mfma_f32_16x16x32_bf16 v[146:149], a[88:91], a[56:59], v[146:149]
    v_mul_f32 v108, s6, v108
    v_mul_f32 v109, s6, v109
    v_mfma_f32_16x16x32_bf16 v[150:153], a[88:91], a[60:63], v[150:153]
    v_cvt_pk_bf16_f32 v32, v106, v107
    v_cvt_pk_bf16_f32 v33, v108, v109
    s_waitcnt lgkmcnt(6)
    v_mfma_f32_16x16x32_bf16 v[166:169], a[92:95], a[60:63], v[166:169]
    ds_read_b64_tr_b16 a[108:109], v21 offset:21664
    v_mul_f32 v122, s6, v122
    v_mfma_f32_16x16x32_bf16 v[162:165], a[92:95], a[56:59], v[162:165]
    ds_read_b64_tr_b16 a[110:111], v21 offset:25248
    v_mul_f32 v123, s6, v123
    v_mfma_f32_16x16x32_bf16 v[158:161], a[92:95], a[52:55], v[158:161]
    v_mul_f32 v124, s6, v124
    v_mul_f32 v125, s6, v125
    v_mfma_f32_16x16x32_bf16 v[154:157], a[92:95], a[48:51], v[154:157]
    v_cvt_pk_bf16_f32 v34, v122, v123
    v_cvt_pk_bf16_f32 v35, v124, v125
    s_waitcnt lgkmcnt(6)
    v_mfma_f32_16x16x32_bf16 v[170:173], a[96:99], a[48:51], v[170:173]
    ds_read_b64_tr_b16 a[112:113], v21 offset:21696
    v_mfma_f32_16x16x32_bf16 v[174:177], a[96:99], a[52:55], v[174:177]
    ds_read_b64_tr_b16 a[114:115], v21 offset:25280
    v_mfma_f32_16x16x32_bf16 v[178:181], a[96:99], a[56:59], v[178:181]
    buffer_store_dwordx4 v[32:35], v41, s[16:19], s14 offen offset:0 sc1
    v_mfma_f32_16x16x32_bf16 v[182:185], a[96:99], a[60:63], v[182:185]
    v_mul_f32 v110, s6, v110
    v_mul_f32 v111, s6, v111
    s_waitcnt vmcnt(9)
    s_barrier
    s_waitcnt lgkmcnt(6)
    v_mfma_f32_16x16x32_bf16 v[198:201], a[100:103], a[60:63], v[198:201]
    ds_read_b64_tr_b16 a[88:89], v21 offset:28672
    v_mul_f32 v112, s6, v112
    v_mfma_f32_16x16x32_bf16 v[194:197], a[100:103], a[56:59], v[194:197]
    ds_read_b64_tr_b16 a[90:91], v21 offset:32256
    v_mul_f32 v113, s6, v113
    v_mfma_f32_16x16x32_bf16 v[190:193], a[100:103], a[52:55], v[190:193]
    v_cvt_pk_bf16_f32 v24, v110, v111
    v_cvt_pk_bf16_f32 v25, v112, v113
    v_mfma_f32_16x16x32_bf16 v[186:189], a[100:103], a[48:51], v[186:189]
    v_mul_f32 v126, s6, v126
    v_mul_f32 v127, s6, v127
    s_waitcnt lgkmcnt(6)
    v_mfma_f32_16x16x32_bf16 v[202:205], a[104:107], a[48:51], v[202:205]
    ds_read_b64_tr_b16 a[92:93], v21 offset:28704
    v_mul_f32 v128, s6, v128
    v_mfma_f32_16x16x32_bf16 v[206:209], a[104:107], a[52:55], v[206:209]
    ds_read_b64_tr_b16 a[94:95], v21 offset:32288
    v_mul_f32 v129, s6, v129
    v_mfma_f32_16x16x32_bf16 v[210:213], a[104:107], a[56:59], v[210:213]
    v_cvt_pk_bf16_f32 v26, v126, v127
    v_cvt_pk_bf16_f32 v27, v128, v129
    v_mfma_f32_16x16x32_bf16 v[214:217], a[104:107], a[60:63], v[214:217]
    buffer_store_dwordx4 v[24:27], v41, s[16:19], s14 offen offset:256 sc1
    s_waitcnt lgkmcnt(6)
    v_mfma_f32_16x16x32_bf16 v[230:233], a[108:111], a[60:63], v[230:233]
    ds_read_b64_tr_b16 a[96:97], v21 offset:28736
    v_mul_f32 v114, s6, v114
    v_mfma_f32_16x16x32_bf16 v[226:229], a[108:111], a[56:59], v[226:229]
    ds_read_b64_tr_b16 a[98:99], v21 offset:32320
    v_mul_f32 v115, s6, v115
    v_mfma_f32_16x16x32_bf16 v[222:225], a[108:111], a[52:55], v[222:225]
    v_mul_f32 v116, s6, v116
    v_mul_f32 v117, s6, v117
    v_mfma_f32_16x16x32_bf16 v[218:221], a[108:111], a[48:51], v[218:221]
    v_cvt_pk_bf16_f32 v28, v114, v115
    v_cvt_pk_bf16_f32 v29, v116, v117
    s_waitcnt lgkmcnt(6)
    v_mfma_f32_16x16x32_bf16 v[234:237], a[112:115], a[48:51], v[234:237]
    ds_read_b64_tr_b16 a[100:101], v21 offset:28768
    v_mul_f32 v130, s6, v130
    v_mfma_f32_16x16x32_bf16 v[238:241], a[112:115], a[52:55], v[238:241]
    ds_read_b64_tr_b16 a[102:103], v21 offset:32352
    v_mul_f32 v131, s6, v131
    v_mfma_f32_16x16x32_bf16 v[242:245], a[112:115], a[56:59], v[242:245]
    v_mul_f32 v132, s6, v132
    v_mul_f32 v133, s6, v133
    v_mfma_f32_16x16x32_bf16 v[246:249], a[112:115], a[60:63], v[246:249]
    v_cvt_pk_bf16_f32 v30, v130, v131
    v_cvt_pk_bf16_f32 v31, v132, v133
    s_waitcnt lgkmcnt(6)
    v_mfma_f32_16x16x32_bf16 v[138:141], a[88:91], a[132:135], v[138:141]
    ds_read_b64_tr_b16 a[104:105], v21 offset:28800
    v_mfma_f32_16x16x32_bf16 v[142:145], a[88:91], a[136:139], v[142:145]
    ds_read_b64_tr_b16 a[106:107], v21 offset:32384
    v_mfma_f32_16x16x32_bf16 v[146:149], a[88:91], a[140:143], v[146:149]
    buffer_store_dwordx4 v[28:31], v41, s[16:19], s14 offen offset:2048 sc1
    v_mfma_f32_16x16x32_bf16 v[150:153], a[88:91], a[144:147], v[150:153]
    v_mul_f32 v118, s6, v118
    v_mul_f32 v119, s6, v119
    s_waitcnt lgkmcnt(6)
    v_mfma_f32_16x16x32_bf16 v[166:169], a[92:95], a[144:147], v[166:169]
    ds_read_b64_tr_b16 a[108:109], v21 offset:28832
    v_mul_f32 v120, s6, v120
    v_mfma_f32_16x16x32_bf16 v[162:165], a[92:95], a[140:143], v[162:165]
    ds_read_b64_tr_b16 a[110:111], v21 offset:32416
    v_mul_f32 v121, s6, v121
    v_mfma_f32_16x16x32_bf16 v[158:161], a[92:95], a[136:139], v[158:161]
    v_cvt_pk_bf16_f32 v32, v118, v119
    v_cvt_pk_bf16_f32 v33, v120, v121
    v_mfma_f32_16x16x32_bf16 v[154:157], a[92:95], a[132:135], v[154:157]
    v_mul_f32 v134, s6, v134
    v_mul_f32 v135, s6, v135
    s_waitcnt lgkmcnt(6)
    v_mfma_f32_16x16x32_bf16 v[170:173], a[96:99], a[132:135], v[170:173]
    ds_read_b64_tr_b16 a[112:113], v21 offset:28864
    v_mul_f32 v136, s6, v136
    v_mfma_f32_16x16x32_bf16 v[174:177], a[96:99], a[136:139], v[174:177]
    ds_read_b64_tr_b16 a[114:115], v21 offset:32448
    v_mul_f32 v137, s6, v137
    v_mfma_f32_16x16x32_bf16 v[178:181], a[96:99], a[140:143], v[178:181]
    v_cvt_pk_bf16_f32 v34, v134, v135
    v_cvt_pk_bf16_f32 v35, v136, v137
    v_mfma_f32_16x16x32_bf16 v[182:185], a[96:99], a[144:147], v[182:185]
    buffer_store_dwordx4 v[32:35], v41, s[16:19], s14 offen offset:2304 sc1
    s_waitcnt lgkmcnt(6)
    v_mfma_f32_16x16x32_bf16 v[198:201], a[100:103], a[144:147], v[198:201]
    ds_read_b64_tr_b16 a[88:89], v21 offset:35840
    v_mov_b32 v42, 0xbdd2d3e8
    v_mfma_f32_16x16x32_bf16 v[194:197], a[100:103], a[140:143], v[194:197]
    ds_read_b64_tr_b16 a[90:91], v21 offset:39424
    v_mov_b32 v43, 0xbdd2d3e8
    v_mfma_f32_16x16x32_bf16 v[190:193], a[100:103], a[136:139], v[190:193]
    v_mov_b32 v44, 0xc0135761
    v_mov_b32 v45, 0xc0135761
    v_mfma_f32_16x16x32_bf16 v[186:189], a[100:103], a[132:135], v[186:189]
    v_mov_b32 v46, 1.0
    v_mov_b32 v47, 1.0
    s_waitcnt lgkmcnt(6)
    v_mfma_f32_16x16x32_bf16 v[202:205], a[104:107], a[132:135], v[202:205]
    s_mul_i32 s48, s36, 7
    ds_read_b64_tr_b16 a[92:93], v21 offset:35872
    s_add_u32 s55, s48, s39
    v_mfma_f32_16x16x32_bf16 v[206:209], a[104:107], a[136:139], v[206:209]
    s_lshr_b32 s55, s55, 1
    ds_read_b64_tr_b16 a[94:95], v21 offset:39456
    s_mul_i32 s56, s39, 6
    v_mfma_f32_16x16x32_bf16 v[210:213], a[104:107], a[140:143], v[210:213]
    s_sub_u32 s56, 6, s56
    s_add_u32 s56, s56, s48
    s_lshr_b32 s56, s56, 1
    v_mfma_f32_16x16x32_bf16 v[214:217], a[104:107], a[144:147], v[214:217]
    s_mul_i32 s57, s44, 144
    s_add_u32 s55, s55, s57
    s_add_u32 s56, s56, s57
    s_waitcnt lgkmcnt(6)
    v_mfma_f32_16x16x32_bf16 v[230:233], a[108:111], a[144:147], v[230:233]
    s_lshl_b32 s55, s55, 10
    ds_read_b64_tr_b16 a[96:97], v21 offset:35904
    s_lshl_b32 s56, s56, 10
    v_mfma_f32_16x16x32_bf16 v[226:229], a[108:111], a[140:143], v[226:229]
    s_add_u32 s68, s55, 16777216
    ds_read_b64_tr_b16 a[98:99], v21 offset:39488
    s_add_u32 s69, s56, 16777216
    v_mfma_f32_16x16x32_bf16 v[222:225], a[108:111], a[136:139], v[222:225]
    s_lshl_b32 s73, s35, 8
    s_lshl_b32 s55, s36, 3
    s_add_u32 s73, s73, s55
    v_mfma_f32_16x16x32_bf16 v[218:221], a[108:111], a[132:135], v[218:221]
    s_add_u32 s73, s73, 50352128
    s_lshl_b32 s55, s34, 29
    s_add_u32 s73, s73, s55
    s_waitcnt lgkmcnt(6)
    v_mfma_f32_16x16x32_bf16 v[234:237], a[112:115], a[132:135], v[234:237]
    s_lshl_b32 s32, s61, 2
    ds_read_b64_tr_b16 a[100:101], v21 offset:35936
    s_bfe_u32 s33, s2, 0x20003
    v_mfma_f32_16x16x32_bf16 v[238:241], a[112:115], a[136:139], v[238:241]
    s_add_u32 s32, s32, s33
    ds_read_b64_tr_b16 a[102:103], v21 offset:39520
    s_lshr_b32 s33, s2, 5
    v_mfma_f32_16x16x32_bf16 v[242:245], a[112:115], a[140:143], v[242:245]
    s_lshl_b32 s55, s32, 17
    s_add_u32 s70, s55, 8388608
    s_add_u32 s71, s55, 12582912
    v_mfma_f32_16x16x32_bf16 v[246:249], a[112:115], a[144:147], v[246:249]
    s_lshl_b32 s72, s33, 3
    s_lshl_b32 s56, s34, 1
    s_add_u32 s72, s72, s56
    s_waitcnt lgkmcnt(6)
    v_mfma_f32_16x16x32_bf16 v[138:141], a[88:91], a[148:151], v[138:141]
    s_lshl_b32 s75, s72, 11
    ds_read_b64_tr_b16 a[104:105], v21 offset:35968
    s_add_u32 s75, s75, s55
    v_mfma_f32_16x16x32_bf16 v[142:145], a[88:91], a[152:155], v[142:145]
    s_add_u32 s75, s75, 4194304
    ds_read_b64_tr_b16 a[106:107], v21 offset:39552
    s_lshr_b32 s74, s15, 1
    v_mfma_f32_16x16x32_bf16 v[146:149], a[88:91], a[156:159], v[146:149]
    s_lshl_b32 s74, s74, 8
    s_add_u32 s74, s74, 50352128
    s_mov_b32 s44, 0
    v_mfma_f32_16x16x32_bf16 v[150:153], a[88:91], a[160:163], v[150:153]
    s_lshl_b32 s54, s34, 11
    s_mov_b32 s66, 50528256
    v_lshlrev_b32 v6, 3, v1
    s_waitcnt lgkmcnt(6)
    v_mfma_f32_16x16x32_bf16 v[166:169], a[92:95], a[160:163], v[166:169]
    s_mul_i32 s55, s34, 14336
    ds_read_b64_tr_b16 a[108:109], v21 offset:36000
    v_add_u32 v28, s55, v252
    v_mfma_f32_16x16x32_bf16 v[162:165], a[92:95], a[156:159], v[162:165]
    ds_read_b64_tr_b16 a[110:111], v21 offset:39584
    v_add_u32 v29, s55, v6
    v_mfma_f32_16x16x32_bf16 v[158:161], a[92:95], a[152:155], v[158:161]
    s_lshl_b32 s55, s39, 9
    v_add_u32 v35, s55, v6
    v_lshrrev_b32 v7, 3, v1
    v_mfma_f32_16x16x32_bf16 v[154:157], a[92:95], a[148:151], v[154:157]
    v_min_u32 v7, 2, v7
    v_lshlrev_b32 v7, 5, v7
    s_waitcnt lgkmcnt(6)
    v_mfma_f32_16x16x32_bf16 v[170:173], a[96:99], a[148:151], v[170:173]
    ds_read_b64_tr_b16 a[112:113], v21 offset:36032
    v_add_u32 v7, s32, v7
    v_mfma_f32_16x16x32_bf16 v[174:177], a[96:99], a[152:155], v[174:177]
    ds_read_b64_tr_b16 a[114:115], v21 offset:39616
    v_mul_u32_u24 v7, 171, v7
    v_mfma_f32_16x16x32_bf16 v[178:181], a[96:99], a[156:159], v[178:181]
    v_lshrrev_b32 v7, 9, v7
    v_lshlrev_b32 v7, 10, v7
    v_mfma_f32_16x16x32_bf16 v[182:185], a[96:99], a[160:163], v[182:185]
    v_and_b32 v38, 7, v1
    v_lshl_add_u32 v7, v38, 7, v7
    s_waitcnt lgkmcnt(6)
    v_mfma_f32_16x16x32_bf16 v[198:201], a[100:103], a[160:163], v[198:201]
    s_mul_i32 s55, s37, 147456
    ds_read_b64_tr_b16 a[88:89], v21 offset:43008
    s_add_u32 s55, s55, 16777216
    v_mfma_f32_16x16x32_bf16 v[194:197], a[100:103], a[156:159], v[194:197]
    ds_read_b64_tr_b16 a[90:91], v21 offset:46592
    v_add_u32 v2, s55, v252
    v_mfma_f32_16x16x32_bf16 v[190:193], a[100:103], a[152:155], v[190:193]
    v_add_u32 v3, 147456, v2
    v_add_u32 v10, s55, v6
    v_mfma_f32_16x16x32_bf16 v[186:189], a[100:103], a[148:151], v[186:189]
    v_add_u32 v11, 147456, v10
    v_add_u32 v33, 4096, v253
    s_waitcnt lgkmcnt(6)
    v_mfma_f32_16x16x32_bf16 v[202:205], a[104:107], a[148:151], v[202:205]
    ds_read_b64_tr_b16 a[92:93], v21 offset:43040
    v_add_u32 v32, 114688, v252
    v_mfma_f32_16x16x32_bf16 v[206:209], a[104:107], a[152:155], v[206:209]
    ds_read_b64_tr_b16 a[94:95], v21 offset:46624
    v_lshrrev_b32 v38, 5, v1
    v_mfma_f32_16x16x32_bf16 v[210:213], a[104:107], a[156:159], v[210:213]
    v_and_b32 v39, 3, v1
    v_xor_b32 v38, v38, v39
    v_mfma_f32_16x16x32_bf16 v[214:217], a[104:107], a[160:163], v[214:217]
    v_lshlrev_b32 v38, 6, v38
    v_lshl_add_u32 v38, v39, 9, v38
    s_waitcnt lgkmcnt(6)
    v_mfma_f32_16x16x32_bf16 v[230:233], a[108:111], a[160:163], v[230:233]
    ds_read_b64_tr_b16 a[96:97], v21 offset:43072
    v_bfe_u32 v39, v1, 2, 2
    v_mfma_f32_16x16x32_bf16 v[226:229], a[108:111], a[156:159], v[226:229]
    ds_read_b64_tr_b16 a[98:99], v21 offset:46656
    v_lshl_add_u32 v38, v39, 4, v38
    v_mfma_f32_16x16x32_bf16 v[222:225], a[108:111], a[152:155], v[222:225]
    v_bfe_u32 v39, v1, 4, 1
    v_lshl_add_u32 v38, v39, 3, v38
    v_mfma_f32_16x16x32_bf16 v[218:221], a[108:111], a[148:151], v[218:221]
    v_add_u32 v31, 122880, v38
    v_xor_b32 v30, 128, v31
    s_waitcnt lgkmcnt(6)
    v_mfma_f32_16x16x32_bf16 v[234:237], a[112:115], a[148:151], v[234:237]
    ds_read_b64_tr_b16 a[100:101], v21 offset:43104
    v_cmp_gt_u32 vcc, 16, v1
    v_mfma_f32_16x16x32_bf16 v[238:241], a[112:115], a[152:155], v[238:241]
    ds_read_b64_tr_b16 a[102:103], v21 offset:46688
    v_lshrrev_b32 v38, 6, v0
    v_mfma_f32_16x16x32_bf16 v[242:245], a[112:115], a[156:159], v[242:245]
    v_lshl_add_u32 v38, v38, 4, v1
    v_lshlrev_b32 v38, 7, v38
    v_mfma_f32_16x16x32_bf16 v[246:249], a[112:115], a[160:163], v[246:249]
    v_cndmask_b32 v34, -2.0, v38, vcc
    s_and_b32 s55, s31, 1
    s_waitcnt lgkmcnt(6)
    v_mfma_f32_16x16x32_bf16 v[138:141], a[88:91], a[164:167], v[138:141]
    s_lshl_b32 s55, s55, 2
    ds_read_b64_tr_b16 a[104:105], v21 offset:43136
    v_lshrrev_b32 v38, 4, v1
    v_mfma_f32_16x16x32_bf16 v[142:145], a[88:91], a[168:171], v[142:145]
    ds_read_b64_tr_b16 a[106:107], v21 offset:46720
    v_bfe_u32 v39, v1, 1, 3
    v_mfma_f32_16x16x32_bf16 v[146:149], a[88:91], a[172:175], v[146:149]
    v_xor_b32 v39, v39, v38
    v_xor_b32 v39, s55, v39
    v_mfma_f32_16x16x32_bf16 v[150:153], a[88:91], a[176:179], v[150:153]
    s_lshl_b32 s55, s34, 3
    v_add_u32 v38, s55, v38
    v_lshlrev_b32 v38, 11, v38
    s_waitcnt lgkmcnt(6)
    v_mfma_f32_16x16x32_bf16 v[166:169], a[92:95], a[176:179], v[166:169]
    ds_read_b64_tr_b16 a[108:109], v21 offset:43168
    v_and_b32 v40, 1, v1
    v_mfma_f32_16x16x32_bf16 v[162:165], a[92:95], a[172:175], v[162:165]
    ds_read_b64_tr_b16 a[110:111], v21 offset:46752
    v_lshl_add_u32 v38, v40, 4, v38
    v_mfma_f32_16x16x32_bf16 v[158:161], a[92:95], a[168:171], v[158:161]
    s_lshr_b32 s55, s31, 1
    s_lshl_b32 s55, s55, 8
    v_add_u32 v38, s55, v38
    v_mfma_f32_16x16x32_bf16 v[154:157], a[92:95], a[164:167], v[154:157]
    v_lshl_add_u32 v4, v39, 5, v38
    v_xor_b32 v39, 4, v39
    s_waitcnt lgkmcnt(6)
    v_mfma_f32_16x16x32_bf16 v[170:173], a[96:99], a[164:167], v[170:173]
    ds_read_b64_tr_b16 a[112:113], v21 offset:43200
    v_lshl_add_u32 v38, v39, 5, v38
    v_mfma_f32_16x16x32_bf16 v[174:177], a[96:99], a[168:171], v[174:177]
    ds_read_b64_tr_b16 a[114:115], v21 offset:46784
    v_add_u32 v5, 8192, v38
    v_mfma_f32_16x16x32_bf16 v[178:181], a[96:99], a[172:175], v[178:181]
    v_lshrrev_b32 v38, 3, v1
    s_lshl_b32 s55, s37, 4
    v_mfma_f32_16x16x32_bf16 v[182:185], a[96:99], a[176:179], v[182:185]
    v_add_u32 v38, s55, v38
    v_lshlrev_b32 v38, 11, v38
    s_waitcnt vmcnt(0)
    s_barrier
    s_mov_b64 exec, 1
    buffer_store_dwordx2 v[250:251], off, s[16:19], s7 sc1
    s_mov_b64 exec, -1
    s_waitcnt lgkmcnt(6)
    v_mfma_f32_16x16x32_bf16 v[198:201], a[100:103], a[176:179], v[198:201]
    ds_read_b64_tr_b16 a[88:89], v21 offset:50176
    v_and_b32 v39, 7, v1
    v_mfma_f32_16x16x32_bf16 v[194:197], a[100:103], a[172:175], v[194:197]
    ds_read_b64_tr_b16 a[90:91], v21 offset:53760
    v_lshlrev_b32 v39, 4, v39
    v_mfma_f32_16x16x32_bf16 v[190:193], a[100:103], a[168:171], v[190:193]
    s_lshl_b32 s55, s31, 7
    v_add_u32 v27, s55, v39
    v_add_u32 v26, v38, v27
    v_mfma_f32_16x16x32_bf16 v[186:189], a[100:103], a[164:167], v[186:189]
    s_mov_b32 s3, 0x4000
    s_mov_b32 s40, 0x8000
    s_mov_b32 s41, 0xc000
    s_waitcnt lgkmcnt(6)
    v_mfma_f32_16x16x32_bf16 v[202:205], a[104:107], a[164:167], v[202:205]
    ds_read_b64_tr_b16 a[92:93], v21 offset:50208
    v_lshrrev_b32 v38, 4, v1
    v_mfma_f32_16x16x32_bf16 v[206:209], a[104:107], a[168:171], v[206:209]
    ds_read_b64_tr_b16 a[94:95], v21 offset:53792
    v_xor_b32 v38, v38, v1
    v_mfma_f32_16x16x32_bf16 v[210:213], a[104:107], a[172:175], v[210:213]
    v_and_b32 v38, 1, v38
    v_cmp_eq_u32 vcc, 0, v38
    v_mfma_f32_16x16x32_bf16 v[214:217], a[104:107], a[176:179], v[214:217]
    v_mov_b32 v39, 0x3f803f80
    v_mov_b32 v40, 0
    s_waitcnt lgkmcnt(6)
    v_mfma_f32_16x16x32_bf16 v[230:233], a[108:111], a[176:179], v[230:233]
    ds_read_b64_tr_b16 a[96:97], v21 offset:50240
    v_cndmask_b32 v41, v40, v39, vcc
    v_mfma_f32_16x16x32_bf16 v[226:229], a[108:111], a[172:175], v[226:229]
    ds_read_b64_tr_b16 a[98:99], v21 offset:53824
    v_cmp_gt_u32 vcc, 64, v0
    v_mfma_f32_16x16x32_bf16 v[222:225], a[108:111], a[168:171], v[222:225]
    v_lshlrev_b32 v40, 11, v0
    s_bfe_u32 s55, s2, 0x40003
    v_mfma_f32_16x16x32_bf16 v[218:221], a[108:111], a[164:167], v[218:221]
    s_mul_i32 s55, s55, 131072
    s_lshr_b32 s56, s2, 7
    s_lshl_b32 s56, s56, 10
    s_waitcnt lgkmcnt(6)
    v_mfma_f32_16x16x32_bf16 v[234:237], a[112:115], a[164:167], v[234:237]
    s_add_u32 s55, s55, s56
    ds_read_b64_tr_b16 a[100:101], v21 offset:50272
    s_add_u32 s5, s55, 384
    v_mfma_f32_16x16x32_bf16 v[238:241], a[112:115], a[168:171], v[238:241]
    s_and_b32 s55, s31, 1
    ds_read_b64_tr_b16 a[102:103], v21 offset:53856
    s_mul_i32 s55, s55, 3670016
    v_mfma_f32_16x16x32_bf16 v[242:245], a[112:115], a[172:175], v[242:245]
    s_add_u32 s4, s5, s55
    s_add_u32 s4, s4, 1048576
    v_cndmask_b32 v40, -2.0, v40, vcc
    v_mfma_f32_16x16x32_bf16 v[246:249], a[112:115], a[176:179], v[246:249]
    s_waitcnt lgkmcnt(6)
    v_mfma_f32_16x16x32_bf16 v[138:141], a[88:91], a[180:183], v[138:141]
    ds_read_b64_tr_b16 a[104:105], v21 offset:50304
    v_mfma_f32_16x16x32_bf16 v[142:145], a[88:91], a[184:187], v[142:145]
    ds_read_b64_tr_b16 a[106:107], v21 offset:53888
    v_mfma_f32_16x16x32_bf16 v[146:149], a[88:91], a[188:191], v[146:149]
    v_mfma_f32_16x16x32_bf16 v[150:153], a[88:91], a[192:195], v[150:153]
    s_waitcnt lgkmcnt(6)
    v_mfma_f32_16x16x32_bf16 v[166:169], a[92:95], a[192:195], v[166:169]
    ds_read_b64_tr_b16 a[108:109], v21 offset:50336
    v_mfma_f32_16x16x32_bf16 v[162:165], a[92:95], a[188:191], v[162:165]
    ds_read_b64_tr_b16 a[110:111], v21 offset:53920
    v_mfma_f32_16x16x32_bf16 v[158:161], a[92:95], a[184:187], v[158:161]
    v_mfma_f32_16x16x32_bf16 v[154:157], a[92:95], a[180:183], v[154:157]
    s_waitcnt lgkmcnt(6)
    v_mfma_f32_16x16x32_bf16 v[170:173], a[96:99], a[180:183], v[170:173]
    ds_read_b64_tr_b16 a[112:113], v21 offset:50368
    v_mfma_f32_16x16x32_bf16 v[174:177], a[96:99], a[184:187], v[174:177]
    ds_read_b64_tr_b16 a[114:115], v21 offset:53952
    v_mfma_f32_16x16x32_bf16 v[178:181], a[96:99], a[188:191], v[178:181]
    v_mfma_f32_16x16x32_bf16 v[182:185], a[96:99], a[192:195], v[182:185]
    s_waitcnt lgkmcnt(6)
    v_mfma_f32_16x16x32_bf16 v[198:201], a[100:103], a[192:195], v[198:201]
    v_mfma_f32_16x16x32_bf16 v[194:197], a[100:103], a[188:191], v[194:197]
    v_mfma_f32_16x16x32_bf16 v[190:193], a[100:103], a[184:187], v[190:193]
    v_mfma_f32_16x16x32_bf16 v[186:189], a[100:103], a[180:183], v[186:189]
    s_waitcnt lgkmcnt(4)
    v_mfma_f32_16x16x32_bf16 v[202:205], a[104:107], a[180:183], v[202:205]
    v_mfma_f32_16x16x32_bf16 v[206:209], a[104:107], a[184:187], v[206:209]
    v_mfma_f32_16x16x32_bf16 v[210:213], a[104:107], a[188:191], v[210:213]
    v_mfma_f32_16x16x32_bf16 v[214:217], a[104:107], a[192:195], v[214:217]
    s_waitcnt lgkmcnt(2)
    v_mfma_f32_16x16x32_bf16 v[230:233], a[108:111], a[192:195], v[230:233]
    v_mfma_f32_16x16x32_bf16 v[226:229], a[108:111], a[188:191], v[226:229]
    v_mfma_f32_16x16x32_bf16 v[222:225], a[108:111], a[184:187], v[222:225]
    v_mfma_f32_16x16x32_bf16 v[218:221], a[108:111], a[180:183], v[218:221]
    s_waitcnt lgkmcnt(0)
    v_mfma_f32_16x16x32_bf16 v[234:237], a[112:115], a[180:183], v[234:237]
    v_mfma_f32_16x16x32_bf16 v[238:241], a[112:115], a[184:187], v[238:241]
    v_mfma_f32_16x16x32_bf16 v[242:245], a[112:115], a[188:191], v[242:245]
    v_mfma_f32_16x16x32_bf16 v[246:249], a[112:115], a[192:195], v[246:249]
    s_nop 7
    v_pk_mul_f32 v[48:49], v[138:139], v[138:139]
    v_pk_mul_f32 v[50:51], v[140:141], v[140:141]
    v_pk_mul_f32 v[52:53], v[154:155], v[154:155]
    v_pk_mul_f32 v[54:55], v[156:157], v[156:157]
    v_pk_fma_f32 v[48:49], v[48:49], v[42:43], v[44:45]
    v_pk_fma_f32 v[50:51], v[50:51], v[42:43], v[44:45]
    v_pk_fma_f32 v[52:53], v[52:53], v[42:43], v[44:45]
    v_pk_fma_f32 v[54:55], v[54:55], v[42:43], v[44:45]
    v_pk_mul_f32 v[48:49], v[48:49], v[138:139]
    v_pk_mul_f32 v[50:51], v[50:51], v[140:141]
    v_pk_mul_f32 v[52:53], v[52:53], v[154:155]
    v_pk_mul_f32 v[54:55], v[54:55], v[156:157]
    v_exp_f32 v48, v48
    v_exp_f32 v49, v49
    v_exp_f32 v50, v50
    v_exp_f32 v51, v51
    v_exp_f32 v52, v52
    v_exp_f32 v53, v53
    v_exp_f32 v54, v54
    v_exp_f32 v55, v55
    v_pk_add_f32 v[48:49], v[48:49], v[46:47]
    v_pk_add_f32 v[50:51], v[50:51], v[46:47]
    v_pk_add_f32 v[52:53], v[52:53], v[46:47]
    v_pk_add_f32 v[54:55], v[54:55], v[46:47]
    v_rcp_f32 v48, v48
    v_rcp_f32 v49, v49
    v_rcp_f32 v50, v50
    v_rcp_f32 v51, v51
    v_rcp_f32 v52, v52
    v_rcp_f32 v53, v53
    v_rcp_f32 v54, v54
    v_rcp_f32 v55, v55
    v_pk_mul_f32 v[48:49], v[48:49], v[138:139]
    v_pk_mul_f32 v[50:51], v[50:51], v[140:141]
    v_pk_mul_f32 v[52:53], v[52:53], v[154:155]
    v_pk_mul_f32 v[54:55], v[54:55], v[156:157]
    v_cvt_pk_bf16_f32 v56, v48, v49
    v_cvt_pk_bf16_f32 v57, v50, v51
    v_cvt_pk_bf16_f32 v58, v52, v53
    v_cvt_pk_bf16_f32 v59, v54, v55
    ds_write_b128 v28, v[56:59] offset:0
    v_pk_mul_f32 v[48:49], v[142:143], v[142:143]
    v_pk_mul_f32 v[50:51], v[144:145], v[144:145]
    v_pk_mul_f32 v[52:53], v[158:159], v[158:159]
    v_pk_mul_f32 v[54:55], v[160:161], v[160:161]
    v_pk_fma_f32 v[48:49], v[48:49], v[42:43], v[44:45]
    v_pk_fma_f32 v[50:51], v[50:51], v[42:43], v[44:45]
    v_pk_fma_f32 v[52:53], v[52:53], v[42:43], v[44:45]
    v_pk_fma_f32 v[54:55], v[54:55], v[42:43], v[44:45]
    v_pk_mul_f32 v[48:49], v[48:49], v[142:143]
    v_pk_mul_f32 v[50:51], v[50:51], v[144:145]
    v_pk_mul_f32 v[52:53], v[52:53], v[158:159]
    v_pk_mul_f32 v[54:55], v[54:55], v[160:161]
    v_exp_f32 v48, v48
    v_exp_f32 v49, v49
    v_exp_f32 v50, v50
    v_exp_f32 v51, v51
    v_exp_f32 v52, v52
    v_exp_f32 v53, v53
    v_exp_f32 v54, v54
    v_exp_f32 v55, v55
    v_pk_add_f32 v[48:49], v[48:49], v[46:47]
    v_pk_add_f32 v[50:51], v[50:51], v[46:47]
    v_pk_add_f32 v[52:53], v[52:53], v[46:47]
    v_pk_add_f32 v[54:55], v[54:55], v[46:47]
    v_rcp_f32 v48, v48
    v_rcp_f32 v49, v49
    v_rcp_f32 v50, v50
    v_rcp_f32 v51, v51
    v_rcp_f32 v52, v52
    v_rcp_f32 v53, v53
    v_rcp_f32 v54, v54
    v_rcp_f32 v55, v55
    v_pk_mul_f32 v[48:49], v[48:49], v[142:143]
    v_pk_mul_f32 v[50:51], v[50:51], v[144:145]
    v_pk_mul_f32 v[52:53], v[52:53], v[158:159]
    v_pk_mul_f32 v[54:55], v[54:55], v[160:161]
    v_cvt_pk_bf16_f32 v60, v48, v49
    v_cvt_pk_bf16_f32 v61, v50, v51
    v_cvt_pk_bf16_f32 v62, v52, v53
    v_cvt_pk_bf16_f32 v63, v54, v55
    ds_write_b128 v28, v[60:63] offset:3584
    v_pk_mul_f32 v[48:49], v[146:147], v[146:147]
    v_pk_mul_f32 v[50:51], v[148:149], v[148:149]
    v_pk_mul_f32 v[52:53], v[162:163], v[162:163]
    v_pk_mul_f32 v[54:55], v[164:165], v[164:165]
    v_pk_fma_f32 v[48:49], v[48:49], v[42:43], v[44:45]
    v_pk_fma_f32 v[50:51], v[50:51], v[42:43], v[44:45]
    v_pk_fma_f32 v[52:53], v[52:53], v[42:43], v[44:45]
    v_pk_fma_f32 v[54:55], v[54:55], v[42:43], v[44:45]
    v_pk_mul_f32 v[48:49], v[48:49], v[146:147]
    v_pk_mul_f32 v[50:51], v[50:51], v[148:149]
    v_pk_mul_f32 v[52:53], v[52:53], v[162:163]
    v_pk_mul_f32 v[54:55], v[54:55], v[164:165]
    v_exp_f32 v48, v48
    v_exp_f32 v49, v49
    v_exp_f32 v50, v50
    v_exp_f32 v51, v51
    v_exp_f32 v52, v52
    v_exp_f32 v53, v53
    v_exp_f32 v54, v54
    v_exp_f32 v55, v55
    v_pk_add_f32 v[48:49], v[48:49], v[46:47]
    v_pk_add_f32 v[50:51], v[50:51], v[46:47]
    v_pk_add_f32 v[52:53], v[52:53], v[46:47]
    v_pk_add_f32 v[54:55], v[54:55], v[46:47]
    v_rcp_f32 v48, v48
    v_rcp_f32 v49, v49
    v_rcp_f32 v50, v50
    v_rcp_f32 v51, v51
    v_rcp_f32 v52, v52
    v_rcp_f32 v53, v53
    v_rcp_f32 v54, v54
    v_rcp_f32 v55, v55
    v_pk_mul_f32 v[48:49], v[48:49], v[146:147]
    v_pk_mul_f32 v[50:51], v[50:51], v[148:149]
    v_pk_mul_f32 v[52:53], v[52:53], v[162:163]
    v_pk_mul_f32 v[54:55], v[54:55], v[164:165]
    v_cvt_pk_bf16_f32 v56, v48, v49
    v_cvt_pk_bf16_f32 v57, v50, v51
    v_cvt_pk_bf16_f32 v58, v52, v53
    v_cvt_pk_bf16_f32 v59, v54, v55
    ds_write_b128 v28, v[56:59] offset:7168
    v_pk_mul_f32 v[48:49], v[150:151], v[150:151]
    v_pk_mul_f32 v[50:51], v[152:153], v[152:153]
    v_pk_mul_f32 v[52:53], v[166:167], v[166:167]
    v_pk_mul_f32 v[54:55], v[168:169], v[168:169]
    v_pk_fma_f32 v[48:49], v[48:49], v[42:43], v[44:45]
    v_pk_fma_f32 v[50:51], v[50:51], v[42:43], v[44:45]
    v_pk_fma_f32 v[52:53], v[52:53], v[42:43], v[44:45]
    v_pk_fma_f32 v[54:55], v[54:55], v[42:43], v[44:45]
    v_pk_mul_f32 v[48:49], v[48:49], v[150:151]
    v_pk_mul_f32 v[50:51], v[50:51], v[152:153]
    v_pk_mul_f32 v[52:53], v[52:53], v[166:167]
    v_pk_mul_f32 v[54:55], v[54:55], v[168:169]
    v_exp_f32 v48, v48
    v_exp_f32 v49, v49
    v_exp_f32 v50, v50
    v_exp_f32 v51, v51
    v_exp_f32 v52, v52
    v_exp_f32 v53, v53
    v_exp_f32 v54, v54
    v_exp_f32 v55, v55
    v_pk_add_f32 v[48:49], v[48:49], v[46:47]
    v_pk_add_f32 v[50:51], v[50:51], v[46:47]
    v_pk_add_f32 v[52:53], v[52:53], v[46:47]
    v_pk_add_f32 v[54:55], v[54:55], v[46:47]
    v_rcp_f32 v48, v48
    v_rcp_f32 v49, v49
    v_rcp_f32 v50, v50
    v_rcp_f32 v51, v51
    v_rcp_f32 v52, v52
    v_rcp_f32 v53, v53
    v_rcp_f32 v54, v54
    v_rcp_f32 v55, v55
    v_pk_mul_f32 v[48:49], v[48:49], v[150:151]
    v_pk_mul_f32 v[50:51], v[50:51], v[152:153]
    v_pk_mul_f32 v[52:53], v[52:53], v[166:167]
    v_pk_mul_f32 v[54:55], v[54:55], v[168:169]
    v_cvt_pk_bf16_f32 v60, v48, v49
    v_cvt_pk_bf16_f32 v61, v50, v51
    v_cvt_pk_bf16_f32 v62, v52, v53
    v_cvt_pk_bf16_f32 v63, v54, v55
    ds_write_b128 v28, v[60:63] offset:10752
    v_pk_mul_f32 v[48:49], v[170:171], v[170:171]
    v_pk_mul_f32 v[50:51], v[172:173], v[172:173]
    v_pk_mul_f32 v[52:53], v[186:187], v[186:187]
    v_pk_mul_f32 v[54:55], v[188:189], v[188:189]
    v_pk_fma_f32 v[48:49], v[48:49], v[42:43], v[44:45]
    v_pk_fma_f32 v[50:51], v[50:51], v[42:43], v[44:45]
    v_pk_fma_f32 v[52:53], v[52:53], v[42:43], v[44:45]
    v_pk_fma_f32 v[54:55], v[54:55], v[42:43], v[44:45]
    v_pk_mul_f32 v[48:49], v[48:49], v[170:171]
    v_pk_mul_f32 v[50:51], v[50:51], v[172:173]
    v_pk_mul_f32 v[52:53], v[52:53], v[186:187]
    v_pk_mul_f32 v[54:55], v[54:55], v[188:189]
    v_exp_f32 v48, v48
    v_exp_f32 v49, v49
    v_exp_f32 v50, v50
    v_exp_f32 v51, v51
    v_exp_f32 v52, v52
    v_exp_f32 v53, v53
    v_exp_f32 v54, v54
    v_exp_f32 v55, v55
    v_pk_add_f32 v[48:49], v[48:49], v[46:47]
    v_pk_add_f32 v[50:51], v[50:51], v[46:47]
    v_pk_add_f32 v[52:53], v[52:53], v[46:47]
    v_pk_add_f32 v[54:55], v[54:55], v[46:47]
    v_rcp_f32 v48, v48
    v_rcp_f32 v49, v49
    v_rcp_f32 v50, v50
    v_rcp_f32 v51, v51
    v_rcp_f32 v52, v52
    v_rcp_f32 v53, v53
    v_rcp_f32 v54, v54
    v_rcp_f32 v55, v55
    v_pk_mul_f32 v[48:49], v[48:49], v[170:171]
    v_pk_mul_f32 v[50:51], v[50:51], v[172:173]
    v_pk_mul_f32 v[52:53], v[52:53], v[186:187]
    v_pk_mul_f32 v[54:55], v[54:55], v[188:189]
    v_cvt_pk_bf16_f32 v56, v48, v49
    v_cvt_pk_bf16_f32 v57, v50, v51
    v_cvt_pk_bf16_f32 v58, v52, v53
    v_cvt_pk_bf16_f32 v59, v54, v55
    ds_write_b128 v28, v[56:59] offset:1024
    buffer_load_dwordx2 v[8:9], v7, s[16:19], s66 offen sc1
    v_pk_mul_f32 v[48:49], v[174:175], v[174:175]
    v_pk_mul_f32 v[50:51], v[176:177], v[176:177]
    v_pk_mul_f32 v[52:53], v[190:191], v[190:191]
    v_pk_mul_f32 v[54:55], v[192:193], v[192:193]
    v_pk_fma_f32 v[48:49], v[48:49], v[42:43], v[44:45]
    v_pk_fma_f32 v[50:51], v[50:51], v[42:43], v[44:45]
    v_pk_fma_f32 v[52:53], v[52:53], v[42:43], v[44:45]
    v_pk_fma_f32 v[54:55], v[54:55], v[42:43], v[44:45]
    v_pk_mul_f32 v[48:49], v[48:49], v[174:175]
    v_pk_mul_f32 v[50:51], v[50:51], v[176:177]
    v_pk_mul_f32 v[52:53], v[52:53], v[190:191]
    v_pk_mul_f32 v[54:55], v[54:55], v[192:193]
    v_exp_f32 v48, v48
    v_exp_f32 v49, v49
    v_exp_f32 v50, v50
    v_exp_f32 v51, v51
    v_exp_f32 v52, v52
    v_exp_f32 v53, v53
    v_exp_f32 v54, v54
    v_exp_f32 v55, v55
    v_pk_add_f32 v[48:49], v[48:49], v[46:47]
    v_pk_add_f32 v[50:51], v[50:51], v[46:47]
    v_pk_add_f32 v[52:53], v[52:53], v[46:47]
    v_pk_add_f32 v[54:55], v[54:55], v[46:47]
    v_rcp_f32 v48, v48
    v_rcp_f32 v49, v49
    v_rcp_f32 v50, v50
    v_rcp_f32 v51, v51
    v_rcp_f32 v52, v52
    v_rcp_f32 v53, v53
    v_rcp_f32 v54, v54
    v_rcp_f32 v55, v55
    v_pk_mul_f32 v[48:49], v[48:49], v[174:175]
    v_pk_mul_f32 v[50:51], v[50:51], v[176:177]
    v_pk_mul_f32 v[52:53], v[52:53], v[190:191]
    v_pk_mul_f32 v[54:55], v[54:55], v[192:193]
    v_cvt_pk_bf16_f32 v60, v48, v49
    v_cvt_pk_bf16_f32 v61, v50, v51
    v_cvt_pk_bf16_f32 v62, v52, v53
    v_cvt_pk_bf16_f32 v63, v54, v55
    ds_write_b128 v28, v[60:63] offset:4608
    v_pk_mul_f32 v[48:49], v[178:179], v[178:179]
    v_pk_mul_f32 v[50:51], v[180:181], v[180:181]
    v_pk_mul_f32 v[52:53], v[194:195], v[194:195]
    v_pk_mul_f32 v[54:55], v[196:197], v[196:197]
    v_pk_fma_f32 v[48:49], v[48:49], v[42:43], v[44:45]
    v_pk_fma_f32 v[50:51], v[50:51], v[42:43], v[44:45]
    v_pk_fma_f32 v[52:53], v[52:53], v[42:43], v[44:45]
    v_pk_fma_f32 v[54:55], v[54:55], v[42:43], v[44:45]
    v_pk_mul_f32 v[48:49], v[48:49], v[178:179]
    v_pk_mul_f32 v[50:51], v[50:51], v[180:181]
    v_pk_mul_f32 v[52:53], v[52:53], v[194:195]
    v_pk_mul_f32 v[54:55], v[54:55], v[196:197]
    v_exp_f32 v48, v48
    v_exp_f32 v49, v49
    v_exp_f32 v50, v50
    v_exp_f32 v51, v51
    v_exp_f32 v52, v52
    v_exp_f32 v53, v53
    v_exp_f32 v54, v54
    v_exp_f32 v55, v55
    v_pk_add_f32 v[48:49], v[48:49], v[46:47]
    v_pk_add_f32 v[50:51], v[50:51], v[46:47]
    v_pk_add_f32 v[52:53], v[52:53], v[46:47]
    v_pk_add_f32 v[54:55], v[54:55], v[46:47]
    v_rcp_f32 v48, v48
    v_rcp_f32 v49, v49
    v_rcp_f32 v50, v50
    v_rcp_f32 v51, v51
    v_rcp_f32 v52, v52
    v_rcp_f32 v53, v53
    v_rcp_f32 v54, v54
    v_rcp_f32 v55, v55
    v_pk_mul_f32 v[48:49], v[48:49], v[178:179]
    v_pk_mul_f32 v[50:51], v[50:51], v[180:181]
    v_pk_mul_f32 v[52:53], v[52:53], v[194:195]
    v_pk_mul_f32 v[54:55], v[54:55], v[196:197]
    v_cvt_pk_bf16_f32 v56, v48, v49
    v_cvt_pk_bf16_f32 v57, v50, v51
    v_cvt_pk_bf16_f32 v58, v52, v53
    v_cvt_pk_bf16_f32 v59, v54, v55
    ds_write_b128 v28, v[56:59] offset:8192
    v_pk_mul_f32 v[48:49], v[182:183], v[182:183]
    v_pk_mul_f32 v[50:51], v[184:185], v[184:185]
    v_pk_mul_f32 v[52:53], v[198:199], v[198:199]
    v_pk_mul_f32 v[54:55], v[200:201], v[200:201]
    v_pk_fma_f32 v[48:49], v[48:49], v[42:43], v[44:45]
    v_pk_fma_f32 v[50:51], v[50:51], v[42:43], v[44:45]
    v_pk_fma_f32 v[52:53], v[52:53], v[42:43], v[44:45]
    v_pk_fma_f32 v[54:55], v[54:55], v[42:43], v[44:45]
    v_pk_mul_f32 v[48:49], v[48:49], v[182:183]
    v_pk_mul_f32 v[50:51], v[50:51], v[184:185]
    v_pk_mul_f32 v[52:53], v[52:53], v[198:199]
    v_pk_mul_f32 v[54:55], v[54:55], v[200:201]
    v_exp_f32 v48, v48
    v_exp_f32 v49, v49
    v_exp_f32 v50, v50
    v_exp_f32 v51, v51
    v_exp_f32 v52, v52
    v_exp_f32 v53, v53
    v_exp_f32 v54, v54
    v_exp_f32 v55, v55
    v_pk_add_f32 v[48:49], v[48:49], v[46:47]
    v_pk_add_f32 v[50:51], v[50:51], v[46:47]
    v_pk_add_f32 v[52:53], v[52:53], v[46:47]
    v_pk_add_f32 v[54:55], v[54:55], v[46:47]
    v_rcp_f32 v48, v48
    v_rcp_f32 v49, v49
    v_rcp_f32 v50, v50
    v_rcp_f32 v51, v51
    v_rcp_f32 v52, v52
    v_rcp_f32 v53, v53
    v_rcp_f32 v54, v54
    v_rcp_f32 v55, v55
    v_pk_mul_f32 v[48:49], v[48:49], v[182:183]
    v_pk_mul_f32 v[50:51], v[50:51], v[184:185]
    v_pk_mul_f32 v[52:53], v[52:53], v[198:199]
    v_pk_mul_f32 v[54:55], v[54:55], v[200:201]
    v_cvt_pk_bf16_f32 v60, v48, v49
    v_cvt_pk_bf16_f32 v61, v50, v51
    v_cvt_pk_bf16_f32 v62, v52, v53
    v_cvt_pk_bf16_f32 v63, v54, v55
    ds_write_b128 v28, v[60:63] offset:11776
    s_waitcnt vmcnt(0)
    v_cmp_ne_u32 vcc, s52, v8
    v_cmp_ne_u32 s[64:65], s53, v9
    s_nop 1
    s_or_b64 s[64:65], vcc, s[64:65]
    s_and_b32 s64, s64, 0xffffff
    s_cbranch_scc1 L_qkv_slow
L_qkv_ok:
    buffer_load_dwordx4 v[64:67], v252, s[16:19], s75 offen offset:0 sc1
    buffer_load_dwordx4 v[68:71], v252, s[16:19], s75 offen offset:1024 sc1
    buffer_load_dwordx4 v[72:75], v252, s[16:19], s75 offen offset:2048 sc1
    buffer_load_dwordx4 v[76:79], v252, s[16:19], s75 offen offset:3072 sc1
    buffer_load_dwordx4 v[12:15], v252, s[16:19], s70 offen offset:0 sc1
    buffer_load_dwordx4 v[16:19], v252, s[16:19], s70 offen offset:1024 sc1
    s_mov_b32 s42, s70
    s_mov_b32 s43, s71
    v_pk_mul_f32 v[48:49], v[202:203], v[202:203]
    v_pk_mul_f32 v[50:51], v[204:205], v[204:205]
    v_pk_mul_f32 v[52:53], v[218:219], v[218:219]
    v_pk_mul_f32 v[54:55], v[220:221], v[220:221]
    v_pk_fma_f32 v[48:49], v[48:49], v[42:43], v[44:45]
    v_pk_fma_f32 v[50:51], v[50:51], v[42:43], v[44:45]
    v_pk_fma_f32 v[52:53], v[52:53], v[42:43], v[44:45]
    v_pk_fma_f32 v[54:55], v[54:55], v[42:43], v[44:45]
    v_pk_mul_f32 v[48:49], v[48:49], v[202:203]
    v_pk_mul_f32 v[50:51], v[50:51], v[204:205]
    v_pk_mul_f32 v[52:53], v[52:53], v[218:219]
    v_pk_mul_f32 v[54:55], v[54:55], v[220:221]
    v_exp_f32 v48, v48
    v_exp_f32 v49, v49
    v_exp_f32 v50, v50
    v_exp_f32 v51, v51
    v_exp_f32 v52, v52
    v_exp_f32 v53, v53
    v_exp_f32 v54, v54
    v_exp_f32 v55, v55
    v_pk_add_f32 v[48:49], v[48:49], v[46:47]
    v_pk_add_f32 v[50:51], v[50:51], v[46:47]
    v_pk_add_f32 v[52:53], v[52:53], v[46:47]
    v_pk_add_f32 v[54:55], v[54:55], v[46:47]
    v_rcp_f32 v48, v48
    v_rcp_f32 v49, v49
    v_rcp_f32 v50, v50
    v_rcp_f32 v51, v51
    v_rcp_f32 v52, v52
    v_rcp_f32 v53, v53
    v_rcp_f32 v54, v54
    v_rcp_f32 v55, v55
    v_pk_mul_f32 v[48:49], v[48:49], v[202:203]
    v_pk_mul_f32 v[50:51], v[50:51], v[204:205]
    v_pk_mul_f32 v[52:53], v[52:53], v[218:219]
    v_pk_mul_f32 v[54:55], v[54:55], v[220:221]
    v_cvt_pk_bf16_f32 v56, v48, v49
    v_cvt_pk_bf16_f32 v57, v50, v51
    v_cvt_pk_bf16_f32 v58, v52, v53
    v_cvt_pk_bf16_f32 v59, v54, v55
    ds_write_b128 v28, v[56:59] offset:2048
    s_add_u32 m0, s38, 131072
    s_nop 0
    buffer_load_dwordx4 v253, s[16:19], s42 offen sc1 lds
    s_add_u32 m0, s38, 135168
    s_nop 0
    buffer_load_dwordx4 v33, s[16:19], s42 offen sc1 lds
    s_add_u32 m0, s38, 139264
    s_nop 0
    buffer_load_dwordx4 v253, s[16:19], s43 offen sc1 lds
    s_add_u32 m0, s38, 143360
    s_nop 0
    buffer_load_dwordx4 v33, s[16:19], s43 offen sc1 lds
    s_add_u32 s42, s42, 8192
    s_add_u32 s43, s43, 8192
    v_pk_mul_f32 v[48:49], v[206:207], v[206:207]
    v_pk_mul_f32 v[50:51], v[208:209], v[208:209]
    v_pk_mul_f32 v[52:53], v[222:223], v[222:223]
    v_pk_mul_f32 v[54:55], v[224:225], v[224:225]
    v_pk_fma_f32 v[48:49], v[48:49], v[42:43], v[44:45]
    v_pk_fma_f32 v[50:51], v[50:51], v[42:43], v[44:45]
    v_pk_fma_f32 v[52:53], v[52:53], v[42:43], v[44:45]
    v_pk_fma_f32 v[54:55], v[54:55], v[42:43], v[44:45]
    v_pk_mul_f32 v[48:49], v[48:49], v[206:207]
    v_pk_mul_f32 v[50:51], v[50:51], v[208:209]
    v_pk_mul_f32 v[52:53], v[52:53], v[222:223]
    v_pk_mul_f32 v[54:55], v[54:55], v[224:225]
    v_exp_f32 v48, v48
    v_exp_f32 v49, v49
    v_exp_f32 v50, v50
    v_exp_f32 v51, v51
    v_exp_f32 v52, v52
    v_exp_f32 v53, v53
    v_exp_f32 v54, v54
    v_exp_f32 v55, v55
    v_pk_add_f32 v[48:49], v[48:49], v[46:47]
    v_pk_add_f32 v[50:51], v[50:51], v[46:47]
    v_pk_add_f32 v[52:53], v[52:53], v[46:47]
    v_pk_add_f32 v[54:55], v[54:55], v[46:47]
    v_rcp_f32 v48, v48
    v_rcp_f32 v49, v49
    v_rcp_f32 v50, v50
    v_rcp_f32 v51, v51
    v_rcp_f32 v52, v52
    v_rcp_f32 v53, v53
    v_rcp_f32 v54, v54
    v_rcp_f32 v55, v55
    v_pk_mul_f32 v[48:49], v[48:49], v[206:207]
    v_pk_mul_f32 v[50:51], v[50:51], v[208:209]
    v_pk_mul_f32 v[52:53], v[52:53], v[222:223]
    v_pk_mul_f32 v[54:55], v[54:55], v[224:225]
    v_cvt_pk_bf16_f32 v60, v48, v49
    v_cvt_pk_bf16_f32 v61, v50, v51
    v_cvt_pk_bf16_f32 v62, v52, v53
    v_cvt_pk_bf16_f32 v63, v54, v55
    ds_write_b128 v28, v[60:63] offset:5632
    v_pk_mul_f32 v[48:49], v[210:211], v[210:211]
    v_pk_mul_f32 v[50:51], v[212:213], v[212:213]
    v_pk_mul_f32 v[52:53], v[226:227], v[226:227]
    v_pk_mul_f32 v[54:55], v[228:229], v[228:229]
    v_pk_fma_f32 v[48:49], v[48:49], v[42:43], v[44:45]
    v_pk_fma_f32 v[50:51], v[50:51], v[42:43], v[44:45]
    v_pk_fma_f32 v[52:53], v[52:53], v[42:43], v[44:45]
    v_pk_fma_f32 v[54:55], v[54:55], v[42:43], v[44:45]
    v_pk_mul_f32 v[48:49], v[48:49], v[210:211]
    v_pk_mul_f32 v[50:51], v[50:51], v[212:213]
    v_pk_mul_f32 v[52:53], v[52:53], v[226:227]
    v_pk_mul_f32 v[54:55], v[54:55], v[228:229]
    v_exp_f32 v48, v48
    v_exp_f32 v49, v49
    v_exp_f32 v50, v50
    v_exp_f32 v51, v51
    v_exp_f32 v52, v52
    v_exp_f32 v53, v53
    v_exp_f32 v54, v54
    v_exp_f32 v55, v55
    v_pk_add_f32 v[48:49], v[48:49], v[46:47]
    v_pk_add_f32 v[50:51], v[50:51], v[46:47]
    v_pk_add_f32 v[52:53], v[52:53], v[46:47]
    v_pk_add_f32 v[54:55], v[54:55], v[46:47]
    v_rcp_f32 v48, v48
    v_rcp_f32 v49, v49
    v_rcp_f32 v50, v50
    v_rcp_f32 v51, v51
    v_rcp_f32 v52, v52
    v_rcp_f32 v53, v53
    v_rcp_f32 v54, v54
    v_rcp_f32 v55, v55
    v_pk_mul_f32 v[48:49], v[48:49], v[210:211]
    v_pk_mul_f32 v[50:51], v[50:51], v[212:213]
    v_pk_mul_f32 v[52:53], v[52:53], v[226:227]
    v_pk_mul_f32 v[54:55], v[54:55], v[228:229]
    v_cvt_pk_bf16_f32 v56, v48, v49
    v_cvt_pk_bf16_f32 v57, v50, v51
    v_cvt_pk_bf16_f32 v58, v52, v53
    v_cvt_pk_bf16_f32 v59, v54, v55
    ds_write_b128 v28, v[56:59] offset:9216
    v_pk_mul_f32 v[48:49], v[214:215], v[214:215]
    v_pk_mul_f32 v[50:51], v[216:217], v[216:217]
    v_pk_mul_f32 v[52:53], v[230:231], v[230:231]
    v_pk_mul_f32 v[54:55], v[232:233], v[232:233]
    v_pk_fma_f32 v[48:49], v[48:49], v[42:43], v[44:45]
    v_pk_fma_f32 v[50:51], v[50:51], v[42:43], v[44:45]
    v_pk_fma_f32 v[52:53], v[52:53], v[42:43], v[44:45]
    v_pk_fma_f32 v[54:55], v[54:55], v[42:43], v[44:45]
    v_pk_mul_f32 v[48:49], v[48:49], v[214:215]
    v_pk_mul_f32 v[50:51], v[50:51], v[216:217]
    v_pk_mul_f32 v[52:53], v[52:53], v[230:231]
    v_pk_mul_f32 v[54:55], v[54:55], v[232:233]
    v_exp_f32 v48, v48
    v_exp_f32 v49, v49
    v_exp_f32 v50, v50
    v_exp_f32 v51, v51
    v_exp_f32 v52, v52
    v_exp_f32 v53, v53
    v_exp_f32 v54, v54
    v_exp_f32 v55, v55
    v_pk_add_f32 v[48:49], v[48:49], v[46:47]
    v_pk_add_f32 v[50:51], v[50:51], v[46:47]
    v_pk_add_f32 v[52:53], v[52:53], v[46:47]
    v_pk_add_f32 v[54:55], v[54:55], v[46:47]
    v_rcp_f32 v48, v48
    v_rcp_f32 v49, v49
    v_rcp_f32 v50, v50
    v_rcp_f32 v51, v51
    v_rcp_f32 v52, v52
    v_rcp_f32 v53, v53
    v_rcp_f32 v54, v54
    v_rcp_f32 v55, v55
    v_pk_mul_f32 v[48:49], v[48:49], v[214:215]
    v_pk_mul_f32 v[50:51], v[50:51], v[216:217]
    v_pk_mul_f32 v[52:53], v[52:53], v[230:231]
    v_pk_mul_f32 v[54:55], v[54:55], v[232:233]
    v_cvt_pk_bf16_f32 v60, v48, v49
    v_cvt_pk_bf16_f32 v61, v50, v51
    v_cvt_pk_bf16_f32 v62, v52, v53
    v_cvt_pk_bf16_f32 v63, v54, v55
    ds_write_b128 v28, v[60:63] offset:12800
    s_add_u32 m0, s38, 114688
    s_nop 0
    buffer_load_dwordx4 v253, s[16:19], s42 offen sc1 lds
    s_add_u32 m0, s38, 118784
    s_nop 0
    buffer_load_dwordx4 v33, s[16:19], s42 offen sc1 lds
    s_add_u32 m0, s38, 122880
    s_nop 0
    buffer_load_dwordx4 v253, s[16:19], s43 offen sc1 lds
    s_add_u32 m0, s38, 126976
    s_nop 0
    buffer_load_dwordx4 v33, s[16:19], s43 offen sc1 lds
    s_add_u32 s42, s42, 8192
    s_add_u32 s43, s43, 8192
    s_waitcnt vmcnt(8)
    v_mfma_f32_32x32x16_bf16 v[112:127], v[12:15], v[64:67], 0
    v_pk_mul_f32 v[48:49], v[234:235], v[234:235]
    v_pk_mul_f32 v[50:51], v[236:237], v[236:237]
    v_pk_mul_f32 v[52:53], v[238:239], v[238:239]
    v_pk_mul_f32 v[54:55], v[240:241], v[240:241]
    v_pk_fma_f32 v[48:49], v[48:49], v[42:43], v[44:45]
    v_pk_fma_f32 v[50:51], v[50:51], v[42:43], v[44:45]
    v_mfma_f32_32x32x16_bf16 v[112:127], v[16:19], v[68:71], v[112:127]
    v_pk_fma_f32 v[52:53], v[52:53], v[42:43], v[44:45]
    v_pk_fma_f32 v[54:55], v[54:55], v[42:43], v[44:45]
    v_pk_mul_f32 v[48:49], v[48:49], v[234:235]
    v_pk_mul_f32 v[50:51], v[50:51], v[236:237]
    v_pk_mul_f32 v[52:53], v[52:53], v[238:239]
    v_pk_mul_f32 v[54:55], v[54:55], v[240:241]
    v_mfma_f32_32x32x16_bf16 v[128:143], v[12:15], v[72:75], 0
    v_exp_f32 v48, v48
    v_exp_f32 v49, v49
    v_exp_f32 v50, v50
    v_exp_f32 v51, v51
    v_exp_f32 v52, v52
    v_exp_f32 v53, v53
    v_mfma_f32_32x32x16_bf16 v[128:143], v[16:19], v[76:79], v[128:143]
    v_exp_f32 v54, v54
    v_exp_f32 v55, v55
    v_pk_add_f32 v[48:49], v[48:49], v[46:47]
    v_pk_add_f32 v[50:51], v[50:51], v[46:47]
    v_pk_add_f32 v[52:53], v[52:53], v[46:47]
    v_pk_add_f32 v[54:55], v[54:55], v[46:47]
    v_rcp_f32 v48, v48
    v_rcp_f32 v49, v49
    v_rcp_f32 v50, v50
    v_rcp_f32 v51, v51
    v_rcp_f32 v52, v52
    v_rcp_f32 v53, v53
    v_rcp_f32 v54, v54
    v_rcp_f32 v55, v55
    v_pk_mul_f32 v[48:49], v[48:49], v[234:235]
    v_pk_mul_f32 v[50:51], v[50:51], v[236:237]
    v_pk_mul_f32 v[52:53], v[52:53], v[238:239]
    v_pk_mul_f32 v[54:55], v[54:55], v[240:241]
    v_cvt_pk_bf16_f32 v56, v48, v49
    v_cvt_pk_bf16_f32 v57, v50, v51
    v_cvt_pk_bf16_f32 v58, v52, v53
    v_cvt_pk_bf16_f32 v59, v54, v55
    ds_write_b64 v29, v[56:57] offset:3072
    ds_write_b64 v29, v[58:59] offset:6656
    v_max3_f32 v36, v112, v113, v114
    v_max_f32 v36, v36, v127
    v_max3_f32 v36, v36, v115, v116
    v_max3_f32 v36, v36, v117, v118
    v_max3_f32 v36, v36, v119, v120
    v_max3_f32 v36, v36, v121, v122
    v_max3_f32 v36, v36, v123, v124
    v_max3_f32 v36, v36, v125, v126
    v_max3_f32 v37, v128, v129, v130
    v_max_f32 v37, v37, v143
    v_max3_f32 v37, v37, v131, v132
    v_max3_f32 v37, v37, v133, v134
    v_max3_f32 v37, v37, v135, v136
    v_max3_f32 v37, v37, v137, v138
    v_max3_f32 v37, v37, v139, v140
    v_max3_f32 v37, v37, v141, v142
    v_mov_b32 v38, v36
    v_mov_b32 v39, v37
    s_nop 1
    v_permlane32_swap_b32 v36, v38
    v_permlane32_swap_b32 v37, v39
    s_nop 1
    v_max_f32 v36, v36, v38
    v_sub_f32 v80, 0, v36
    v_sub_f32 v81, 0, v36
    v_sub_f32 v82, 0, v36
    v_sub_f32 v83, 0, v36
    v_sub_f32 v84, 0, v36
    v_sub_f32 v85, 0, v36
    v_sub_f32 v86, 0, v36
    v_sub_f32 v87, 0, v36
    v_sub_f32 v88, 0, v36
    v_sub_f32 v89, 0, v36
    v_sub_f32 v90, 0, v36
    v_sub_f32 v91, 0, v36
    v_sub_f32 v92, 0, v36
    v_sub_f32 v93, 0, v36
    v_sub_f32 v94, 0, v36
    v_sub_f32 v95, 0, v36
    v_max_f32 v37, v37, v39
    v_sub_f32 v96, 0, v37
    v_sub_f32 v97, 0, v37
    v_sub_f32 v98, 0, v37
    v_sub_f32 v99, 0, v37
    v_sub_f32 v100, 0, v37
    v_sub_f32 v101, 0, v37
    v_sub_f32 v102, 0, v37
    v_sub_f32 v103, 0, v37
    v_sub_f32 v104, 0, v37
    v_sub_f32 v105, 0, v37
    v_sub_f32 v106, 0, v37
    v_sub_f32 v107, 0, v37
    v_sub_f32 v108, 0, v37
    v_sub_f32 v109, 0, v37
    v_sub_f32 v110, 0, v37
    v_sub_f32 v111, 0, v37
    v_mfma_f32_32x32x16_bf16 v[112:127], v[12:15], v[64:67], v[80:95]
    v_mfma_f32_32x32x16_bf16 v[112:127], v[16:19], v[68:71], v[112:127]
    v_pk_mul_f32 v[48:49], v[242:243], v[242:243]
    v_pk_mul_f32 v[50:51], v[244:245], v[244:245]
    v_pk_mul_f32 v[52:53], v[246:247], v[246:247]
    v_pk_mul_f32 v[54:55], v[248:249], v[248:249]
    v_pk_fma_f32 v[48:49], v[48:49], v[42:43], v[44:45]
    v_pk_fma_f32 v[50:51], v[50:51], v[42:43], v[44:45]
    v_pk_fma_f32 v[52:53], v[52:53], v[42:43], v[44:45]
    v_pk_fma_f32 v[54:55], v[54:55], v[42:43], v[44:45]
    v_pk_mul_f32 v[48:49], v[48:49], v[242:243]
    v_pk_mul_f32 v[50:51], v[50:51], v[244:245]
    v_pk_mul_f32 v[52:53], v[52:53], v[246:247]
    v_pk_mul_f32 v[54:55], v[54:55], v[248:249]
    v_exp_f32 v48, v48
    v_exp_f32 v49, v49
    v_exp_f32 v50, v50
    v_exp_f32 v51, v51
    v_exp_f32 v52, v52
    v_exp_f32 v53, v53
    v_exp_f32 v54, v54
    v_exp_f32 v55, v55
    v_pk_add_f32 v[48:49], v[48:49], v[46:47]
    v_pk_add_f32 v[50:51], v[50:51], v[46:47]
    v_pk_add_f32 v[52:53], v[52:53], v[46:47]
    v_pk_add_f32 v[54:55], v[54:55], v[46:47]
    v_rcp_f32 v48, v48
    v_rcp_f32 v49, v49
    v_rcp_f32 v50, v50
    v_rcp_f32 v51, v51
    v_rcp_f32 v52, v52
    v_rcp_f32 v53, v53
    v_rcp_f32 v54, v54
    v_rcp_f32 v55, v55
    v_pk_mul_f32 v[48:49], v[48:49], v[242:243]
    v_pk_mul_f32 v[50:51], v[50:51], v[244:245]
    v_pk_mul_f32 v[52:53], v[52:53], v[246:247]
    v_pk_mul_f32 v[54:55], v[54:55], v[248:249]
    v_cvt_pk_bf16_f32 v60, v48, v49
    v_cvt_pk_bf16_f32 v61, v50, v51
    v_cvt_pk_bf16_f32 v62, v52, v53
    v_cvt_pk_bf16_f32 v63, v54, v55
    ds_write_b64 v29, v[60:61] offset:10240
    ds_write_b64 v29, v[62:63] offset:13824
L_at_start:
    s_and_b32 s62, s31, 1
    s_mul_i32 s59, s62, 57344
    s_mul_i32 s60, s62, 3670016
    s_lshl_b32 s90, s2, 13
    s_mov_b32 s91, s90

    s_lshr_b32 s64, s2, 3
    v_and_b32 v248, 15, v0
    v_lshl_add_u32 v248, s64, 4, v248
    v_lshlrev_b32 v248, 7, v248
    v_min_u32 v248, L_end-L_pfa, v248
    s_waitcnt vmcnt(4)
    s_barrier
    ds_read_b64_tr_b16 v[220:221], v31 offset:16384
    ds_read_b64_tr_b16 v[222:223], v30 offset:16384
    ds_read_b64_tr_b16 v[224:225], v31 offset:16640
    ds_read_b64_tr_b16 v[226:227], v30 offset:16640
    v_mov_b32 v200, v41
    v_mov_b32 v201, v41
    v_mov_b32 v202, v41
    v_mov_b32 v203, v41
    v_mfma_f32_32x32x16_bf16 v[128:143], v[12:15], v[72:75], v[96:111]
    s_add_u32 m0, s38, 147456
    ds_read_b128 v[212:215], v32 offset:18432
    ds_read_b128 v[216:219], v32 offset:19456
    buffer_load_dwordx4 v253, s[16:19], s42 offen sc1 lds
    v_exp_f32 v112, v112
    v_exp_f32 v113, v113
    v_exp_f32 v114, v114
    v_exp_f32 v115, v115
    v_exp_f32 v116, v116
    v_exp_f32 v117, v117
    v_exp_f32 v118, v118
    v_exp_f32 v119, v119
    v_cvt_pk_bf16_f32 v144, v112, v113
    v_exp_f32 v120, v120
    v_cvt_pk_bf16_f32 v145, v114, v115
    v_mfma_f32_32x32x16_bf16 v[128:143], v[16:19], v[76:79], v[128:143]
    s_waitcnt lgkmcnt(0)
    s_add_u32 m0, s38, 151552
    s_nop 0
    buffer_load_dwordx4 v33, s[16:19], s42 offen sc1 lds
    v_exp_f32 v121, v121
    v_exp_f32 v122, v122
    v_exp_f32 v123, v123
    v_cvt_pk_bf16_f32 v146, v116, v117
    v_cvt_pk_bf16_f32 v147, v118, v119
    v_exp_f32 v124, v124
    v_exp_f32 v125, v125
    v_exp_f32 v126, v126
    v_cvt_pk_bf16_f32 v148, v120, v121
    v_cvt_pk_bf16_f32 v149, v122, v123
    v_exp_f32 v127, v127
    v_cvt_pk_bf16_f32 v150, v124, v125
    v_cvt_pk_bf16_f32 v151, v126, v127
    v_mfma_f32_32x32x16_bf16 v[160:175], v[220:223], v[144:147], 0
    ds_read_b64_tr_b16 v[228:229], v31 offset:18432
    v_exp_f32 v128, v128
    v_exp_f32 v129, v129
    v_exp_f32 v130, v130
    v_exp_f32 v131, v131
    v_mfma_f32_32x32x16_bf16 v[160:175], v[224:227], v[148:151], v[160:175]
    ds_read_b64_tr_b16 v[230:231], v30 offset:18432
    v_exp_f32 v132, v132
    v_exp_f32 v133, v133
    v_exp_f32 v134, v134
    v_exp_f32 v135, v135
    v_mfma_f32_32x32x16_bf16 v[112:127], v[212:215], v[64:67], v[80:95]
    ds_read_b64_tr_b16 v[232:233], v31 offset:18688
    v_cvt_pk_bf16_f32 v152, v128, v129
    v_exp_f32 v136, v136
    v_exp_f32 v137, v137
    v_cvt_pk_bf16_f32 v153, v130, v131
    v_exp_f32 v138, v138
    v_mfma_f32_32x32x16_bf16 v[112:127], v[216:219], v[68:71], v[112:127]
    ds_read_b64_tr_b16 v[234:235], v30 offset:18688
    v_exp_f32 v139, v139
    v_cvt_pk_bf16_f32 v154, v132, v133
    v_exp_f32 v140, v140
    v_exp_f32 v141, v141
    v_cvt_pk_bf16_f32 v155, v134, v135
    v_mfma_f32_16x16x32_bf16 v[192:195], v[200:203], v[144:147], 0
    v_exp_f32 v142, v142
    v_cvt_pk_bf16_f32 v156, v136, v137
    v_cvt_pk_bf16_f32 v157, v138, v139
    v_mfma_f32_16x16x32_bf16 v[192:195], v[200:203], v[148:151], v[192:195]
    v_exp_f32 v143, v143
    v_cvt_pk_bf16_f32 v158, v140, v141
    v_cvt_pk_bf16_f32 v159, v142, v143
    v_mfma_f32_32x32x16_bf16 v[176:191], v[220:223], v[152:155], 0
    s_add_u32 m0, s38, 155648
    ds_read_b128 v[204:207], v32 offset:20480
    v_exp_f32 v112, v112
    v_exp_f32 v113, v113
    v_exp_f32 v114, v114
    v_exp_f32 v115, v115
    v_mfma_f32_32x32x16_bf16 v[176:191], v[224:227], v[156:159], v[176:191]
    ds_read_b128 v[208:211], v32 offset:21504
    v_exp_f32 v116, v116
    v_exp_f32 v117, v117
    v_exp_f32 v118, v118
    v_exp_f32 v119, v119
    v_mfma_f32_32x32x16_bf16 v[128:143], v[212:215], v[72:75], v[96:111]
    buffer_load_dwordx4 v253, s[16:19], s43 offen sc1 lds
    v_cvt_pk_bf16_f32 v144, v112, v113
    v_exp_f32 v120, v120
    v_exp_f32 v121, v121
    v_cvt_pk_bf16_f32 v145, v114, v115
    v_cvt_pk_bf16_f32 v146, v116, v117
    v_mfma_f32_32x32x16_bf16 v[128:143], v[216:219], v[76:79], v[128:143]
    s_add_u32 m0, s38, 159744
    v_cvt_pk_bf16_f32 v147, v118, v119
    v_exp_f32 v122, v122
    v_exp_f32 v123, v123
    v_exp_f32 v124, v124
    v_exp_f32 v125, v125
    v_mfma_f32_16x16x32_bf16 v[196:199], v[200:203], v[152:155], 0
    buffer_load_dwordx4 v33, s[16:19], s43 offen sc1 lds
    v_cvt_pk_bf16_f32 v148, v120, v121
    v_exp_f32 v126, v126
    v_mfma_f32_16x16x32_bf16 v[196:199], v[200:203], v[156:159], v[196:199]
    s_waitcnt lgkmcnt(0)
    v_cvt_pk_bf16_f32 v149, v122, v123
    v_exp_f32 v127, v127
    v_cvt_pk_bf16_f32 v150, v124, v125
    v_cvt_pk_bf16_f32 v151, v126, v127
    v_mfma_f32_32x32x16_bf16 v[160:175], v[228:231], v[144:147], v[160:175]
    s_add_u32 s42, s42, 8192
    ds_read_b64_tr_b16 v[220:221], v31 offset:20480
    v_exp_f32 v128, v128
    v_exp_f32 v129, v129
    v_exp_f32 v130, v130
    v_exp_f32 v131, v131
    v_mfma_f32_32x32x16_bf16 v[160:175], v[232:235], v[148:151], v[160:175]
    s_add_u32 s43, s43, 8192
    ds_read_b64_tr_b16 v[222:223], v30 offset:20480
    v_exp_f32 v132, v132
    v_exp_f32 v133, v133
    v_exp_f32 v134, v134
    v_exp_f32 v135, v135
    v_mfma_f32_32x32x16_bf16 v[112:127], v[204:207], v[64:67], v[80:95]
    ds_read_b64_tr_b16 v[224:225], v31 offset:20736
    v_cvt_pk_bf16_f32 v152, v128, v129
    v_exp_f32 v136, v136
    v_exp_f32 v137, v137
    v_cvt_pk_bf16_f32 v153, v130, v131
    v_exp_f32 v138, v138
    v_mfma_f32_32x32x16_bf16 v[112:127], v[208:211], v[68:71], v[112:127]
    ds_read_b64_tr_b16 v[226:227], v30 offset:20736
    v_exp_f32 v139, v139
    v_cvt_pk_bf16_f32 v154, v132, v133
    v_exp_f32 v140, v140
    v_exp_f32 v141, v141
    v_cvt_pk_bf16_f32 v155, v134, v135
    v_mfma_f32_16x16x32_bf16 v[192:195], v[200:203], v[144:147], v[192:195]
    v_exp_f32 v142, v142
    v_cvt_pk_bf16_f32 v156, v136, v137
    v_cvt_pk_bf16_f32 v157, v138, v139
    v_mfma_f32_16x16x32_bf16 v[192:195], v[200:203], v[148:151], v[192:195]
    v_exp_f32 v143, v143
    v_cvt_pk_bf16_f32 v158, v140, v141
    v_cvt_pk_bf16_f32 v159, v142, v143
    v_mfma_f32_32x32x16_bf16 v[176:191], v[228:231], v[152:155], v[176:191]
    ds_read_b128 v[212:215], v32 offset:22528
    v_exp_f32 v112, v112
    v_exp_f32 v113, v113
    v_exp_f32 v114, v114
    v_exp_f32 v115, v115
    v_mfma_f32_32x32x16_bf16 v[176:191], v[232:235], v[156:159], v[176:191]
    ds_read_b128 v[216:219], v32 offset:23552
    v_cvt_pk_bf16_f32 v144, v112, v113
    v_exp_f32 v116, v116
    v_exp_f32 v117, v117
    v_exp_f32 v118, v118
    v_mfma_f32_32x32x16_bf16 v[128:143], v[204:207], v[72:75], v[96:111]
    v_exp_f32 v119, v119
    v_exp_f32 v120, v120
    v_exp_f32 v121, v121
    v_cvt_pk_bf16_f32 v145, v114, v115
    v_exp_f32 v122, v122
    v_mfma_f32_32x32x16_bf16 v[128:143], v[208:211], v[76:79], v[128:143]
    v_exp_f32 v123, v123
    v_cvt_pk_bf16_f32 v146, v116, v117
    v_cvt_pk_bf16_f32 v147, v118, v119
    v_exp_f32 v124, v124
    v_exp_f32 v125, v125
    v_mfma_f32_16x16x32_bf16 v[196:199], v[200:203], v[152:155], v[196:199]
    v_exp_f32 v126, v126
    v_cvt_pk_bf16_f32 v148, v120, v121
    v_cvt_pk_bf16_f32 v149, v122, v123
    v_mfma_f32_16x16x32_bf16 v[196:199], v[200:203], v[156:159], v[196:199]
    s_waitcnt lgkmcnt(0)
    v_exp_f32 v127, v127
    v_cvt_pk_bf16_f32 v150, v124, v125
    v_cvt_pk_bf16_f32 v151, v126, v127
    v_mfma_f32_32x32x16_bf16 v[160:175], v[220:223], v[144:147], v[160:175]
    ds_read_b64_tr_b16 v[228:229], v31 offset:22528
    v_exp_f32 v128, v128
    v_exp_f32 v129, v129
    v_exp_f32 v130, v130
    v_exp_f32 v131, v131
    v_mfma_f32_32x32x16_bf16 v[160:175], v[224:227], v[148:151], v[160:175]
    ds_read_b64_tr_b16 v[230:231], v30 offset:22528
    v_exp_f32 v132, v132
    v_exp_f32 v133, v133
    v_exp_f32 v134, v134
    v_exp_f32 v135, v135
    v_mfma_f32_32x32x16_bf16 v[112:127], v[212:215], v[64:67], v[80:95]
    ds_read_b64_tr_b16 v[232:233], v31 offset:22784
    v_cvt_pk_bf16_f32 v152, v128, v129
    v_cvt_pk_bf16_f32 v153, v130, v131
    v_exp_f32 v136, v136
    v_exp_f32 v137, v137
    v_exp_f32 v138, v138
    v_mfma_f32_32x32x16_bf16 v[112:127], v[216:219], v[68:71], v[112:127]
    ds_read_b64_tr_b16 v[234:235], v30 offset:22784
    v_exp_f32 v139, v139
    v_cvt_pk_bf16_f32 v154, v132, v133
    v_cvt_pk_bf16_f32 v155, v134, v135
    v_exp_f32 v140, v140
    v_exp_f32 v141, v141
    v_mfma_f32_16x16x32_bf16 v[192:195], v[200:203], v[144:147], v[192:195]
    buffer_load_dword a224, v34, s[84:87], s91 offen
    v_cvt_pk_bf16_f32 v156, v136, v137
    v_exp_f32 v142, v142
    v_mfma_f32_16x16x32_bf16 v[192:195], v[200:203], v[148:151], v[192:195]
    v_cvt_pk_bf16_f32 v157, v138, v139
    v_exp_f32 v143, v143
    v_cvt_pk_bf16_f32 v158, v140, v141
    v_cvt_pk_bf16_f32 v159, v142, v143
    s_mov_b32 s45, 0
    .p2align 6
L_at_r:
    v_mfma_f32_32x32x16_bf16 v[176:191], v[220:223], v[152:155], v[176:191]
    s_waitcnt vmcnt(5) lgkmcnt(0)
    s_barrier
    v_exp_f32 v112, v112
    v_exp_f32 v113, v113
    v_exp_f32 v114, v114
    v_exp_f32 v115, v115
    v_mfma_f32_32x32x16_bf16 v[176:191], v[224:227], v[156:159], v[176:191]
    ds_read_b128 v[204:207], v32 offset:0
    v_exp_f32 v116, v116
    v_exp_f32 v117, v117
    v_exp_f32 v118, v118
    v_exp_f32 v119, v119
    v_mfma_f32_32x32x16_bf16 v[128:143], v[212:215], v[72:75], v[96:111]
    ds_read_b128 v[208:211], v32 offset:1024
    v_cvt_pk_bf16_f32 v144, v112, v113
    v_exp_f32 v120, v120
    v_exp_f32 v121, v121
    v_cvt_pk_bf16_f32 v145, v114, v115
    v_exp_f32 v122, v122
    v_mfma_f32_32x32x16_bf16 v[128:143], v[216:219], v[76:79], v[128:143]
    v_exp_f32 v123, v123
    v_cvt_pk_bf16_f32 v146, v116, v117
    v_cvt_pk_bf16_f32 v147, v118, v119
    v_exp_f32 v124, v124
    v_exp_f32 v125, v125
    v_mfma_f32_16x16x32_bf16 v[196:199], v[200:203], v[152:155], v[196:199]
    v_exp_f32 v126, v126
    v_cvt_pk_bf16_f32 v148, v120, v121
    v_cvt_pk_bf16_f32 v149, v122, v123
    v_mfma_f32_16x16x32_bf16 v[196:199], v[200:203], v[156:159], v[196:199]
    s_waitcnt lgkmcnt(0)
    v_exp_f32 v127, v127
    v_cvt_pk_bf16_f32 v150, v124, v125
    v_cvt_pk_bf16_f32 v151, v126, v127
    v_mfma_f32_32x32x16_bf16 v[160:175], v[228:231], v[144:147], v[160:175]
    ds_read_b64_tr_b16 v[220:221], v31 offset:0
    v_exp_f32 v128, v128
    v_exp_f32 v129, v129
    v_exp_f32 v130, v130
    v_exp_f32 v131, v131
    v_mfma_f32_32x32x16_bf16 v[160:175], v[232:235], v[148:151], v[160:175]
    ds_read_b64_tr_b16 v[222:223], v30 offset:0
    v_exp_f32 v132, v132
    v_exp_f32 v133, v133
    v_exp_f32 v134, v134
    v_exp_f32 v135, v135
    v_mfma_f32_32x32x16_bf16 v[112:127], v[204:207], v[64:67], v[80:95]
    ds_read_b64_tr_b16 v[224:225], v31 offset:256
    v_cvt_pk_bf16_f32 v152, v128, v129
    v_exp_f32 v136, v136
    v_exp_f32 v137, v137
    v_cvt_pk_bf16_f32 v153, v130, v131
    v_exp_f32 v138, v138
    v_mfma_f32_32x32x16_bf16 v[112:127], v[208:211], v[68:71], v[112:127]
    ds_read_b64_tr_b16 v[226:227], v30 offset:256
    v_exp_f32 v139, v139
    v_cvt_pk_bf16_f32 v154, v132, v133
    v_exp_f32 v140, v140
    v_exp_f32 v141, v141
    v_cvt_pk_bf16_f32 v155, v134, v135
    v_mfma_f32_16x16x32_bf16 v[192:195], v[200:203], v[144:147], v[192:195]
    ds_read_b128 v[12:15], v28 offset:0
    v_exp_f32 v142, v142
    v_cvt_pk_bf16_f32 v156, v136, v137
    v_cvt_pk_bf16_f32 v157, v138, v139
    v_mfma_f32_16x16x32_bf16 v[192:195], v[200:203], v[148:151], v[192:195]
    v_exp_f32 v143, v143
    v_cvt_pk_bf16_f32 v158, v140, v141
    v_cvt_pk_bf16_f32 v159, v142, v143
    v_mfma_f32_32x32x16_bf16 v[176:191], v[228:231], v[152:155], v[176:191]
    s_add_u32 m0, s38, 131072
    ds_read_b128 v[212:215], v32 offset:2048
    v_exp_f32 v112, v112
    v_exp_f32 v113, v113
    v_exp_f32 v114, v114
    v_exp_f32 v115, v115
    v_mfma_f32_32x32x16_bf16 v[176:191], v[232:235], v[156:159], v[176:191]
    ds_read_b128 v[216:219], v32 offset:3072
    v_exp_f32 v116, v116
    v_exp_f32 v117, v117
    v_exp_f32 v118, v118
    v_exp_f32 v119, v119
    v_mfma_f32_32x32x16_bf16 v[128:143], v[204:207], v[72:75], v[96:111]
    buffer_load_dwordx4 v253, s[16:19], s42 offen sc1 lds
    v_cvt_pk_bf16_f32 v144, v112, v113
    v_exp_f32 v120, v120
    v_exp_f32 v121, v121
    v_cvt_pk_bf16_f32 v145, v114, v115
    v_cvt_pk_bf16_f32 v146, v116, v117
    v_mfma_f32_32x32x16_bf16 v[128:143], v[208:211], v[76:79], v[128:143]
    s_add_u32 m0, s38, 135168
    v_cvt_pk_bf16_f32 v147, v118, v119
    v_exp_f32 v122, v122
    v_exp_f32 v123, v123
    v_exp_f32 v124, v124
    v_exp_f32 v125, v125
    v_mfma_f32_16x16x32_bf16 v[196:199], v[200:203], v[152:155], v[196:199]
    buffer_load_dwordx4 v33, s[16:19], s42 offen sc1 lds
    v_cvt_pk_bf16_f32 v148, v120, v121
    v_exp_f32 v126, v126
    v_mfma_f32_16x16x32_bf16 v[196:199], v[200:203], v[156:159], v[196:199]
    s_waitcnt lgkmcnt(0)
    v_cvt_pk_bf16_f32 v149, v122, v123
    v_exp_f32 v127, v127
    v_cvt_pk_bf16_f32 v150, v124, v125
    v_cvt_pk_bf16_f32 v151, v126, v127
    v_mfma_f32_32x32x16_bf16 v[160:175], v[220:223], v[144:147], v[160:175]
    ds_read_b64_tr_b16 v[228:229], v31 offset:2048
    v_exp_f32 v128, v128
    v_exp_f32 v129, v129
    v_exp_f32 v130, v130
    v_exp_f32 v131, v131
    v_mfma_f32_32x32x16_bf16 v[160:175], v[224:227], v[148:151], v[160:175]
    ds_read_b64_tr_b16 v[230:231], v30 offset:2048
    v_exp_f32 v132, v132
    v_exp_f32 v133, v133
    v_exp_f32 v134, v134
    v_exp_f32 v135, v135
    v_mfma_f32_32x32x16_bf16 v[112:127], v[212:215], v[64:67], v[80:95]
    ds_read_b64_tr_b16 v[232:233], v31 offset:2304
    v_cvt_pk_bf16_f32 v152, v128, v129
    v_cvt_pk_bf16_f32 v153, v130, v131
    v_exp_f32 v136, v136
    v_exp_f32 v137, v137
    v_exp_f32 v138, v138
    v_mfma_f32_32x32x16_bf16 v[112:127], v[216:219], v[68:71], v[112:127]
    ds_read_b64_tr_b16 v[234:235], v30 offset:2304
    v_exp_f32 v139, v139
    v_cvt_pk_bf16_f32 v154, v132, v133
    v_cvt_pk_bf16_f32 v155, v134, v135
    v_exp_f32 v140, v140
    v_exp_f32 v141, v141
    v_mfma_f32_16x16x32_bf16 v[192:195], v[200:203], v[144:147], v[192:195]
    buffer_store_dwordx4 v[12:15], v252, s[16:19], s68 offen offset:0 sc1
    v_cvt_pk_bf16_f32 v156, v136, v137
    v_exp_f32 v142, v142
    v_mfma_f32_16x16x32_bf16 v[192:195], v[200:203], v[148:151], v[192:195]
    v_cvt_pk_bf16_f32 v157, v138, v139
    v_exp_f32 v143, v143
    v_cvt_pk_bf16_f32 v158, v140, v141
    v_cvt_pk_bf16_f32 v159, v142, v143
    v_mfma_f32_32x32x16_bf16 v[176:191], v[220:223], v[152:155], v[176:191]
    s_add_u32 m0, s38, 139264
    ds_read_b128 v[204:207], v32 offset:4096
    v_exp_f32 v112, v112
    v_exp_f32 v113, v113
    v_exp_f32 v114, v114
    v_exp_f32 v115, v115
    v_mfma_f32_32x32x16_bf16 v[176:191], v[224:227], v[156:159], v[176:191]
    ds_read_b128 v[208:211], v32 offset:5120
    v_exp_f32 v116, v116
    v_exp_f32 v117, v117
    v_exp_f32 v118, v118
    v_exp_f32 v119, v119
    v_mfma_f32_32x32x16_bf16 v[128:143], v[212:215], v[72:75], v[96:111]
    buffer_load_dwordx4 v253, s[16:19], s43 offen sc1 lds
    v_cvt_pk_bf16_f32 v144, v112, v113
    v_exp_f32 v120, v120
    v_exp_f32 v121, v121
    v_cvt_pk_bf16_f32 v145, v114, v115
    v_cvt_pk_bf16_f32 v146, v116, v117
    v_mfma_f32_32x32x16_bf16 v[128:143], v[216:219], v[76:79], v[128:143]
    s_add_u32 m0, s38, 143360
    v_cvt_pk_bf16_f32 v147, v118, v119
    v_exp_f32 v122, v122
    v_exp_f32 v123, v123
    v_exp_f32 v124, v124
    v_exp_f32 v125, v125
    v_mfma_f32_16x16x32_bf16 v[196:199], v[200:203], v[152:155], v[196:199]
    buffer_load_dwordx4 v33, s[16:19], s43 offen sc1 lds
    v_cvt_pk_bf16_f32 v148, v120, v121
    v_exp_f32 v126, v126
    v_mfma_f32_16x16x32_bf16 v[196:199], v[200:203], v[156:159], v[196:199]
    s_waitcnt lgkmcnt(0)
    v_cvt_pk_bf16_f32 v149, v122, v123
    v_exp_f32 v127, v127
    v_cvt_pk_bf16_f32 v150, v124, v125
    v_cvt_pk_bf16_f32 v151, v126, v127
    v_mfma_f32_32x32x16_bf16 v[160:175], v[228:231], v[144:147], v[160:175]
    s_add_u32 s42, s42, 8192
    ds_read_b64_tr_b16 v[220:221], v31 offset:4096
    v_exp_f32 v128, v128
    v_exp_f32 v129, v129
    v_exp_f32 v130, v130
    v_exp_f32 v131, v131
    v_mfma_f32_32x32x16_bf16 v[160:175], v[232:235], v[148:151], v[160:175]
    s_add_u32 s43, s43, 8192
    ds_read_b64_tr_b16 v[222:223], v30 offset:4096
    v_exp_f32 v132, v132
    v_exp_f32 v133, v133
    v_exp_f32 v134, v134
    v_exp_f32 v135, v135
    v_mfma_f32_32x32x16_bf16 v[112:127], v[204:207], v[64:67], v[80:95]
    ds_read_b64_tr_b16 v[224:225], v31 offset:4352
    v_cvt_pk_bf16_f32 v152, v128, v129
    v_exp_f32 v136, v136
    v_exp_f32 v137, v137
    v_cvt_pk_bf16_f32 v153, v130, v131
    v_exp_f32 v138, v138
    v_mfma_f32_32x32x16_bf16 v[112:127], v[208:211], v[68:71], v[112:127]
    ds_read_b64_tr_b16 v[226:227], v30 offset:4352
    v_exp_f32 v139, v139
    v_cvt_pk_bf16_f32 v154, v132, v133
    v_exp_f32 v140, v140
    v_exp_f32 v141, v141
    v_cvt_pk_bf16_f32 v155, v134, v135
    v_mfma_f32_16x16x32_bf16 v[192:195], v[200:203], v[144:147], v[192:195]
    ds_read_b128 v[16:19], v28 offset:1024
    v_exp_f32 v142, v142
    v_cvt_pk_bf16_f32 v156, v136, v137
    v_cvt_pk_bf16_f32 v157, v138, v139
    v_mfma_f32_16x16x32_bf16 v[192:195], v[200:203], v[148:151], v[192:195]
    v_exp_f32 v143, v143
    v_cvt_pk_bf16_f32 v158, v140, v141
    v_cvt_pk_bf16_f32 v159, v142, v143
    v_mfma_f32_32x32x16_bf16 v[176:191], v[228:231], v[152:155], v[176:191]
    ds_read_b128 v[212:215], v32 offset:6144
    v_exp_f32 v112, v112
    v_exp_f32 v113, v113
    v_exp_f32 v114, v114
    v_exp_f32 v115, v115
    v_mfma_f32_32x32x16_bf16 v[176:191], v[232:235], v[156:159], v[176:191]
    ds_read_b128 v[216:219], v32 offset:7168
    v_cvt_pk_bf16_f32 v144, v112, v113
    v_exp_f32 v116, v116
    v_exp_f32 v117, v117
    v_exp_f32 v118, v118
    v_mfma_f32_32x32x16_bf16 v[128:143], v[204:207], v[72:75], v[96:111]
    v_exp_f32 v119, v119
    v_exp_f32 v120, v120
    v_exp_f32 v121, v121
    v_cvt_pk_bf16_f32 v145, v114, v115
    v_exp_f32 v122, v122
    v_mfma_f32_32x32x16_bf16 v[128:143], v[208:211], v[76:79], v[128:143]
    v_exp_f32 v123, v123
    v_cvt_pk_bf16_f32 v146, v116, v117
    v_cvt_pk_bf16_f32 v147, v118, v119
    v_exp_f32 v124, v124
    v_exp_f32 v125, v125
    v_mfma_f32_16x16x32_bf16 v[196:199], v[200:203], v[152:155], v[196:199]
    v_exp_f32 v126, v126
    v_cvt_pk_bf16_f32 v148, v120, v121
    v_cvt_pk_bf16_f32 v149, v122, v123
    v_mfma_f32_16x16x32_bf16 v[196:199], v[200:203], v[156:159], v[196:199]
    s_waitcnt lgkmcnt(0)
    v_exp_f32 v127, v127
    v_cvt_pk_bf16_f32 v150, v124, v125
    v_cvt_pk_bf16_f32 v151, v126, v127
    v_mfma_f32_32x32x16_bf16 v[160:175], v[220:223], v[144:147], v[160:175]
    ds_read_b64_tr_b16 v[228:229], v31 offset:6144
    v_exp_f32 v128, v128
    v_exp_f32 v129, v129
    v_exp_f32 v130, v130
    v_exp_f32 v131, v131
    v_mfma_f32_32x32x16_bf16 v[160:175], v[224:227], v[148:151], v[160:175]
    ds_read_b64_tr_b16 v[230:231], v30 offset:6144
    v_exp_f32 v132, v132
    v_exp_f32 v133, v133
    v_exp_f32 v134, v134
    v_exp_f32 v135, v135
    v_mfma_f32_32x32x16_bf16 v[112:127], v[212:215], v[64:67], v[80:95]
    ds_read_b64_tr_b16 v[232:233], v31 offset:6400
    v_cvt_pk_bf16_f32 v152, v128, v129
    v_cvt_pk_bf16_f32 v153, v130, v131
    v_exp_f32 v136, v136
    v_exp_f32 v137, v137
    v_exp_f32 v138, v138
    v_mfma_f32_32x32x16_bf16 v[112:127], v[216:219], v[68:71], v[112:127]
    ds_read_b64_tr_b16 v[234:235], v30 offset:6400
    v_exp_f32 v139, v139
    v_cvt_pk_bf16_f32 v154, v132, v133
    v_cvt_pk_bf16_f32 v155, v134, v135
    v_exp_f32 v140, v140
    v_exp_f32 v141, v141
    v_mfma_f32_16x16x32_bf16 v[192:195], v[200:203], v[144:147], v[192:195]
    buffer_store_dwordx4 v[16:19], v252, s[16:19], s68 offen offset:1024 sc1
    v_cvt_pk_bf16_f32 v156, v136, v137
    v_exp_f32 v142, v142
    v_mfma_f32_16x16x32_bf16 v[192:195], v[200:203], v[148:151], v[192:195]
    v_cvt_pk_bf16_f32 v157, v138, v139
    v_exp_f32 v143, v143
    v_cvt_pk_bf16_f32 v158, v140, v141
    v_cvt_pk_bf16_f32 v159, v142, v143
    v_mfma_f32_32x32x16_bf16 v[176:191], v[220:223], v[152:155], v[176:191]
    s_waitcnt vmcnt(6) lgkmcnt(0)
    s_barrier
    v_exp_f32 v112, v112
    v_exp_f32 v113, v113
    v_exp_f32 v114, v114
    v_exp_f32 v115, v115
    v_mfma_f32_32x32x16_bf16 v[176:191], v[224:227], v[156:159], v[176:191]
    ds_read_b128 v[204:207], v32 offset:32768
    v_exp_f32 v116, v116
    v_exp_f32 v117, v117
    v_exp_f32 v118, v118
    v_exp_f32 v119, v119
    v_mfma_f32_32x32x16_bf16 v[128:143], v[212:215], v[72:75], v[96:111]
    ds_read_b128 v[208:211], v32 offset:33792
    v_cvt_pk_bf16_f32 v144, v112, v113
    v_exp_f32 v120, v120
    v_exp_f32 v121, v121
    v_cvt_pk_bf16_f32 v145, v114, v115
    v_exp_f32 v122, v122
    v_mfma_f32_32x32x16_bf16 v[128:143], v[216:219], v[76:79], v[128:143]
    v_exp_f32 v123, v123
    v_cvt_pk_bf16_f32 v146, v116, v117
    v_cvt_pk_bf16_f32 v147, v118, v119
    v_exp_f32 v124, v124
    v_exp_f32 v125, v125
    v_mfma_f32_16x16x32_bf16 v[196:199], v[200:203], v[152:155], v[196:199]
    v_exp_f32 v126, v126
    v_cvt_pk_bf16_f32 v148, v120, v121
    v_cvt_pk_bf16_f32 v149, v122, v123
    v_mfma_f32_16x16x32_bf16 v[196:199], v[200:203], v[156:159], v[196:199]
    s_waitcnt lgkmcnt(0)
    v_exp_f32 v127, v127
    v_cvt_pk_bf16_f32 v150, v124, v125
    v_cvt_pk_bf16_f32 v151, v126, v127
    v_mfma_f32_32x32x16_bf16 v[160:175], v[228:231], v[144:147], v[160:175]
    ds_read_b64_tr_b16 v[220:221], v31 offset:32768
    v_exp_f32 v128, v128
    v_exp_f32 v129, v129
    v_exp_f32 v130, v130
    v_exp_f32 v131, v131
    v_mfma_f32_32x32x16_bf16 v[160:175], v[232:235], v[148:151], v[160:175]
    ds_read_b64_tr_b16 v[222:223], v30 offset:32768
    v_exp_f32 v132, v132
    v_exp_f32 v133, v133
    v_exp_f32 v134, v134
    v_exp_f32 v135, v135
    v_mfma_f32_32x32x16_bf16 v[112:127], v[204:207], v[64:67], v[80:95]
    ds_read_b64_tr_b16 v[224:225], v31 offset:33024
    v_cvt_pk_bf16_f32 v152, v128, v129
    v_exp_f32 v136, v136
    v_exp_f32 v137, v137
    v_cvt_pk_bf16_f32 v153, v130, v131
    v_exp_f32 v138, v138
    v_mfma_f32_32x32x16_bf16 v[112:127], v[208:211], v[68:71], v[112:127]
    ds_read_b64_tr_b16 v[226:227], v30 offset:33024
    v_exp_f32 v139, v139
    v_cvt_pk_bf16_f32 v154, v132, v133
    v_exp_f32 v140, v140
    v_exp_f32 v141, v141
    v_cvt_pk_bf16_f32 v155, v134, v135
    v_mfma_f32_16x16x32_bf16 v[192:195], v[200:203], v[144:147], v[192:195]
    ds_read_b128 v[20:23], v28 offset:2048
    v_exp_f32 v142, v142
    v_cvt_pk_bf16_f32 v156, v136, v137
    v_cvt_pk_bf16_f32 v157, v138, v139
    v_mfma_f32_16x16x32_bf16 v[192:195], v[200:203], v[148:151], v[192:195]
    v_exp_f32 v143, v143
    v_cvt_pk_bf16_f32 v158, v140, v141
    v_cvt_pk_bf16_f32 v159, v142, v143
    v_mfma_f32_32x32x16_bf16 v[176:191], v[228:231], v[152:155], v[176:191]
    s_add_u32 m0, s38, 114688
    ds_read_b128 v[212:215], v32 offset:34816
    v_exp_f32 v112, v112
    v_exp_f32 v113, v113
    v_exp_f32 v114, v114
    v_exp_f32 v115, v115
    v_mfma_f32_32x32x16_bf16 v[176:191], v[232:235], v[156:159], v[176:191]
    ds_read_b128 v[216:219], v32 offset:35840
    v_exp_f32 v116, v116
    v_exp_f32 v117, v117
    v_exp_f32 v118, v118
    v_exp_f32 v119, v119
    v_mfma_f32_32x32x16_bf16 v[128:143], v[204:207], v[72:75], v[96:111]
    buffer_load_dwordx4 v253, s[16:19], s42 offen sc1 lds
    v_cvt_pk_bf16_f32 v144, v112, v113
    v_exp_f32 v120, v120
    v_exp_f32 v121, v121
    v_cvt_pk_bf16_f32 v145, v114, v115
    v_cvt_pk_bf16_f32 v146, v116, v117
    v_mfma_f32_32x32x16_bf16 v[128:143], v[208:211], v[76:79], v[128:143]
    s_add_u32 m0, s38, 118784
    v_cvt_pk_bf16_f32 v147, v118, v119
    v_exp_f32 v122, v122
    v_exp_f32 v123, v123
    v_exp_f32 v124, v124
    v_exp_f32 v125, v125
    v_mfma_f32_16x16x32_bf16 v[196:199], v[200:203], v[152:155], v[196:199]
    buffer_load_dwordx4 v33, s[16:19], s42 offen sc1 lds
    v_cvt_pk_bf16_f32 v148, v120, v121
    v_exp_f32 v126, v126
    v_mfma_f32_16x16x32_bf16 v[196:199], v[200:203], v[156:159], v[196:199]
    s_waitcnt lgkmcnt(0)
    v_cvt_pk_bf16_f32 v149, v122, v123
    v_exp_f32 v127, v127
    v_cvt_pk_bf16_f32 v150, v124, v125
    v_cvt_pk_bf16_f32 v151, v126, v127
    v_mfma_f32_32x32x16_bf16 v[160:175], v[220:223], v[144:147], v[160:175]
    ds_read_b64_tr_b16 v[228:229], v31 offset:34816
    v_exp_f32 v128, v128
    v_exp_f32 v129, v129
    v_exp_f32 v130, v130
    v_exp_f32 v131, v131
    v_mfma_f32_32x32x16_bf16 v[160:175], v[224:227], v[148:151], v[160:175]
    ds_read_b64_tr_b16 v[230:231], v30 offset:34816
    v_exp_f32 v132, v132
    v_exp_f32 v133, v133
    v_exp_f32 v134, v134
    v_exp_f32 v135, v135
    v_mfma_f32_32x32x16_bf16 v[112:127], v[212:215], v[64:67], v[80:95]
    ds_read_b64_tr_b16 v[232:233], v31 offset:35072
    v_cvt_pk_bf16_f32 v152, v128, v129
    v_exp_f32 v136, v136
    v_exp_f32 v137, v137
    v_cvt_pk_bf16_f32 v153, v130, v131
    v_exp_f32 v138, v138
    v_cvt_pk_bf16_f32 v154, v132, v133
    v_mfma_f32_32x32x16_bf16 v[112:127], v[216:219], v[68:71], v[112:127]
    ds_read_b64_tr_b16 v[234:235], v30 offset:35072
    v_exp_f32 v139, v139
    v_exp_f32 v140, v140
    v_exp_f32 v141, v141
    v_cvt_pk_bf16_f32 v155, v134, v135
    v_cvt_pk_bf16_f32 v156, v136, v137
    v_mfma_f32_16x16x32_bf16 v[192:195], v[200:203], v[144:147], v[192:195]
    buffer_store_dwordx4 v[20:23], v252, s[16:19], s68 offen offset:2048 sc1
    s_add_u32 s68, s68, 147456
    v_cvt_pk_bf16_f32 v157, v138, v139
    v_exp_f32 v142, v142
    v_mfma_f32_16x16x32_bf16 v[192:195], v[200:203], v[148:151], v[192:195]
    ds_read_b64 v[24:25], v29 offset:3072
    v_exp_f32 v143, v143
    v_cvt_pk_bf16_f32 v158, v140, v141
    v_cvt_pk_bf16_f32 v159, v142, v143
    v_mfma_f32_32x32x16_bf16 v[176:191], v[220:223], v[152:155], v[176:191]
    s_add_u32 m0, s38, 122880
    ds_read_b128 v[204:207], v32 offset:36864
    v_exp_f32 v112, v112
    v_exp_f32 v113, v113
    v_exp_f32 v114, v114
    v_exp_f32 v115, v115
    v_mfma_f32_32x32x16_bf16 v[176:191], v[224:227], v[156:159], v[176:191]
    ds_read_b128 v[208:211], v32 offset:37888
    v_exp_f32 v116, v116
    v_exp_f32 v117, v117
    v_exp_f32 v118, v118
    v_exp_f32 v119, v119
    v_mfma_f32_32x32x16_bf16 v[128:143], v[212:215], v[72:75], v[96:111]
    buffer_load_dwordx4 v253, s[16:19], s43 offen sc1 lds
    v_cvt_pk_bf16_f32 v144, v112, v113
    v_exp_f32 v120, v120
    v_exp_f32 v121, v121
    v_cvt_pk_bf16_f32 v145, v114, v115
    v_cvt_pk_bf16_f32 v146, v116, v117
    v_mfma_f32_32x32x16_bf16 v[128:143], v[216:219], v[76:79], v[128:143]
    s_add_u32 m0, s38, 126976
    v_cvt_pk_bf16_f32 v147, v118, v119
    v_exp_f32 v122, v122
    v_exp_f32 v123, v123
    v_exp_f32 v124, v124
    v_exp_f32 v125, v125
    v_mfma_f32_16x16x32_bf16 v[196:199], v[200:203], v[152:155], v[196:199]
    buffer_load_dwordx4 v33, s[16:19], s43 offen sc1 lds
    v_cvt_pk_bf16_f32 v148, v120, v121
    v_exp_f32 v126, v126
    v_mfma_f32_16x16x32_bf16 v[196:199], v[200:203], v[156:159], v[196:199]
    s_waitcnt lgkmcnt(0)
    v_cvt_pk_bf16_f32 v149, v122, v123
    v_exp_f32 v127, v127
    v_cvt_pk_bf16_f32 v150, v124, v125
    v_cvt_pk_bf16_f32 v151, v126, v127
    v_mfma_f32_32x32x16_bf16 v[160:175], v[228:231], v[144:147], v[160:175]
    s_add_u32 s42, s42, 8192
    ds_read_b64_tr_b16 v[220:221], v31 offset:36864
    v_exp_f32 v128, v128
    v_exp_f32 v129, v129
    v_exp_f32 v130, v130
    v_exp_f32 v131, v131
    v_mfma_f32_32x32x16_bf16 v[160:175], v[232:235], v[148:151], v[160:175]
    s_add_u32 s43, s43, 8192
    ds_read_b64_tr_b16 v[222:223], v30 offset:36864
    v_exp_f32 v132, v132
    v_exp_f32 v133, v133
    v_exp_f32 v134, v134
    v_exp_f32 v135, v135
    v_mfma_f32_32x32x16_bf16 v[112:127], v[204:207], v[64:67], v[80:95]
    ds_read_b64_tr_b16 v[224:225], v31 offset:37120
    v_cvt_pk_bf16_f32 v152, v128, v129
    v_cvt_pk_bf16_f32 v153, v130, v131
    v_exp_f32 v136, v136
    v_exp_f32 v137, v137
    v_exp_f32 v138, v138
    v_mfma_f32_32x32x16_bf16 v[112:127], v[208:211], v[68:71], v[112:127]
    ds_read_b64_tr_b16 v[226:227], v30 offset:37120
    v_exp_f32 v139, v139
    v_cvt_pk_bf16_f32 v154, v132, v133
    v_cvt_pk_bf16_f32 v155, v134, v135
    v_exp_f32 v140, v140
    v_exp_f32 v141, v141
    v_mfma_f32_16x16x32_bf16 v[192:195], v[200:203], v[144:147], v[192:195]
    buffer_store_dwordx2 v[24:25], v35, s[16:19], s69 offen sc1
    s_add_u32 s69, s69, 147456
    v_cvt_pk_bf16_f32 v156, v136, v137
    v_exp_f32 v142, v142
    v_mfma_f32_16x16x32_bf16 v[192:195], v[200:203], v[148:151], v[192:195]
    v_cvt_pk_bf16_f32 v157, v138, v139
    v_exp_f32 v143, v143
    v_cvt_pk_bf16_f32 v158, v140, v141
    v_cvt_pk_bf16_f32 v159, v142, v143
    v_mfma_f32_32x32x16_bf16 v[176:191], v[228:231], v[152:155], v[176:191]
    ds_read_b128 v[212:215], v32 offset:38912
    v_exp_f32 v112, v112
    v_exp_f32 v113, v113
    v_exp_f32 v114, v114
    v_exp_f32 v115, v115
    v_mfma_f32_32x32x16_bf16 v[176:191], v[232:235], v[156:159], v[176:191]
    ds_read_b128 v[216:219], v32 offset:39936
    v_exp_f32 v116, v116
    v_exp_f32 v117, v117
    v_exp_f32 v118, v118
    v_exp_f32 v119, v119
    v_mfma_f32_32x32x16_bf16 v[128:143], v[204:207], v[72:75], v[96:111]
    v_add_u32 v28, 3584, v28
    v_add_u32 v29, 3584, v29
    v_cvt_pk_bf16_f32 v144, v112, v113
    v_exp_f32 v120, v120
    v_exp_f32 v121, v121
    v_cvt_pk_bf16_f32 v145, v114, v115
    v_cvt_pk_bf16_f32 v146, v116, v117
    v_mfma_f32_32x32x16_bf16 v[128:143], v[208:211], v[76:79], v[128:143]
    v_exp_f32 v122, v122
    v_exp_f32 v123, v123
    v_exp_f32 v124, v124
    v_exp_f32 v125, v125
    v_cvt_pk_bf16_f32 v147, v118, v119
    v_mfma_f32_16x16x32_bf16 v[196:199], v[200:203], v[152:155], v[196:199]
    v_exp_f32 v126, v126
    v_cvt_pk_bf16_f32 v148, v120, v121
    v_cvt_pk_bf16_f32 v149, v122, v123
    v_mfma_f32_16x16x32_bf16 v[196:199], v[200:203], v[156:159], v[196:199]
    s_waitcnt lgkmcnt(0)
    v_exp_f32 v127, v127
    v_cvt_pk_bf16_f32 v150, v124, v125
    v_cvt_pk_bf16_f32 v151, v126, v127
    v_mfma_f32_32x32x16_bf16 v[160:175], v[220:223], v[144:147], v[160:175]
    ds_read_b64_tr_b16 v[228:229], v31 offset:38912
    v_exp_f32 v128, v128
    v_exp_f32 v129, v129
    v_exp_f32 v130, v130
    v_exp_f32 v131, v131
    v_mfma_f32_32x32x16_bf16 v[160:175], v[224:227], v[148:151], v[160:175]
    ds_read_b64_tr_b16 v[230:231], v30 offset:38912
    v_exp_f32 v132, v132
    v_exp_f32 v133, v133
    v_exp_f32 v134, v134
    v_exp_f32 v135, v135
    v_mfma_f32_32x32x16_bf16 v[112:127], v[212:215], v[64:67], v[80:95]
    ds_read_b64_tr_b16 v[232:233], v31 offset:39168
    v_cvt_pk_bf16_f32 v152, v128, v129
    v_cvt_pk_bf16_f32 v153, v130, v131
    v_exp_f32 v136, v136
    v_exp_f32 v137, v137
    v_exp_f32 v138, v138
    v_mfma_f32_32x32x16_bf16 v[112:127], v[216:219], v[68:71], v[112:127]
    ds_read_b64_tr_b16 v[234:235], v30 offset:39168
    v_exp_f32 v139, v139
    v_cvt_pk_bf16_f32 v154, v132, v133
    v_cvt_pk_bf16_f32 v155, v134, v135
    v_exp_f32 v140, v140
    v_exp_f32 v141, v141
    v_mfma_f32_16x16x32_bf16 v[192:195], v[200:203], v[144:147], v[192:195]
    buffer_load_dword a224, v34, s[80:83], s90 offen
    s_add_u32 s90, s90, 2097152
    v_cvt_pk_bf16_f32 v156, v136, v137
    v_exp_f32 v142, v142
    v_mfma_f32_16x16x32_bf16 v[192:195], v[200:203], v[148:151], v[192:195]
    v_cvt_pk_bf16_f32 v157, v138, v139
    v_exp_f32 v143, v143
    v_cvt_pk_bf16_f32 v158, v140, v141
    v_cvt_pk_bf16_f32 v159, v142, v143
    v_mfma_f32_32x32x16_bf16 v[176:191], v[220:223], v[152:155], v[176:191]
    s_waitcnt vmcnt(8) lgkmcnt(0)
    s_barrier
    v_exp_f32 v112, v112
    v_exp_f32 v113, v113
    v_exp_f32 v114, v114
    v_exp_f32 v115, v115
    v_mfma_f32_32x32x16_bf16 v[176:191], v[224:227], v[156:159], v[176:191]
    ds_read_b128 v[204:207], v32 offset:16384
    v_exp_f32 v116, v116
    v_exp_f32 v117, v117
    v_exp_f32 v118, v118
    v_exp_f32 v119, v119
    v_mfma_f32_32x32x16_bf16 v[128:143], v[212:215], v[72:75], v[96:111]
    ds_read_b128 v[208:211], v32 offset:17408
    v_cvt_pk_bf16_f32 v144, v112, v113
    v_exp_f32 v120, v120
    v_exp_f32 v121, v121
    v_cvt_pk_bf16_f32 v145, v114, v115
    v_exp_f32 v122, v122
    v_mfma_f32_32x32x16_bf16 v[128:143], v[216:219], v[76:79], v[128:143]
    v_exp_f32 v123, v123
    v_cvt_pk_bf16_f32 v146, v116, v117
    v_cvt_pk_bf16_f32 v147, v118, v119
    v_exp_f32 v124, v124
    v_exp_f32 v125, v125
    v_mfma_f32_16x16x32_bf16 v[196:199], v[200:203], v[152:155], v[196:199]
    v_exp_f32 v126, v126
    v_cvt_pk_bf16_f32 v148, v120, v121
    v_cvt_pk_bf16_f32 v149, v122, v123
    v_mfma_f32_16x16x32_bf16 v[196:199], v[200:203], v[156:159], v[196:199]
    s_waitcnt lgkmcnt(0)
    v_exp_f32 v127, v127
    v_cvt_pk_bf16_f32 v150, v124, v125
    v_cvt_pk_bf16_f32 v151, v126, v127
    v_mfma_f32_32x32x16_bf16 v[160:175], v[228:231], v[144:147], v[160:175]
    ds_read_b64_tr_b16 v[220:221], v31 offset:16384
    v_exp_f32 v128, v128
    v_exp_f32 v129, v129
    v_exp_f32 v130, v130
    v_exp_f32 v131, v131
    v_mfma_f32_32x32x16_bf16 v[160:175], v[232:235], v[148:151], v[160:175]
    ds_read_b64_tr_b16 v[222:223], v30 offset:16384
    v_exp_f32 v132, v132
    v_exp_f32 v133, v133
    v_exp_f32 v134, v134
    v_exp_f32 v135, v135
    v_mfma_f32_32x32x16_bf16 v[112:127], v[204:207], v[64:67], v[80:95]
    ds_read_b64_tr_b16 v[224:225], v31 offset:16640
    v_cvt_pk_bf16_f32 v152, v128, v129
    v_exp_f32 v136, v136
    v_exp_f32 v137, v137
    v_cvt_pk_bf16_f32 v153, v130, v131
    v_exp_f32 v138, v138
    v_mfma_f32_32x32x16_bf16 v[112:127], v[208:211], v[68:71], v[112:127]
    ds_read_b64_tr_b16 v[226:227], v30 offset:16640
    v_exp_f32 v139, v139
    v_cvt_pk_bf16_f32 v154, v132, v133
    v_exp_f32 v140, v140
    v_exp_f32 v141, v141
    v_cvt_pk_bf16_f32 v155, v134, v135
    v_mfma_f32_16x16x32_bf16 v[192:195], v[200:203], v[144:147], v[192:195]
    v_exp_f32 v142, v142
    v_cvt_pk_bf16_f32 v156, v136, v137
    v_cvt_pk_bf16_f32 v157, v138, v139
    v_mfma_f32_16x16x32_bf16 v[192:195], v[200:203], v[148:151], v[192:195]
    v_exp_f32 v143, v143
    v_cvt_pk_bf16_f32 v158, v140, v141
    v_cvt_pk_bf16_f32 v159, v142, v143
    v_mfma_f32_32x32x16_bf16 v[176:191], v[228:231], v[152:155], v[176:191]
    s_add_u32 m0, s38, 147456
    ds_read_b128 v[212:215], v32 offset:18432
    v_exp_f32 v112, v112
    v_exp_f32 v113, v113
    v_exp_f32 v114, v114
    v_exp_f32 v115, v115
    v_mfma_f32_32x32x16_bf16 v[176:191], v[232:235], v[156:159], v[176:191]
    ds_read_b128 v[216:219], v32 offset:19456
    v_exp_f32 v116, v116
    v_exp_f32 v117, v117
    v_exp_f32 v118, v118
    v_exp_f32 v119, v119
    v_mfma_f32_32x32x16_bf16 v[128:143], v[204:207], v[72:75], v[96:111]
    buffer_load_dwordx4 v253, s[16:19], s42 offen sc1 lds
    v_cvt_pk_bf16_f32 v144, v112, v113
    v_exp_f32 v120, v120
    v_exp_f32 v121, v121
    v_cvt_pk_bf16_f32 v145, v114, v115
    v_cvt_pk_bf16_f32 v146, v116, v117
    v_mfma_f32_32x32x16_bf16 v[128:143], v[208:211], v[76:79], v[128:143]
    s_add_u32 m0, s38, 151552
    v_cvt_pk_bf16_f32 v147, v118, v119
    v_exp_f32 v122, v122
    v_exp_f32 v123, v123
    v_exp_f32 v124, v124
    v_exp_f32 v125, v125
    v_mfma_f32_16x16x32_bf16 v[196:199], v[200:203], v[152:155], v[196:199]
    buffer_load_dwordx4 v33, s[16:19], s42 offen sc1 lds
    v_cvt_pk_bf16_f32 v148, v120, v121
    v_exp_f32 v126, v126
    v_mfma_f32_16x16x32_bf16 v[196:199], v[200:203], v[156:159], v[196:199]
    s_waitcnt lgkmcnt(0)
    v_cvt_pk_bf16_f32 v149, v122, v123
    v_exp_f32 v127, v127
    v_cvt_pk_bf16_f32 v150, v124, v125
    v_cvt_pk_bf16_f32 v151, v126, v127
    v_mfma_f32_32x32x16_bf16 v[160:175], v[220:223], v[144:147], v[160:175]
    ds_read_b64_tr_b16 v[228:229], v31 offset:18432
    v_exp_f32 v128, v128
    v_exp_f32 v129, v129
    v_exp_f32 v130, v130
    v_exp_f32 v131, v131
    v_mfma_f32_32x32x16_bf16 v[160:175], v[224:227], v[148:151], v[160:175]
    ds_read_b64_tr_b16 v[230:231], v30 offset:18432
    v_exp_f32 v132, v132
    v_exp_f32 v133, v133
    v_exp_f32 v134, v134
    v_exp_f32 v135, v135
    v_mfma_f32_32x32x16_bf16 v[112:127], v[212:215], v[64:67], v[80:95]
    ds_read_b64_tr_b16 v[232:233], v31 offset:18688
    v_cvt_pk_bf16_f32 v152, v128, v129
    v_cvt_pk_bf16_f32 v153, v130, v131
    v_exp_f32 v136, v136
    v_exp_f32 v137, v137
    v_exp_f32 v138, v138
    v_mfma_f32_32x32x16_bf16 v[112:127], v[216:219], v[68:71], v[112:127]
    ds_read_b64_tr_b16 v[234:235], v30 offset:18688
    v_exp_f32 v139, v139
    v_cvt_pk_bf16_f32 v154, v132, v133
    v_cvt_pk_bf16_f32 v155, v134, v135
    v_exp_f32 v140, v140
    v_exp_f32 v141, v141
    v_mfma_f32_16x16x32_bf16 v[192:195], v[200:203], v[144:147], v[192:195]
    global_load_dword a224, v248, s[92:93]
    v_cvt_pk_bf16_f32 v156, v136, v137
    v_exp_f32 v142, v142
    v_mfma_f32_16x16x32_bf16 v[192:195], v[200:203], v[148:151], v[192:195]
    v_cvt_pk_bf16_f32 v157, v138, v139
    v_exp_f32 v143, v143
    v_cvt_pk_bf16_f32 v158, v140, v141
    v_cvt_pk_bf16_f32 v159, v142, v143
    v_mfma_f32_32x32x16_bf16 v[176:191], v[220:223], v[152:155], v[176:191]
    s_add_u32 m0, s38, 155648
    ds_read_b128 v[204:207], v32 offset:20480
    v_exp_f32 v112, v112
    v_exp_f32 v113, v113
    v_exp_f32 v114, v114
    v_exp_f32 v115, v115
    v_mfma_f32_32x32x16_bf16 v[176:191], v[224:227], v[156:159], v[176:191]
    ds_read_b128 v[208:211], v32 offset:21504
    v_exp_f32 v116, v116
    v_exp_f32 v117, v117
    v_exp_f32 v118, v118
    v_exp_f32 v119, v119
    v_mfma_f32_32x32x16_bf16 v[128:143], v[212:215], v[72:75], v[96:111]
    buffer_load_dwordx4 v253, s[16:19], s43 offen sc1 lds
    v_cvt_pk_bf16_f32 v144, v112, v113
    v_exp_f32 v120, v120
    v_exp_f32 v121, v121
    v_cvt_pk_bf16_f32 v145, v114, v115
    v_cvt_pk_bf16_f32 v146, v116, v117
    v_mfma_f32_32x32x16_bf16 v[128:143], v[216:219], v[76:79], v[128:143]
    s_add_u32 m0, s38, 159744
    v_cvt_pk_bf16_f32 v147, v118, v119
    v_exp_f32 v122, v122
    v_exp_f32 v123, v123
    v_exp_f32 v124, v124
    v_exp_f32 v125, v125
    v_mfma_f32_16x16x32_bf16 v[196:199], v[200:203], v[152:155], v[196:199]
    buffer_load_dwordx4 v33, s[16:19], s43 offen sc1 lds
    v_cvt_pk_bf16_f32 v148, v120, v121
    v_exp_f32 v126, v126
    v_mfma_f32_16x16x32_bf16 v[196:199], v[200:203], v[156:159], v[196:199]
    s_waitcnt lgkmcnt(0)
    v_cvt_pk_bf16_f32 v149, v122, v123
    v_exp_f32 v127, v127
    v_cvt_pk_bf16_f32 v150, v124, v125
    v_cvt_pk_bf16_f32 v151, v126, v127
    v_mfma_f32_32x32x16_bf16 v[160:175], v[228:231], v[144:147], v[160:175]
    s_add_u32 s42, s42, 8192
    ds_read_b64_tr_b16 v[220:221], v31 offset:20480
    v_exp_f32 v128, v128
    v_exp_f32 v129, v129
    v_exp_f32 v130, v130
    v_exp_f32 v131, v131
    v_mfma_f32_32x32x16_bf16 v[160:175], v[232:235], v[148:151], v[160:175]
    s_add_u32 s43, s43, 8192
    ds_read_b64_tr_b16 v[222:223], v30 offset:20480
    v_exp_f32 v132, v132
    v_exp_f32 v133, v133
    v_exp_f32 v134, v134
    v_exp_f32 v135, v135
    v_mfma_f32_32x32x16_bf16 v[112:127], v[204:207], v[64:67], v[80:95]
    ds_read_b64_tr_b16 v[224:225], v31 offset:20736
    v_cvt_pk_bf16_f32 v152, v128, v129
    v_exp_f32 v136, v136
    v_exp_f32 v137, v137
    v_cvt_pk_bf16_f32 v153, v130, v131
    v_exp_f32 v138, v138
    v_mfma_f32_32x32x16_bf16 v[112:127], v[208:211], v[68:71], v[112:127]
    ds_read_b64_tr_b16 v[226:227], v30 offset:20736
    v_exp_f32 v139, v139
    v_cvt_pk_bf16_f32 v154, v132, v133
    v_exp_f32 v140, v140
    v_exp_f32 v141, v141
    v_cvt_pk_bf16_f32 v155, v134, v135
    v_mfma_f32_16x16x32_bf16 v[192:195], v[200:203], v[144:147], v[192:195]
    v_exp_f32 v142, v142
    v_cvt_pk_bf16_f32 v156, v136, v137
    v_cvt_pk_bf16_f32 v157, v138, v139
    v_mfma_f32_16x16x32_bf16 v[192:195], v[200:203], v[148:151], v[192:195]
    v_exp_f32 v143, v143
    v_cvt_pk_bf16_f32 v158, v140, v141
    v_cvt_pk_bf16_f32 v159, v142, v143
    v_mfma_f32_32x32x16_bf16 v[176:191], v[228:231], v[152:155], v[176:191]
    ds_read_b128 v[212:215], v32 offset:22528
    v_exp_f32 v112, v112
    v_exp_f32 v113, v113
    v_exp_f32 v114, v114
    v_exp_f32 v115, v115
    v_mfma_f32_32x32x16_bf16 v[176:191], v[232:235], v[156:159], v[176:191]
    ds_read_b128 v[216:219], v32 offset:23552
    v_cvt_pk_bf16_f32 v144, v112, v113
    v_exp_f32 v116, v116
    v_exp_f32 v117, v117
    v_exp_f32 v118, v118
    v_mfma_f32_32x32x16_bf16 v[128:143], v[204:207], v[72:75], v[96:111]
    v_exp_f32 v119, v119
    v_exp_f32 v120, v120
    v_exp_f32 v121, v121
    v_cvt_pk_bf16_f32 v145, v114, v115
    v_exp_f32 v122, v122
    v_mfma_f32_32x32x16_bf16 v[128:143], v[208:211], v[76:79], v[128:143]
    v_exp_f32 v123, v123
    v_cvt_pk_bf16_f32 v146, v116, v117
    v_cvt_pk_bf16_f32 v147, v118, v119
    v_exp_f32 v124, v124
    v_exp_f32 v125, v125
    v_mfma_f32_16x16x32_bf16 v[196:199], v[200:203], v[152:155], v[196:199]
    v_exp_f32 v126, v126
    v_cvt_pk_bf16_f32 v148, v120, v121
    v_cvt_pk_bf16_f32 v149, v122, v123
    v_mfma_f32_16x16x32_bf16 v[196:199], v[200:203], v[156:159], v[196:199]
    s_waitcnt lgkmcnt(0)
    v_exp_f32 v127, v127
    v_cvt_pk_bf16_f32 v150, v124, v125
    v_cvt_pk_bf16_f32 v151, v126, v127
    v_mfma_f32_32x32x16_bf16 v[160:175], v[220:223], v[144:147], v[160:175]
    ds_read_b64_tr_b16 v[228:229], v31 offset:22528
    v_exp_f32 v128, v128
    v_exp_f32 v129, v129
    v_exp_f32 v130, v130
    v_exp_f32 v131, v131
    v_mfma_f32_32x32x16_bf16 v[160:175], v[224:227], v[148:151], v[160:175]
    ds_read_b64_tr_b16 v[230:231], v30 offset:22528
    v_exp_f32 v132, v132
    v_exp_f32 v133, v133
    v_exp_f32 v134, v134
    v_exp_f32 v135, v135
    v_mfma_f32_32x32x16_bf16 v[112:127], v[212:215], v[64:67], v[80:95]
    ds_read_b64_tr_b16 v[232:233], v31 offset:22784
    v_cvt_pk_bf16_f32 v152, v128, v129
    v_exp_f32 v136, v136
    v_exp_f32 v137, v137
    v_cvt_pk_bf16_f32 v153, v130, v131
    v_exp_f32 v138, v138
    v_mfma_f32_32x32x16_bf16 v[112:127], v[216:219], v[68:71], v[112:127]
    ds_read_b64_tr_b16 v[234:235], v30 offset:22784
    v_exp_f32 v139, v139
    v_cvt_pk_bf16_f32 v154, v132, v133
    v_exp_f32 v140, v140
    v_exp_f32 v141, v141
    v_cvt_pk_bf16_f32 v155, v134, v135
    v_mfma_f32_16x16x32_bf16 v[192:195], v[200:203], v[144:147], v[192:195]
    v_exp_f32 v142, v142
    v_cvt_pk_bf16_f32 v156, v136, v137
    v_cvt_pk_bf16_f32 v157, v138, v139
    v_mfma_f32_16x16x32_bf16 v[192:195], v[200:203], v[148:151], v[192:195]
    v_exp_f32 v143, v143
    v_cvt_pk_bf16_f32 v158, v140, v141
    v_cvt_pk_bf16_f32 v159, v142, v143
    s_add_u32 s45, s45, 1
    s_cmp_lt_u32 s45, 4
    s_cbranch_scc1 L_at_r
    v_mfma_f32_32x32x16_bf16 v[176:191], v[220:223], v[152:155], v[176:191]
    s_waitcnt vmcnt(6) lgkmcnt(0)
    s_barrier
    v_exp_f32 v112, v112
    v_exp_f32 v113, v113
    v_exp_f32 v114, v114
    v_exp_f32 v115, v115
    v_cvt_pk_bf16_f32 v144, v112, v113
    v_mfma_f32_32x32x16_bf16 v[176:191], v[224:227], v[156:159], v[176:191]
    ds_read_b128 v[204:207], v32 offset:0
    v_exp_f32 v116, v116
    v_exp_f32 v117, v117
    v_exp_f32 v118, v118
    v_exp_f32 v119, v119
    v_mfma_f32_32x32x16_bf16 v[128:143], v[212:215], v[72:75], v[96:111]
    ds_read_b128 v[208:211], v32 offset:1024
    v_exp_f32 v120, v120
    v_exp_f32 v121, v121
    v_cvt_pk_bf16_f32 v145, v114, v115
    v_exp_f32 v122, v122
    v_exp_f32 v123, v123
    v_mfma_f32_32x32x16_bf16 v[128:143], v[216:219], v[76:79], v[128:143]
    s_mov_b64 exec, 1
    buffer_store_dwordx2 v[250:251], off, s[16:19], s73 sc1
    s_mov_b64 exec, -1
    v_cvt_pk_bf16_f32 v146, v116, v117
    v_cvt_pk_bf16_f32 v147, v118, v119
    v_exp_f32 v124, v124
    v_mfma_f32_16x16x32_bf16 v[196:199], v[200:203], v[152:155], v[196:199]
    v_cvt_pk_bf16_f32 v148, v120, v121
    v_exp_f32 v125, v125
    v_exp_f32 v126, v126
    v_mfma_f32_16x16x32_bf16 v[196:199], v[200:203], v[156:159], v[196:199]
    s_waitcnt lgkmcnt(0)
    v_cvt_pk_bf16_f32 v149, v122, v123
    v_exp_f32 v127, v127
    v_cvt_pk_bf16_f32 v150, v124, v125
    v_cvt_pk_bf16_f32 v151, v126, v127
    v_mfma_f32_32x32x16_bf16 v[160:175], v[228:231], v[144:147], v[160:175]
    ds_read_b64_tr_b16 v[220:221], v31 offset:0
    v_exp_f32 v128, v128
    v_exp_f32 v129, v129
    v_exp_f32 v130, v130
    v_exp_f32 v131, v131
    v_mfma_f32_32x32x16_bf16 v[160:175], v[232:235], v[148:151], v[160:175]
    ds_read_b64_tr_b16 v[222:223], v30 offset:0
    v_exp_f32 v132, v132
    v_exp_f32 v133, v133
    v_exp_f32 v134, v134
    v_exp_f32 v135, v135
    v_mfma_f32_32x32x16_bf16 v[112:127], v[204:207], v[64:67], v[80:95]
    ds_read_b64_tr_b16 v[224:225], v31 offset:256
    v_cvt_pk_bf16_f32 v152, v128, v129
    v_cvt_pk_bf16_f32 v153, v130, v131
    v_exp_f32 v136, v136
    v_exp_f32 v137, v137
    v_exp_f32 v138, v138
    v_mfma_f32_32x32x16_bf16 v[112:127], v[208:211], v[68:71], v[112:127]
    ds_read_b64_tr_b16 v[226:227], v30 offset:256
    v_exp_f32 v139, v139
    v_cvt_pk_bf16_f32 v154, v132, v133
    v_cvt_pk_bf16_f32 v155, v134, v135
    v_exp_f32 v140, v140
    v_exp_f32 v141, v141
    v_mfma_f32_16x16x32_bf16 v[192:195], v[200:203], v[144:147], v[192:195]
    buffer_load_dwordx4 v[58:61], v27, s[8:11], 0 offen
    v_cvt_pk_bf16_f32 v156, v136, v137
    v_exp_f32 v142, v142
    v_mfma_f32_16x16x32_bf16 v[192:195], v[200:203], v[148:151], v[192:195]
    v_cvt_pk_bf16_f32 v157, v138, v139
    v_exp_f32 v143, v143
    v_cvt_pk_bf16_f32 v158, v140, v141
    v_cvt_pk_bf16_f32 v159, v142, v143
    v_mfma_f32_32x32x16_bf16 v[176:191], v[228:231], v[152:155], v[176:191]
    s_add_u32 m0, s38, 131072
    ds_read_b128 v[212:215], v32 offset:2048
    v_exp_f32 v112, v112
    v_exp_f32 v113, v113
    v_exp_f32 v114, v114
    v_exp_f32 v115, v115
    v_mfma_f32_32x32x16_bf16 v[176:191], v[232:235], v[156:159], v[176:191]
    ds_read_b128 v[216:219], v32 offset:3072
    v_exp_f32 v116, v116
    v_exp_f32 v117, v117
    v_exp_f32 v118, v118
    v_exp_f32 v119, v119
    v_mfma_f32_32x32x16_bf16 v[128:143], v[204:207], v[72:75], v[96:111]
    buffer_load_dwordx4 v253, s[16:19], s42 offen sc1 lds
    v_cvt_pk_bf16_f32 v144, v112, v113
    v_exp_f32 v120, v120
    v_exp_f32 v121, v121
    v_cvt_pk_bf16_f32 v145, v114, v115
    v_cvt_pk_bf16_f32 v146, v116, v117
    v_mfma_f32_32x32x16_bf16 v[128:143], v[208:211], v[76:79], v[128:143]
    s_add_u32 m0, s38, 135168
    v_cvt_pk_bf16_f32 v147, v118, v119
    v_exp_f32 v122, v122
    v_exp_f32 v123, v123
    v_exp_f32 v124, v124
    v_exp_f32 v125, v125
    v_mfma_f32_16x16x32_bf16 v[196:199], v[200:203], v[152:155], v[196:199]
    buffer_load_dwordx4 v33, s[16:19], s42 offen sc1 lds
    v_cvt_pk_bf16_f32 v148, v120, v121
    v_exp_f32 v126, v126
    v_mfma_f32_16x16x32_bf16 v[196:199], v[200:203], v[156:159], v[196:199]
    s_waitcnt lgkmcnt(0)
    v_cvt_pk_bf16_f32 v149, v122, v123
    v_exp_f32 v127, v127
    v_cvt_pk_bf16_f32 v150, v124, v125
    v_cvt_pk_bf16_f32 v151, v126, v127
    v_mfma_f32_32x32x16_bf16 v[160:175], v[220:223], v[144:147], v[160:175]
    ds_read_b64_tr_b16 v[228:229], v31 offset:2048
    v_exp_f32 v128, v128
    v_exp_f32 v129, v129
    v_exp_f32 v130, v130
    v_exp_f32 v131, v131
    v_exp_f32 v132, v132
    v_mfma_f32_32x32x16_bf16 v[160:175], v[224:227], v[148:151], v[160:175]
    ds_read_b64_tr_b16 v[230:231], v30 offset:2048
    v_cvt_pk_bf16_f32 v152, v128, v129
    v_exp_f32 v133, v133
    v_exp_f32 v134, v134
    v_exp_f32 v135, v135
    v_exp_f32 v136, v136
    v_mfma_f32_32x32x16_bf16 v[112:127], v[212:215], v[64:67], v[80:95]
    ds_read_b64_tr_b16 v[232:233], v31 offset:2304
    buffer_load_dwordx4 v[42:45], v26, s[20:23], 0 offen
    v_exp_f32 v137, v137
    v_cvt_pk_bf16_f32 v153, v130, v131
    v_exp_f32 v138, v138
    v_exp_f32 v139, v139
    v_mfma_f32_32x32x16_bf16 v[112:127], v[216:219], v[68:71], v[112:127]
    ds_read_b64_tr_b16 v[234:235], v30 offset:2304
    buffer_load_dwordx4 v[46:49], v26, s[20:23], s3 offen
    v_cvt_pk_bf16_f32 v154, v132, v133
    v_cvt_pk_bf16_f32 v155, v134, v135
    v_exp_f32 v140, v140
    v_exp_f32 v141, v141
    v_mfma_f32_16x16x32_bf16 v[192:195], v[200:203], v[144:147], v[192:195]
    buffer_load_dwordx4 v[50:53], v26, s[20:23], s40 offen
    v_exp_f32 v142, v142
    v_cvt_pk_bf16_f32 v156, v136, v137
    v_cvt_pk_bf16_f32 v157, v138, v139
    v_mfma_f32_16x16x32_bf16 v[192:195], v[200:203], v[148:151], v[192:195]
    buffer_load_dwordx4 v[54:57], v26, s[20:23], s41 offen
    v_exp_f32 v143, v143
    v_cvt_pk_bf16_f32 v158, v140, v141
    v_cvt_pk_bf16_f32 v159, v142, v143
    v_mfma_f32_32x32x16_bf16 v[176:191], v[220:223], v[152:155], v[176:191]
    s_add_u32 m0, s38, 139264
    ds_read_b128 v[204:207], v32 offset:4096
    buffer_load_dwordx4 v253, s[16:19], s43 offen sc1 lds
    v_exp_f32 v112, v112
    v_exp_f32 v113, v113
    v_exp_f32 v114, v114
    v_cvt_pk_bf16_f32 v144, v112, v113
    v_mfma_f32_32x32x16_bf16 v[176:191], v[224:227], v[156:159], v[176:191]
    s_add_u32 m0, s38, 143360
    ds_read_b128 v[208:211], v32 offset:5120
    v_exp_f32 v115, v115
    v_exp_f32 v116, v116
    v_exp_f32 v117, v117
    v_exp_f32 v118, v118
    v_exp_f32 v119, v119
    v_mfma_f32_32x32x16_bf16 v[128:143], v[212:215], v[72:75], v[96:111]
    buffer_load_dwordx4 v33, s[16:19], s43 offen sc1 lds
    s_add_u32 m0, s54, 0
    v_exp_f32 v120, v120
    v_exp_f32 v121, v121
    v_cvt_pk_bf16_f32 v145, v114, v115
    v_exp_f32 v122, v122
    v_mfma_f32_32x32x16_bf16 v[128:143], v[216:219], v[76:79], v[128:143]
    buffer_load_dwordx4 v4, s[80:83], s60 offen lds
    s_add_u32 m0, s54, 1024
    v_exp_f32 v123, v123
    v_cvt_pk_bf16_f32 v146, v116, v117
    v_cvt_pk_bf16_f32 v147, v118, v119
    v_exp_f32 v124, v124
    v_mfma_f32_16x16x32_bf16 v[196:199], v[200:203], v[152:155], v[196:199]
    buffer_load_dwordx4 v5, s[80:83], s60 offen lds
    s_add_u32 s60, s60, 65536
    v_exp_f32 v125, v125
    v_exp_f32 v126, v126
    v_mfma_f32_16x16x32_bf16 v[196:199], v[200:203], v[156:159], v[196:199]
    s_waitcnt lgkmcnt(0)
    v_cvt_pk_bf16_f32 v148, v120, v121
    v_cvt_pk_bf16_f32 v149, v122, v123
    v_exp_f32 v127, v127
    v_cvt_pk_bf16_f32 v150, v124, v125
    v_cvt_pk_bf16_f32 v151, v126, v127
    v_mfma_f32_32x32x16_bf16 v[160:175], v[228:231], v[144:147], v[160:175]
    s_add_u32 s42, s42, 8192
    ds_read_b64_tr_b16 v[220:221], v31 offset:4096
    s_add_u32 s43, s43, 8192
    v_exp_f32 v128, v128
    v_exp_f32 v129, v129
    v_exp_f32 v130, v130
    v_exp_f32 v131, v131
    v_cvt_pk_bf16_f32 v152, v128, v129
    v_mfma_f32_32x32x16_bf16 v[160:175], v[232:235], v[148:151], v[160:175]
    s_add_u32 m0, s54, 8192
    ds_read_b64_tr_b16 v[222:223], v30 offset:4096
    v_exp_f32 v132, v132
    v_exp_f32 v133, v133
    v_exp_f32 v134, v134
    v_exp_f32 v135, v135
    v_exp_f32 v136, v136
    v_mfma_f32_32x32x16_bf16 v[112:127], v[204:207], v[64:67], v[80:95]
    ds_read_b64_tr_b16 v[224:225], v31 offset:4352
    buffer_load_dwordx4 v4, s[80:83], s60 offen lds
    s_add_u32 m0, s54, 9216
    v_exp_f32 v137, v137
    v_cvt_pk_bf16_f32 v153, v130, v131
    v_exp_f32 v138, v138
    v_cvt_pk_bf16_f32 v154, v132, v133
    v_mfma_f32_32x32x16_bf16 v[112:127], v[208:211], v[68:71], v[112:127]
    ds_read_b64_tr_b16 v[226:227], v30 offset:4352
    buffer_load_dwordx4 v5, s[80:83], s60 offen lds
    s_add_u32 s60, s60, 65536
    s_add_u32 m0, s54, 16384
    v_exp_f32 v139, v139
    v_exp_f32 v140, v140
    v_cvt_pk_bf16_f32 v155, v134, v135
    v_mfma_f32_16x16x32_bf16 v[192:195], v[200:203], v[144:147], v[192:195]
    buffer_load_dwordx4 v4, s[80:83], s60 offen lds
    v_exp_f32 v141, v141
    v_exp_f32 v142, v142
    v_mfma_f32_16x16x32_bf16 v[192:195], v[200:203], v[148:151], v[192:195]
    v_cvt_pk_bf16_f32 v156, v136, v137
    v_cvt_pk_bf16_f32 v157, v138, v139
    v_exp_f32 v143, v143
    v_cvt_pk_bf16_f32 v158, v140, v141
    v_cvt_pk_bf16_f32 v159, v142, v143
    v_mfma_f32_32x32x16_bf16 v[176:191], v[228:231], v[152:155], v[176:191]
    s_add_u32 m0, s54, 17408
    ds_read_b128 v[212:215], v32 offset:6144
    v_exp_f32 v112, v112
    v_exp_f32 v113, v113
    v_exp_f32 v114, v114
    v_exp_f32 v115, v115
    v_cvt_pk_bf16_f32 v144, v112, v113
    v_mfma_f32_32x32x16_bf16 v[176:191], v[232:235], v[156:159], v[176:191]
    ds_read_b128 v[216:219], v32 offset:7168
    buffer_load_dwordx4 v5, s[80:83], s60 offen lds
    s_add_u32 s60, s60, 65536
    v_exp_f32 v116, v116
    v_exp_f32 v117, v117
    v_cvt_pk_bf16_f32 v145, v114, v115
    v_mfma_f32_32x32x16_bf16 v[128:143], v[204:207], v[72:75], v[96:111]
    s_add_u32 m0, s54, 24576
    v_exp_f32 v118, v118
    v_exp_f32 v119, v119
    v_exp_f32 v120, v120
    v_exp_f32 v121, v121
    v_exp_f32 v122, v122
    v_mfma_f32_32x32x16_bf16 v[128:143], v[208:211], v[76:79], v[128:143]
    buffer_load_dwordx4 v4, s[80:83], s60 offen lds
    v_exp_f32 v123, v123
    v_cvt_pk_bf16_f32 v146, v116, v117
    v_exp_f32 v124, v124
    v_exp_f32 v125, v125
    v_mfma_f32_16x16x32_bf16 v[196:199], v[200:203], v[152:155], v[196:199]
    s_add_u32 m0, s54, 25600
    v_cvt_pk_bf16_f32 v147, v118, v119
    v_exp_f32 v126, v126
    v_cvt_pk_bf16_f32 v148, v120, v121
    v_cvt_pk_bf16_f32 v149, v122, v123
    v_cvt_pk_bf16_f32 v150, v124, v125
    v_mfma_f32_16x16x32_bf16 v[196:199], v[200:203], v[156:159], v[196:199]
    s_waitcnt lgkmcnt(0)
    buffer_load_dwordx4 v5, s[80:83], s60 offen lds
    s_add_u32 s60, s60, 65536
    v_exp_f32 v127, v127
    s_nop 0
    v_cvt_pk_bf16_f32 v151, v126, v127
    v_mfma_f32_32x32x16_bf16 v[160:175], v[220:223], v[144:147], v[160:175]
    s_add_u32 m0, s54, 32768
    ds_read_b64_tr_b16 v[228:229], v31 offset:6144
    v_exp_f32 v128, v128
    v_exp_f32 v129, v129
    v_exp_f32 v130, v130
    v_cvt_pk_bf16_f32 v152, v128, v129
    v_exp_f32 v131, v131
    v_mfma_f32_32x32x16_bf16 v[160:175], v[224:227], v[148:151], v[160:175]
    ds_read_b64_tr_b16 v[230:231], v30 offset:6144
    buffer_load_dwordx4 v4, s[80:83], s60 offen lds
    v_exp_f32 v132, v132
    v_exp_f32 v133, v133
    v_exp_f32 v134, v134
    v_mfma_f32_32x32x16_bf16 v[112:127], v[212:215], v[64:67], v[80:95]
    s_add_u32 m0, s54, 33792
    ds_read_b64_tr_b16 v[232:233], v31 offset:6400
    v_exp_f32 v135, v135
    v_exp_f32 v136, v136
    v_exp_f32 v137, v137
    v_cvt_pk_bf16_f32 v153, v130, v131
    v_exp_f32 v138, v138
    v_cvt_pk_bf16_f32 v154, v132, v133
    v_mfma_f32_32x32x16_bf16 v[112:127], v[216:219], v[68:71], v[112:127]
    ds_read_b64_tr_b16 v[234:235], v30 offset:6400
    buffer_load_dwordx4 v5, s[80:83], s60 offen lds
    s_add_u32 s60, s60, 65536
    v_cvt_pk_bf16_f32 v155, v134, v135
    v_exp_f32 v139, v139
    v_exp_f32 v140, v140
    v_mfma_f32_16x16x32_bf16 v[192:195], v[200:203], v[144:147], v[192:195]
    s_add_u32 m0, s54, 40960
    v_exp_f32 v141, v141
    v_exp_f32 v142, v142
    v_cvt_pk_bf16_f32 v156, v136, v137
    v_cvt_pk_bf16_f32 v157, v138, v139
    v_mfma_f32_16x16x32_bf16 v[192:195], v[200:203], v[148:151], v[192:195]
    buffer_load_dwordx4 v4, s[80:83], s60 offen lds
    v_exp_f32 v143, v143
    v_cvt_pk_bf16_f32 v158, v140, v141
    v_cvt_pk_bf16_f32 v159, v142, v143
    v_mfma_f32_32x32x16_bf16 v[176:191], v[220:223], v[152:155], v[176:191]
    s_waitcnt vmcnt(21) lgkmcnt(0)
    s_barrier
    v_exp_f32 v112, v112
    v_exp_f32 v113, v113
    v_exp_f32 v114, v114
    v_cvt_pk_bf16_f32 v144, v112, v113
    v_exp_f32 v115, v115
    v_mfma_f32_32x32x16_bf16 v[176:191], v[224:227], v[156:159], v[176:191]
    s_add_u32 m0, s54, 41984
    ds_read_b128 v[204:207], v32 offset:32768
    buffer_load_dwordx4 v5, s[80:83], s60 offen lds
    s_add_u32 s60, s60, 65536
    v_cvt_pk_bf16_f32 v145, v114, v115
    v_exp_f32 v116, v116
    v_exp_f32 v117, v117
    v_mfma_f32_32x32x16_bf16 v[128:143], v[212:215], v[72:75], v[96:111]
    s_add_u32 m0, s54, 49152
    ds_read_b128 v[208:211], v32 offset:33792
    v_exp_f32 v118, v118
    v_exp_f32 v119, v119
    v_exp_f32 v120, v120
    v_exp_f32 v121, v121
    v_exp_f32 v122, v122
    v_mfma_f32_32x32x16_bf16 v[128:143], v[216:219], v[76:79], v[128:143]
    buffer_load_dwordx4 v4, s[80:83], s60 offen lds
    s_add_u32 m0, s54, 50176
    v_exp_f32 v123, v123
    v_cvt_pk_bf16_f32 v146, v116, v117
    v_cvt_pk_bf16_f32 v147, v118, v119
    v_exp_f32 v124, v124
    v_mfma_f32_16x16x32_bf16 v[196:199], v[200:203], v[152:155], v[196:199]
    buffer_load_dwordx4 v5, s[80:83], s60 offen lds
    s_add_u32 s60, s60, 65536
    v_exp_f32 v125, v125
    v_exp_f32 v126, v126
    v_mfma_f32_16x16x32_bf16 v[196:199], v[200:203], v[156:159], v[196:199]
    s_waitcnt lgkmcnt(0)
    v_cvt_pk_bf16_f32 v148, v120, v121
    v_cvt_pk_bf16_f32 v149, v122, v123
    v_exp_f32 v127, v127
    v_cvt_pk_bf16_f32 v150, v124, v125
    v_cvt_pk_bf16_f32 v151, v126, v127
    v_mfma_f32_32x32x16_bf16 v[160:175], v[228:231], v[144:147], v[160:175]
    s_add_u32 m0, s54, 57344
    ds_read_b64_tr_b16 v[220:221], v31 offset:32768
    v_exp_f32 v128, v128
    v_exp_f32 v129, v129
    v_exp_f32 v130, v130
    v_cvt_pk_bf16_f32 v152, v128, v129
    v_exp_f32 v131, v131
    v_mfma_f32_32x32x16_bf16 v[160:175], v[232:235], v[148:151], v[160:175]
    ds_read_b64_tr_b16 v[222:223], v30 offset:32768
    buffer_load_dwordx4 v4, s[80:83], s60 offen lds
    v_exp_f32 v132, v132
    v_exp_f32 v133, v133
    v_exp_f32 v134, v134
    v_mfma_f32_32x32x16_bf16 v[112:127], v[204:207], v[64:67], v[80:95]
    s_add_u32 m0, s54, 58368
    ds_read_b64_tr_b16 v[224:225], v31 offset:33024
    v_exp_f32 v135, v135
    v_exp_f32 v136, v136
    v_exp_f32 v137, v137
    v_cvt_pk_bf16_f32 v153, v130, v131
    v_exp_f32 v138, v138
    v_cvt_pk_bf16_f32 v154, v132, v133
    v_mfma_f32_32x32x16_bf16 v[112:127], v[208:211], v[68:71], v[112:127]
    ds_read_b64_tr_b16 v[226:227], v30 offset:33024
    buffer_load_dwordx4 v5, s[80:83], s60 offen lds
    s_add_u32 s60, s60, 65536
    v_cvt_pk_bf16_f32 v155, v134, v135
    v_exp_f32 v139, v139
    v_exp_f32 v140, v140
    v_mfma_f32_16x16x32_bf16 v[192:195], v[200:203], v[144:147], v[192:195]
    s_add_u32 m0, s54, 65536
    v_exp_f32 v141, v141
    v_exp_f32 v142, v142
    v_cvt_pk_bf16_f32 v156, v136, v137
    v_cvt_pk_bf16_f32 v157, v138, v139
    v_mfma_f32_16x16x32_bf16 v[192:195], v[200:203], v[148:151], v[192:195]
    buffer_load_dwordx4 v4, s[80:83], s60 offen lds
    v_exp_f32 v143, v143
    v_cvt_pk_bf16_f32 v158, v140, v141
    v_cvt_pk_bf16_f32 v159, v142, v143
    v_mfma_f32_32x32x16_bf16 v[176:191], v[228:231], v[152:155], v[176:191]
    s_add_u32 m0, s54, 66560
    ds_read_b128 v[212:215], v32 offset:34816
    v_exp_f32 v112, v112
    v_exp_f32 v113, v113
    v_exp_f32 v114, v114
    v_exp_f32 v115, v115
    v_cvt_pk_bf16_f32 v144, v112, v113
    v_mfma_f32_32x32x16_bf16 v[176:191], v[232:235], v[156:159], v[176:191]
    ds_read_b128 v[216:219], v32 offset:35840
    buffer_load_dwordx4 v5, s[80:83], s60 offen lds
    s_add_u32 s60, s60, 65536
    v_exp_f32 v116, v116
    v_exp_f32 v117, v117
    v_cvt_pk_bf16_f32 v145, v114, v115
    v_mfma_f32_32x32x16_bf16 v[128:143], v[204:207], v[72:75], v[96:111]
    s_add_u32 m0, s54, 73728
    v_exp_f32 v118, v118
    v_exp_f32 v119, v119
    v_exp_f32 v120, v120
    v_exp_f32 v121, v121
    v_exp_f32 v122, v122
    v_mfma_f32_32x32x16_bf16 v[128:143], v[208:211], v[76:79], v[128:143]
    buffer_load_dwordx4 v4, s[80:83], s60 offen lds
    v_exp_f32 v123, v123
    v_cvt_pk_bf16_f32 v146, v116, v117
    v_exp_f32 v124, v124
    v_exp_f32 v125, v125
    v_mfma_f32_16x16x32_bf16 v[196:199], v[200:203], v[152:155], v[196:199]
    s_add_u32 m0, s54, 74752
    v_cvt_pk_bf16_f32 v147, v118, v119
    v_exp_f32 v126, v126
    v_cvt_pk_bf16_f32 v148, v120, v121
    v_cvt_pk_bf16_f32 v149, v122, v123
    v_cvt_pk_bf16_f32 v150, v124, v125
    v_mfma_f32_16x16x32_bf16 v[196:199], v[200:203], v[156:159], v[196:199]
    s_waitcnt lgkmcnt(0)
    buffer_load_dwordx4 v5, s[80:83], s60 offen lds
    s_add_u32 s60, s60, 65536
    v_exp_f32 v127, v127
    s_nop 0
    v_cvt_pk_bf16_f32 v151, v126, v127
    v_mfma_f32_32x32x16_bf16 v[160:175], v[220:223], v[144:147], v[160:175]
    ds_read_b64_tr_b16 v[228:229], v31 offset:34816
    buffer_load_dwordx2 v[8:9], v6, s[16:19], s74 offen sc1
    s_add_u32 m0, s54, 81920
    v_exp_f32 v128, v128
    v_exp_f32 v129, v129
    v_exp_f32 v130, v130
    v_mfma_f32_32x32x16_bf16 v[160:175], v[224:227], v[148:151], v[160:175]
    ds_read_b64_tr_b16 v[230:231], v30 offset:34816
    buffer_load_dwordx4 v4, s[80:83], s60 offen lds
    s_add_u32 m0, s54, 82944
    v_exp_f32 v131, v131
    v_exp_f32 v132, v132
    v_exp_f32 v133, v133
    v_mfma_f32_32x32x16_bf16 v[112:127], v[212:215], v[64:67], v[80:95]
    ds_read_b64_tr_b16 v[232:233], v31 offset:35072
    v_exp_f32 v134, v134
    v_exp_f32 v135, v135
    v_cvt_pk_bf16_f32 v152, v128, v129
    v_exp_f32 v136, v136
    v_exp_f32 v137, v137
    v_cvt_pk_bf16_f32 v153, v130, v131
    v_cvt_pk_bf16_f32 v154, v132, v133
    v_mfma_f32_32x32x16_bf16 v[112:127], v[216:219], v[68:71], v[112:127]
    ds_read_b64_tr_b16 v[234:235], v30 offset:35072
    buffer_load_dwordx4 v5, s[80:83], s60 offen lds
    s_add_u32 s60, s60, 65536
    s_add_u32 m0, s54, 90112
    v_cvt_pk_bf16_f32 v155, v134, v135
    v_exp_f32 v138, v138
    v_exp_f32 v139, v139
    v_mfma_f32_16x16x32_bf16 v[192:195], v[200:203], v[144:147], v[192:195]
    buffer_load_dwordx4 v4, s[80:83], s60 offen lds
    v_cvt_pk_bf16_f32 v156, v136, v137
    v_exp_f32 v140, v140
    v_exp_f32 v141, v141
    v_mfma_f32_16x16x32_bf16 v[192:195], v[200:203], v[148:151], v[192:195]
    v_cvt_pk_bf16_f32 v157, v138, v139
    v_exp_f32 v142, v142
    v_exp_f32 v143, v143
    v_cvt_pk_bf16_f32 v158, v140, v141
    v_cvt_pk_bf16_f32 v159, v142, v143
    v_mfma_f32_32x32x16_bf16 v[176:191], v[220:223], v[152:155], v[176:191]
    s_add_u32 m0, s54, 91136
    ds_read_b128 v[204:207], v32 offset:36864
    v_exp_f32 v112, v112
    v_exp_f32 v113, v113
    v_exp_f32 v114, v114
    v_exp_f32 v115, v115
    v_cvt_pk_bf16_f32 v144, v112, v113
    v_mfma_f32_32x32x16_bf16 v[176:191], v[224:227], v[156:159], v[176:191]
    ds_read_b128 v[208:211], v32 offset:37888
    buffer_load_dwordx4 v5, s[80:83], s60 offen lds
    s_add_u32 s60, s60, 65536
    v_exp_f32 v116, v116
    v_exp_f32 v117, v117
    v_cvt_pk_bf16_f32 v145, v114, v115
    v_mfma_f32_32x32x16_bf16 v[128:143], v[212:215], v[72:75], v[96:111]
    s_add_u32 m0, s54, 98304
    v_exp_f32 v118, v118
    v_exp_f32 v119, v119
    v_exp_f32 v120, v120
    v_exp_f32 v121, v121
    v_exp_f32 v122, v122
    v_mfma_f32_32x32x16_bf16 v[128:143], v[216:219], v[76:79], v[128:143]
    buffer_load_dwordx4 v4, s[80:83], s60 offen lds
    v_exp_f32 v123, v123
    v_cvt_pk_bf16_f32 v146, v116, v117
    v_exp_f32 v124, v124
    v_exp_f32 v125, v125
    v_mfma_f32_16x16x32_bf16 v[196:199], v[200:203], v[152:155], v[196:199]
    s_add_u32 m0, s54, 99328
    v_cvt_pk_bf16_f32 v147, v118, v119
    v_exp_f32 v126, v126
    v_cvt_pk_bf16_f32 v148, v120, v121
    v_cvt_pk_bf16_f32 v149, v122, v123
    v_cvt_pk_bf16_f32 v150, v124, v125
    v_mfma_f32_16x16x32_bf16 v[196:199], v[200:203], v[156:159], v[196:199]
    s_waitcnt lgkmcnt(0)
    buffer_load_dwordx4 v5, s[80:83], s60 offen lds
    s_add_u32 s60, s60, 65536
    v_exp_f32 v127, v127
    s_nop 0
    v_cvt_pk_bf16_f32 v151, v126, v127
    v_mfma_f32_32x32x16_bf16 v[160:175], v[228:231], v[144:147], v[160:175]
    s_add_u32 m0, s54, 106496
    ds_read_b64_tr_b16 v[220:221], v31 offset:36864
    v_exp_f32 v128, v128
    v_exp_f32 v129, v129
    v_exp_f32 v130, v130
    v_cvt_pk_bf16_f32 v152, v128, v129
    v_exp_f32 v131, v131
    v_mfma_f32_32x32x16_bf16 v[160:175], v[232:235], v[148:151], v[160:175]
    ds_read_b64_tr_b16 v[222:223], v30 offset:36864
    buffer_load_dwordx4 v4, s[80:83], s60 offen lds
    v_exp_f32 v132, v132
    v_exp_f32 v133, v133
    v_exp_f32 v134, v134
    v_mfma_f32_32x32x16_bf16 v[112:127], v[204:207], v[64:67], v[80:95]
    s_add_u32 m0, s54, 107520
    ds_read_b64_tr_b16 v[224:225], v31 offset:37120
    v_exp_f32 v135, v135
    v_exp_f32 v136, v136
    v_exp_f32 v137, v137
    v_cvt_pk_bf16_f32 v153, v130, v131
    v_exp_f32 v138, v138
    v_cvt_pk_bf16_f32 v154, v132, v133
    v_mfma_f32_32x32x16_bf16 v[112:127], v[208:211], v[68:71], v[112:127]
    ds_read_b64_tr_b16 v[226:227], v30 offset:37120
    buffer_load_dwordx4 v5, s[80:83], s60 offen lds
    s_add_u32 s60, s60, 65536
    v_cvt_pk_bf16_f32 v155, v134, v135
    v_exp_f32 v139, v139
    v_exp_f32 v140, v140
    v_mfma_f32_16x16x32_bf16 v[192:195], v[200:203], v[144:147], v[192:195]
    s_add_u32 m0, s54, 114688
    v_exp_f32 v141, v141
    v_exp_f32 v142, v142
    v_cvt_pk_bf16_f32 v156, v136, v137
    v_cvt_pk_bf16_f32 v157, v138, v139
    v_mfma_f32_16x16x32_bf16 v[192:195], v[200:203], v[148:151], v[192:195]
    buffer_load_dwordx4 v4, s[80:83], s60 offen lds
    v_exp_f32 v143, v143
    v_cvt_pk_bf16_f32 v158, v140, v141
    v_cvt_pk_bf16_f32 v159, v142, v143
    v_mfma_f32_32x32x16_bf16 v[176:191], v[228:231], v[152:155], v[176:191]
    s_add_u32 m0, s54, 115712
    ds_read_b128 v[212:215], v32 offset:38912
    v_exp_f32 v112, v112
    v_exp_f32 v113, v113
    v_exp_f32 v114, v114
    v_exp_f32 v115, v115
    v_cvt_pk_bf16_f32 v144, v112, v113
    v_mfma_f32_32x32x16_bf16 v[176:191], v[232:235], v[156:159], v[176:191]
    ds_read_b128 v[216:219], v32 offset:39936
    buffer_load_dwordx4 v5, s[80:83], s60 offen lds
    s_add_u32 s60, s60, 65536
    v_exp_f32 v116, v116
    v_exp_f32 v117, v117
    v_cvt_pk_bf16_f32 v145, v114, v115
    v_mfma_f32_32x32x16_bf16 v[128:143], v[204:207], v[72:75], v[96:111]
    s_add_u32 m0, s54, 122880
    v_exp_f32 v118, v118
    v_exp_f32 v119, v119
    v_exp_f32 v120, v120
    v_exp_f32 v121, v121
    v_exp_f32 v122, v122
    v_mfma_f32_32x32x16_bf16 v[128:143], v[208:211], v[76:79], v[128:143]
    buffer_load_dwordx4 v4, s[80:83], s60 offen lds
    v_exp_f32 v123, v123
    v_cvt_pk_bf16_f32 v146, v116, v117
    v_exp_f32 v124, v124
    v_exp_f32 v125, v125
    v_mfma_f32_16x16x32_bf16 v[196:199], v[200:203], v[152:155], v[196:199]
    s_add_u32 m0, s54, 123904
    v_cvt_pk_bf16_f32 v147, v118, v119
    v_exp_f32 v126, v126
    v_cvt_pk_bf16_f32 v148, v120, v121
    v_cvt_pk_bf16_f32 v149, v122, v123
    v_cvt_pk_bf16_f32 v150, v124, v125
    v_mfma_f32_16x16x32_bf16 v[196:199], v[200:203], v[156:159], v[196:199]
    s_waitcnt lgkmcnt(0)
    buffer_load_dwordx4 v5, s[80:83], s60 offen lds
    s_add_u32 s60, s60, 65536
    v_exp_f32 v127, v127
    s_nop 0
    v_cvt_pk_bf16_f32 v151, v126, v127
    v_mfma_f32_32x32x16_bf16 v[160:175], v[220:223], v[144:147], v[160:175]
    ds_read_b64_tr_b16 v[228:229], v31 offset:38912
    v_exp_f32 v128, v128
    v_exp_f32 v129, v129
    v_exp_f32 v130, v130
    v_exp_f32 v131, v131
    v_exp_f32 v132, v132
    v_mfma_f32_32x32x16_bf16 v[160:175], v[224:227], v[148:151], v[160:175]
    ds_read_b64_tr_b16 v[230:231], v30 offset:38912
    v_exp_f32 v133, v133
    v_exp_f32 v134, v134
    v_exp_f32 v135, v135
    v_cvt_pk_bf16_f32 v152, v128, v129
    v_exp_f32 v136, v136
    v_cvt_pk_bf16_f32 v153, v130, v131
    v_mfma_f32_32x32x16_bf16 v[112:127], v[212:215], v[64:67], v[80:95]
    ds_read_b64_tr_b16 v[232:233], v31 offset:39168
    s_waitcnt vmcnt(12)
    v_cmp_ne_u32 vcc, s52, v8
    v_cmp_ne_u32 s[64:65], s53, v9
    s_nop 1
    s_or_b64 s[64:65], vcc, s[64:65]
    s_and_b32 s64, s64, 0xffffffff
    s_cbranch_scc1 L_h_slow
L_h_ok:
    v_exp_f32 v137, v137
    v_exp_f32 v138, v138
    v_cvt_pk_bf16_f32 v154, v132, v133
    v_mfma_f32_32x32x16_bf16 v[112:127], v[216:219], v[68:71], v[112:127]
    ds_read_b64_tr_b16 v[234:235], v30 offset:39168
    buffer_load_dwordx4 a[0:3], v2, s[16:19], s59 offen offset:0 sc1
    v_exp_f32 v139, v139
    v_exp_f32 v140, v140
    v_exp_f32 v141, v141
    v_cvt_pk_bf16_f32 v155, v134, v135
    v_mfma_f32_16x16x32_bf16 v[192:195], v[200:203], v[144:147], v[192:195]
    buffer_load_dwordx4 a[4:7], v3, s[16:19], s59 offen offset:0 sc1
    v_exp_f32 v142, v142
    v_cvt_pk_bf16_f32 v156, v136, v137
    v_cvt_pk_bf16_f32 v157, v138, v139
    v_mfma_f32_16x16x32_bf16 v[192:195], v[200:203], v[148:151], v[192:195]
    buffer_load_dwordx4 a[8:11], v2, s[16:19], s59 offen offset:1024 sc1
    v_exp_f32 v143, v143
    v_cvt_pk_bf16_f32 v158, v140, v141
    v_cvt_pk_bf16_f32 v159, v142, v143
    v_mfma_f32_32x32x16_bf16 v[176:191], v[220:223], v[152:155], v[176:191]
    s_waitcnt lgkmcnt(0)
    s_barrier
    v_exp_f32 v112, v112
    v_exp_f32 v113, v113
    v_exp_f32 v114, v114
    v_exp_f32 v115, v115
    v_cvt_pk_bf16_f32 v144, v112, v113
    v_mfma_f32_32x32x16_bf16 v[176:191], v[224:227], v[156:159], v[176:191]
    ds_read_b128 v[204:207], v32 offset:16384
    v_exp_f32 v116, v116
    v_exp_f32 v117, v117
    v_exp_f32 v118, v118
    v_exp_f32 v119, v119
    v_cvt_pk_bf16_f32 v145, v114, v115
    v_mfma_f32_32x32x16_bf16 v[128:143], v[212:215], v[72:75], v[96:111]
    ds_read_b128 v[208:211], v32 offset:17408
    v_exp_f32 v120, v120
    v_exp_f32 v121, v121
    v_exp_f32 v122, v122
    v_exp_f32 v123, v123
    v_cvt_pk_bf16_f32 v146, v116, v117
    v_mfma_f32_32x32x16_bf16 v[128:143], v[216:219], v[76:79], v[128:143]
    buffer_load_dwordx4 a[12:15], v3, s[16:19], s59 offen offset:1024 sc1
    v_exp_f32 v124, v124
    v_exp_f32 v125, v125
    v_cvt_pk_bf16_f32 v147, v118, v119
    v_exp_f32 v126, v126
    v_mfma_f32_16x16x32_bf16 v[196:199], v[200:203], v[152:155], v[196:199]
    buffer_load_dwordx4 a[16:19], v2, s[16:19], s59 offen offset:2048 sc1
    v_cvt_pk_bf16_f32 v148, v120, v121
    v_cvt_pk_bf16_f32 v149, v122, v123
    v_cvt_pk_bf16_f32 v150, v124, v125
    v_mfma_f32_16x16x32_bf16 v[196:199], v[200:203], v[156:159], v[196:199]
    s_waitcnt lgkmcnt(0)
    buffer_load_dwordx4 a[20:23], v3, s[16:19], s59 offen offset:2048 sc1
    v_exp_f32 v127, v127
    s_nop 0
    v_cvt_pk_bf16_f32 v151, v126, v127
    v_mfma_f32_32x32x16_bf16 v[160:175], v[228:231], v[144:147], v[160:175]
    ds_read_b64_tr_b16 v[220:221], v31 offset:16384
    v_exp_f32 v128, v128
    v_exp_f32 v129, v129
    v_exp_f32 v130, v130
    v_exp_f32 v131, v131
    v_cvt_pk_bf16_f32 v152, v128, v129
    v_mfma_f32_32x32x16_bf16 v[160:175], v[232:235], v[148:151], v[160:175]
    ds_read_b64_tr_b16 v[222:223], v30 offset:16384
    v_exp_f32 v132, v132
    v_exp_f32 v133, v133
    v_exp_f32 v134, v134
    v_exp_f32 v135, v135
    v_cvt_pk_bf16_f32 v153, v130, v131
    v_mfma_f32_32x32x16_bf16 v[112:127], v[204:207], v[64:67], v[80:95]
    ds_read_b64_tr_b16 v[224:225], v31 offset:16640
    v_exp_f32 v136, v136
    v_exp_f32 v137, v137
    v_exp_f32 v138, v138
    v_exp_f32 v139, v139
    v_cvt_pk_bf16_f32 v154, v132, v133
    v_mfma_f32_32x32x16_bf16 v[112:127], v[208:211], v[68:71], v[112:127]
    ds_read_b64_tr_b16 v[226:227], v30 offset:16640
    buffer_load_dwordx2 a[24:25], v10, s[16:19], s59 offen offset:3072 sc1
    v_exp_f32 v140, v140
    v_exp_f32 v141, v141
    v_cvt_pk_bf16_f32 v155, v134, v135
    v_cvt_pk_bf16_f32 v156, v136, v137
    v_mfma_f32_16x16x32_bf16 v[192:195], v[200:203], v[144:147], v[192:195]
    buffer_load_dwordx2 a[26:27], v10, s[16:19], s59 offen offset:3584 sc1
    v_exp_f32 v142, v142
    v_cvt_pk_bf16_f32 v157, v138, v139
    v_cvt_pk_bf16_f32 v158, v140, v141
    v_mfma_f32_16x16x32_bf16 v[192:195], v[200:203], v[148:151], v[192:195]
    buffer_load_dwordx2 a[28:29], v11, s[16:19], s59 offen offset:3072 sc1
    v_exp_f32 v143, v143
    s_nop 0
    v_cvt_pk_bf16_f32 v159, v142, v143
    v_mfma_f32_32x32x16_bf16 v[176:191], v[228:231], v[152:155], v[176:191]
    ds_read_b128 v[212:215], v32 offset:18432
    v_exp_f32 v112, v112
    v_exp_f32 v113, v113
    v_exp_f32 v114, v114
    v_cvt_pk_bf16_f32 v144, v112, v113
    v_exp_f32 v115, v115
    v_mfma_f32_32x32x16_bf16 v[176:191], v[232:235], v[156:159], v[176:191]
    ds_read_b128 v[216:219], v32 offset:19456
    v_cvt_pk_bf16_f32 v145, v114, v115
    v_exp_f32 v116, v116
    v_exp_f32 v117, v117
    v_exp_f32 v118, v118
    v_exp_f32 v119, v119
    v_mfma_f32_32x32x16_bf16 v[128:143], v[204:207], v[72:75], v[96:111]
    buffer_load_dwordx2 a[30:31], v11, s[16:19], s59 offen offset:3584 sc1
    s_add_u32 s59, s59, 4096
    v_exp_f32 v120, v120
    v_exp_f32 v121, v121
    v_exp_f32 v122, v122
    v_cvt_pk_bf16_f32 v146, v116, v117
    v_mfma_f32_32x32x16_bf16 v[128:143], v[208:211], v[76:79], v[128:143]
    buffer_load_dwordx4 a[32:35], v2, s[16:19], s59 offen offset:0 sc1
    v_cvt_pk_bf16_f32 v147, v118, v119
    v_exp_f32 v123, v123
    v_exp_f32 v124, v124
    v_exp_f32 v125, v125
    v_mfma_f32_16x16x32_bf16 v[196:199], v[200:203], v[152:155], v[196:199]
    buffer_load_dwordx4 a[36:39], v3, s[16:19], s59 offen offset:0 sc1
    v_exp_f32 v126, v126
    v_cvt_pk_bf16_f32 v148, v120, v121
    v_cvt_pk_bf16_f32 v149, v122, v123
    v_mfma_f32_16x16x32_bf16 v[196:199], v[200:203], v[156:159], v[196:199]
    s_waitcnt lgkmcnt(0)
    buffer_load_dwordx4 a[40:43], v2, s[16:19], s59 offen offset:1024 sc1
    v_exp_f32 v127, v127
    v_cvt_pk_bf16_f32 v150, v124, v125
    v_cvt_pk_bf16_f32 v151, v126, v127
    v_mfma_f32_32x32x16_bf16 v[160:175], v[220:223], v[144:147], v[160:175]
    ds_read_b64_tr_b16 v[228:229], v31 offset:18432
    v_exp_f32 v128, v128
    v_exp_f32 v129, v129
    v_exp_f32 v130, v130
    v_exp_f32 v131, v131
    v_cvt_pk_bf16_f32 v152, v128, v129
    v_mfma_f32_32x32x16_bf16 v[160:175], v[224:227], v[148:151], v[160:175]
    ds_read_b64_tr_b16 v[230:231], v30 offset:18432
    v_exp_f32 v132, v132
    v_exp_f32 v133, v133
    v_exp_f32 v134, v134
    v_exp_f32 v135, v135
    v_cvt_pk_bf16_f32 v153, v130, v131
    v_mfma_f32_32x32x16_bf16 v[112:127], v[212:215], v[64:67], v[80:95]
    ds_read_b64_tr_b16 v[232:233], v31 offset:18688
    v_exp_f32 v136, v136
    v_exp_f32 v137, v137
    v_exp_f32 v138, v138
    v_exp_f32 v139, v139
    v_cvt_pk_bf16_f32 v154, v132, v133
    v_mfma_f32_32x32x16_bf16 v[112:127], v[216:219], v[68:71], v[112:127]
    ds_read_b64_tr_b16 v[234:235], v30 offset:18688
    buffer_load_dwordx4 a[44:47], v3, s[16:19], s59 offen offset:1024 sc1
    v_exp_f32 v140, v140
    v_exp_f32 v141, v141
    v_cvt_pk_bf16_f32 v155, v134, v135
    v_cvt_pk_bf16_f32 v156, v136, v137
    v_mfma_f32_16x16x32_bf16 v[192:195], v[200:203], v[144:147], v[192:195]
    buffer_load_dwordx4 a[48:51], v2, s[16:19], s59 offen offset:2048 sc1
    v_exp_f32 v142, v142
    v_cvt_pk_bf16_f32 v157, v138, v139
    v_cvt_pk_bf16_f32 v158, v140, v141
    v_mfma_f32_16x16x32_bf16 v[192:195], v[200:203], v[148:151], v[192:195]
    buffer_load_dwordx4 a[52:55], v3, s[16:19], s59 offen offset:2048 sc1
    v_exp_f32 v143, v143
    s_nop 0
    v_cvt_pk_bf16_f32 v159, v142, v143
    v_mfma_f32_32x32x16_bf16 v[176:191], v[220:223], v[152:155], v[176:191]
    ds_read_b128 v[204:207], v32 offset:20480
    v_exp_f32 v112, v112
    v_exp_f32 v113, v113
    v_exp_f32 v114, v114
    v_exp_f32 v115, v115
    v_cvt_pk_bf16_f32 v144, v112, v113
    v_mfma_f32_32x32x16_bf16 v[176:191], v[224:227], v[156:159], v[176:191]
    ds_read_b128 v[208:211], v32 offset:21504
    v_exp_f32 v116, v116
    v_exp_f32 v117, v117
    v_exp_f32 v118, v118
    v_exp_f32 v119, v119
    v_cvt_pk_bf16_f32 v145, v114, v115
    v_mfma_f32_32x32x16_bf16 v[128:143], v[212:215], v[72:75], v[96:111]
    buffer_load_dwordx4 a[56:59], v2, s[16:19], s59 offen offset:3072 sc1
    v_exp_f32 v120, v120
    v_exp_f32 v121, v121
    v_exp_f32 v122, v122
    v_cvt_pk_bf16_f32 v146, v116, v117
    v_mfma_f32_32x32x16_bf16 v[128:143], v[216:219], v[76:79], v[128:143]
    buffer_load_dwordx4 a[60:63], v3, s[16:19], s59 offen offset:3072 sc1
    s_add_u32 s59, s59, 4096
    v_exp_f32 v123, v123
    v_exp_f32 v124, v124
    v_exp_f32 v125, v125
    v_mfma_f32_16x16x32_bf16 v[196:199], v[200:203], v[152:155], v[196:199]
    buffer_load_dwordx4 a[64:67], v2, s[16:19], s59 offen offset:0 sc1
    v_cvt_pk_bf16_f32 v147, v118, v119
    v_exp_f32 v126, v126
    v_cvt_pk_bf16_f32 v148, v120, v121
    v_mfma_f32_16x16x32_bf16 v[196:199], v[200:203], v[156:159], v[196:199]
    s_waitcnt lgkmcnt(0)
    v_cvt_pk_bf16_f32 v149, v122, v123
    v_exp_f32 v127, v127
    v_cvt_pk_bf16_f32 v150, v124, v125
    v_cvt_pk_bf16_f32 v151, v126, v127
    v_mfma_f32_32x32x16_bf16 v[160:175], v[228:231], v[144:147], v[160:175]
    ds_read_b64_tr_b16 v[220:221], v31 offset:20480
    v_exp_f32 v128, v128
    v_exp_f32 v129, v129
    v_exp_f32 v130, v130
    v_exp_f32 v131, v131
    v_cvt_pk_bf16_f32 v152, v128, v129
    v_mfma_f32_32x32x16_bf16 v[160:175], v[232:235], v[148:151], v[160:175]
    ds_read_b64_tr_b16 v[222:223], v30 offset:20480
    v_exp_f32 v132, v132
    v_exp_f32 v133, v133
    v_exp_f32 v134, v134
    v_exp_f32 v135, v135
    v_cvt_pk_bf16_f32 v153, v130, v131
    v_mfma_f32_32x32x16_bf16 v[112:127], v[204:207], v[64:67], v[80:95]
    ds_read_b64_tr_b16 v[224:225], v31 offset:20736
    v_exp_f32 v136, v136
    v_exp_f32 v137, v137
    v_exp_f32 v138, v138
    v_exp_f32 v139, v139
    v_cvt_pk_bf16_f32 v154, v132, v133
    v_mfma_f32_32x32x16_bf16 v[112:127], v[208:211], v[68:71], v[112:127]
    ds_read_b64_tr_b16 v[226:227], v30 offset:20736
    buffer_load_dwordx4 a[68:71], v3, s[16:19], s59 offen offset:0 sc1
    v_exp_f32 v140, v140
    v_exp_f32 v141, v141
    v_cvt_pk_bf16_f32 v155, v134, v135
    v_cvt_pk_bf16_f32 v156, v136, v137
    v_mfma_f32_16x16x32_bf16 v[192:195], v[200:203], v[144:147], v[192:195]
    buffer_load_dwordx4 a[72:75], v2, s[16:19], s59 offen offset:1024 sc1
    v_exp_f32 v142, v142
    v_cvt_pk_bf16_f32 v157, v138, v139
    v_cvt_pk_bf16_f32 v158, v140, v141
    v_mfma_f32_16x16x32_bf16 v[192:195], v[200:203], v[148:151], v[192:195]
    buffer_load_dwordx4 a[76:79], v3, s[16:19], s59 offen offset:1024 sc1
    v_exp_f32 v143, v143
    s_nop 0
    v_cvt_pk_bf16_f32 v159, v142, v143
    v_mfma_f32_32x32x16_bf16 v[176:191], v[228:231], v[152:155], v[176:191]
    ds_read_b128 v[212:215], v32 offset:22528
    v_exp_f32 v112, v112
    v_exp_f32 v113, v113
    v_exp_f32 v114, v114
    v_cvt_pk_bf16_f32 v144, v112, v113
    v_exp_f32 v115, v115
    v_mfma_f32_32x32x16_bf16 v[176:191], v[232:235], v[156:159], v[176:191]
    ds_read_b128 v[216:219], v32 offset:23552
    v_cvt_pk_bf16_f32 v145, v114, v115
    v_exp_f32 v116, v116
    v_exp_f32 v117, v117
    v_exp_f32 v118, v118
    v_exp_f32 v119, v119
    v_mfma_f32_32x32x16_bf16 v[128:143], v[204:207], v[72:75], v[96:111]
    buffer_load_dwordx2 a[80:81], v10, s[16:19], s59 offen offset:2048 sc1
    v_cvt_pk_bf16_f32 v146, v116, v117
    v_exp_f32 v120, v120
    v_exp_f32 v121, v121
    v_exp_f32 v122, v122
    v_mfma_f32_32x32x16_bf16 v[128:143], v[208:211], v[76:79], v[128:143]
    buffer_load_dwordx2 a[82:83], v10, s[16:19], s59 offen offset:2560 sc1
    v_cvt_pk_bf16_f32 v147, v118, v119
    v_exp_f32 v123, v123
    v_exp_f32 v124, v124
    v_exp_f32 v125, v125
    v_mfma_f32_16x16x32_bf16 v[196:199], v[200:203], v[152:155], v[196:199]
    buffer_load_dwordx2 a[84:85], v11, s[16:19], s59 offen offset:2048 sc1
    v_exp_f32 v126, v126
    v_cvt_pk_bf16_f32 v148, v120, v121
    v_cvt_pk_bf16_f32 v149, v122, v123
    v_mfma_f32_16x16x32_bf16 v[196:199], v[200:203], v[156:159], v[196:199]
    s_waitcnt lgkmcnt(0)
    buffer_load_dwordx2 a[86:87], v11, s[16:19], s59 offen offset:2560 sc1
    v_exp_f32 v127, v127
    v_cvt_pk_bf16_f32 v150, v124, v125
    v_cvt_pk_bf16_f32 v151, v126, v127
    v_mfma_f32_32x32x16_bf16 v[160:175], v[220:223], v[144:147], v[160:175]
    ds_read_b64_tr_b16 v[228:229], v31 offset:22528
    v_exp_f32 v128, v128
    v_exp_f32 v129, v129
    v_exp_f32 v130, v130
    v_exp_f32 v131, v131
    v_exp_f32 v132, v132
    v_mfma_f32_32x32x16_bf16 v[160:175], v[224:227], v[148:151], v[160:175]
    ds_read_b64_tr_b16 v[230:231], v30 offset:22528
    v_exp_f32 v133, v133
    v_exp_f32 v134, v134
    v_exp_f32 v135, v135
    v_cvt_pk_bf16_f32 v152, v128, v129
    v_exp_f32 v136, v136
    v_cvt_pk_bf16_f32 v153, v130, v131
    v_mfma_f32_32x32x16_bf16 v[112:127], v[212:215], v[64:67], v[80:95]
    ds_read_b64_tr_b16 v[232:233], v31 offset:22784
    buffer_load_dword a224, v40, s[80:83], s4 offen
    s_add_u32 s4, s4, 2097152
    v_exp_f32 v137, v137
    v_exp_f32 v138, v138
    v_exp_f32 v139, v139
    v_mfma_f32_32x32x16_bf16 v[112:127], v[216:219], v[68:71], v[112:127]
    ds_read_b64_tr_b16 v[234:235], v30 offset:22784
    buffer_load_dwordx4 a[88:91], v2, s[16:19], s59 offen offset:3072 sc1
    v_cvt_pk_bf16_f32 v154, v132, v133
    v_cvt_pk_bf16_f32 v155, v134, v135
    v_exp_f32 v140, v140
    v_exp_f32 v141, v141
    v_mfma_f32_16x16x32_bf16 v[192:195], v[200:203], v[144:147], v[192:195]
    buffer_load_dwordx4 a[92:95], v3, s[16:19], s59 offen offset:3072 sc1
    s_add_u32 s59, s59, 4096
    v_exp_f32 v142, v142
    v_cvt_pk_bf16_f32 v156, v136, v137
    v_cvt_pk_bf16_f32 v157, v138, v139
    v_mfma_f32_16x16x32_bf16 v[192:195], v[200:203], v[148:151], v[192:195]
    buffer_load_dwordx4 a[96:99], v2, s[16:19], s59 offen offset:0 sc1
    v_exp_f32 v143, v143
    v_cvt_pk_bf16_f32 v158, v140, v141
    v_cvt_pk_bf16_f32 v159, v142, v143
    v_mfma_f32_32x32x16_bf16 v[176:191], v[220:223], v[152:155], v[176:191]
    buffer_load_dwordx4 a[100:103], v3, s[16:19], s59 offen offset:0 sc1
    v_exp_f32 v112, v112
    v_exp_f32 v113, v113
    v_exp_f32 v114, v114
    v_cvt_pk_bf16_f32 v144, v112, v113
    v_mfma_f32_32x32x16_bf16 v[176:191], v[224:227], v[156:159], v[176:191]
    buffer_load_dwordx4 a[104:107], v2, s[16:19], s59 offen offset:1024 sc1
    v_exp_f32 v115, v115
    v_exp_f32 v116, v116
    v_exp_f32 v117, v117
    v_cvt_pk_bf16_f32 v145, v114, v115
    v_mfma_f32_32x32x16_bf16 v[128:143], v[212:215], v[72:75], v[96:111]
    buffer_load_dwordx4 a[108:111], v3, s[16:19], s59 offen offset:1024 sc1
    v_exp_f32 v118, v118
    v_exp_f32 v119, v119
    v_exp_f32 v120, v120
    v_cvt_pk_bf16_f32 v146, v116, v117
    v_mfma_f32_32x32x16_bf16 v[128:143], v[216:219], v[76:79], v[128:143]
    v_cvt_pk_bf16_f32 v147, v118, v119
    v_exp_f32 v121, v121
    v_exp_f32 v122, v122
    v_exp_f32 v123, v123
    v_exp_f32 v124, v124
    v_mfma_f32_16x16x32_bf16 v[196:199], v[200:203], v[152:155], v[196:199]
    v_cvt_pk_bf16_f32 v148, v120, v121
    v_exp_f32 v125, v125
    v_exp_f32 v126, v126
    v_mfma_f32_16x16x32_bf16 v[196:199], v[200:203], v[156:159], v[196:199]
    s_waitcnt lgkmcnt(0)
    v_cvt_pk_bf16_f32 v149, v122, v123
    v_exp_f32 v127, v127
    v_cvt_pk_bf16_f32 v150, v124, v125
    v_cvt_pk_bf16_f32 v151, v126, v127
    v_mfma_f32_32x32x16_bf16 v[160:175], v[228:231], v[144:147], v[160:175]
    buffer_load_dwordx4 a[112:115], v2, s[16:19], s59 offen offset:2048 sc1
    v_exp_f32 v128, v128
    v_exp_f32 v129, v129
    v_exp_f32 v130, v130
    v_exp_f32 v131, v131
    v_exp_f32 v132, v132
    v_exp_f32 v133, v133
    v_mfma_f32_32x32x16_bf16 v[160:175], v[232:235], v[148:151], v[160:175]
    buffer_load_dwordx4 a[116:119], v3, s[16:19], s59 offen offset:2048 sc1
    v_exp_f32 v134, v134
    v_exp_f32 v135, v135
    v_cvt_pk_bf16_f32 v152, v128, v129
    v_exp_f32 v136, v136
    v_exp_f32 v137, v137
    v_cvt_pk_bf16_f32 v153, v130, v131
    v_exp_f32 v138, v138
    v_mfma_f32_16x16x32_bf16 v[192:195], v[200:203], v[144:147], v[192:195]
    buffer_load_dwordx4 a[120:123], v2, s[16:19], s59 offen offset:3072 sc1
    v_exp_f32 v139, v139
    v_cvt_pk_bf16_f32 v154, v132, v133
    v_cvt_pk_bf16_f32 v155, v134, v135
    v_exp_f32 v140, v140
    v_exp_f32 v141, v141
    v_mfma_f32_16x16x32_bf16 v[192:195], v[200:203], v[148:151], v[192:195]
    buffer_load_dwordx4 a[124:127], v3, s[16:19], s59 offen offset:3072 sc1
    s_add_u32 s59, s59, 4096
    v_exp_f32 v142, v142
    v_cvt_pk_bf16_f32 v156, v136, v137
    v_cvt_pk_bf16_f32 v157, v138, v139
    v_exp_f32 v143, v143
    v_cvt_pk_bf16_f32 v158, v140, v141
    v_cvt_pk_bf16_f32 v159, v142, v143
    s_nop 1
    v_mfma_f32_16x16x32_bf16 v[196:199], v[200:203], v[152:155], v[196:199]
    v_mfma_f32_16x16x32_bf16 v[196:199], v[200:203], v[156:159], v[196:199]
    v_mfma_f32_32x32x16_bf16 v[176:191], v[228:231], v[152:155], v[176:191]
    v_mfma_f32_32x32x16_bf16 v[176:191], v[232:235], v[156:159], v[176:191]
    v_bfe_u32 v62, v1, 4, 1
    v_cmp_eq_u32 vcc, 0, v62
    v_mov_b32 v17, 0x58800000
    v_lshrrev_b32 v18, 6, v0
    v_lshlrev_b32 v18, 2, v18
    v_add_u32 v18, 147456, v18
    s_nop 1
    v_cndmask_b32 v14, v193, v192, vcc
    v_cndmask_b32 v15, v197, v196, vcc
    v_add_f32 v16, v14, v15
    v_cmp_nlt_f32 vcc, v16, v17
    v_rcp_f32 v14, v14
    v_rcp_f32 v15, v15
    s_cmp_lg_u64 vcc, 0
    s_cselect_b32 s46, 1, 0
    v_mov_b32 v17, s46
    ds_write_b32 v18, v17
    v_mul_u32_u24 v62, 147456, v62
    v_lshrrev_b32 v63, 5, v1
    v_lshl_add_u32 v62, v63, 8, v62
    v_and_b32 v63, 15, v1
    v_lshl_add_u32 v62, v63, 4, v62
    v_mov_b32 v18, 147456
    s_lshl_b32 s46, s72, 1
    s_mul_i32 s46, s46, 144
    s_add_u32 s46, s46, s32
    s_add_u32 s46, s46, 112
    s_lshl_b32 s46, s46, 10
    s_add_u32 s46, s46, 16777216
    s_add_u32 s47, s46, 294912

    s_waitcnt vmcnt(37)
    s_waitcnt lgkmcnt(0)
    s_barrier
    ds_read_b128 v[22:25], v18
    v_mov_b32 v12, v14
    v_mov_b32 v13, v14
    v_pk_mul_f32 v[160:161], v[160:161], v[12:13]
    v_pk_mul_f32 v[162:163], v[162:163], v[12:13]
    v_pk_mul_f32 v[164:165], v[164:165], v[12:13]
    v_pk_mul_f32 v[166:167], v[166:167], v[12:13]
    v_pk_mul_f32 v[168:169], v[168:169], v[12:13]
    v_pk_mul_f32 v[170:171], v[170:171], v[12:13]
    v_pk_mul_f32 v[172:173], v[172:173], v[12:13]
    v_pk_mul_f32 v[174:175], v[174:175], v[12:13]
    v_cvt_pk_bf16_f32 v112, v160, v161
    v_cvt_pk_bf16_f32 v113, v162, v163
    v_cvt_pk_bf16_f32 v114, v168, v169
    v_cvt_pk_bf16_f32 v115, v170, v171
    v_cvt_pk_bf16_f32 v116, v164, v165
    v_cvt_pk_bf16_f32 v117, v166, v167
    v_cvt_pk_bf16_f32 v118, v172, v173
    v_cvt_pk_bf16_f32 v119, v174, v175
    v_mov_b32 v12, v15
    v_mov_b32 v13, v15
    v_pk_mul_f32 v[176:177], v[176:177], v[12:13]
    v_pk_mul_f32 v[178:179], v[178:179], v[12:13]
    v_pk_mul_f32 v[180:181], v[180:181], v[12:13]
    v_pk_mul_f32 v[182:183], v[182:183], v[12:13]
    v_pk_mul_f32 v[184:185], v[184:185], v[12:13]
    v_pk_mul_f32 v[186:187], v[186:187], v[12:13]
    v_pk_mul_f32 v[188:189], v[188:189], v[12:13]
    v_pk_mul_f32 v[190:191], v[190:191], v[12:13]
    v_cvt_pk_bf16_f32 v120, v176, v177
    v_cvt_pk_bf16_f32 v121, v178, v179
    v_cvt_pk_bf16_f32 v122, v184, v185
    v_cvt_pk_bf16_f32 v123, v186, v187
    v_cvt_pk_bf16_f32 v124, v180, v181
    v_cvt_pk_bf16_f32 v125, v182, v183
    v_cvt_pk_bf16_f32 v126, v188, v189
    v_cvt_pk_bf16_f32 v127, v190, v191
    s_waitcnt lgkmcnt(0)
    v_or_b32 v22, v22, v23
    v_or3_b32 v22, v22, v24, v25
    s_nop 0
    v_readfirstlane_b32 s62, v22
    s_nop 3
    s_andn2_b32 s62, s62, s44
    s_cbranch_scc1 L_at_redo
    buffer_store_dwordx4 v[112:115], v62, s[16:19], s46 offen offset:0 sc1
    buffer_store_dwordx4 v[116:119], v62, s[16:19], s46 offen offset:512 sc1
    buffer_store_dwordx4 v[120:123], v62, s[16:19], s47 offen offset:0 sc1
    buffer_store_dwordx4 v[124:127], v62, s[16:19], s47 offen offset:512 sc1
    v_lshrrev_b32 v64, 2, v1
    v_and_b32 v65, 7, v64
    v_lshlrev_b32 v66, 8, v64
    v_lshl_add_u32 v66, v65, 5, v66
    v_and_b32 v67, 3, v1
    v_lshl_add_u32 v232, v67, 3, v66

    v_xor_b32 v233, 32, v232
    v_xor_b32 v234, 64, v232
    v_xor_b32 v235, 96, v232
    v_xor_b32 v236, 128, v232
    v_xor_b32 v237, 160, v232
    v_xor_b32 v238, 192, v232
    v_xor_b32 v239, 224, v232
    ds_read_b64_tr_b16 a[128:129], v232 offset:0
    ds_read_b64_tr_b16 a[130:131], v232 offset:4096
    ds_read_b64_tr_b16 a[132:133], v233 offset:0
    ds_read_b64_tr_b16 a[134:135], v233 offset:4096
    ds_read_b64_tr_b16 a[136:137], v234 offset:0
    ds_read_b64_tr_b16 a[138:139], v234 offset:4096
    ds_read_b64_tr_b16 a[140:141], v235 offset:0
    ds_read_b64_tr_b16 a[142:143], v235 offset:4096
    ds_read_b64_tr_b16 a[144:145], v236 offset:0
    ds_read_b64_tr_b16 a[146:147], v236 offset:4096
    ds_read_b64_tr_b16 a[148:149], v237 offset:0
    ds_read_b64_tr_b16 a[150:151], v237 offset:4096
    s_waitcnt vmcnt(39)
    s_waitcnt lgkmcnt(8)
    v_mfma_f32_16x16x32_bf16 a[160:163], a[128:131], a[0:3], 0
    ds_read_b64_tr_b16 a[152:153], v238 offset:0
    ds_read_b64_tr_b16 a[154:155], v238 offset:4096
    v_mfma_f32_16x16x32_bf16 a[164:167], a[128:131], a[4:7], 0
    v_add_u32 v240, 0x10000, v232
    v_mfma_f32_16x16x32_bf16 a[172:175], a[132:135], a[4:7], 0
    ds_read_b64_tr_b16 a[156:157], v239 offset:0
    ds_read_b64_tr_b16 a[158:159], v239 offset:4096
    v_mfma_f32_16x16x32_bf16 a[168:171], a[132:135], a[0:3], 0
    v_add_u32 v241, 0x10000, v233
    s_waitcnt lgkmcnt(8)
    v_mfma_f32_16x16x32_bf16 a[176:179], a[136:139], a[0:3], 0
    ds_read_b64_tr_b16 a[128:129], v232 offset:8192
    ds_read_b64_tr_b16 a[130:131], v232 offset:12288
    v_mfma_f32_16x16x32_bf16 a[180:183], a[136:139], a[4:7], 0
    v_add_u32 v242, 0x10000, v234
    v_mfma_f32_16x16x32_bf16 a[188:191], a[140:143], a[4:7], 0
    ds_read_b64_tr_b16 a[132:133], v233 offset:8192
    ds_read_b64_tr_b16 a[134:135], v233 offset:12288
    v_mfma_f32_16x16x32_bf16 a[184:187], a[140:143], a[0:3], 0
    v_add_u32 v243, 0x10000, v235
    s_waitcnt lgkmcnt(8)
    v_mfma_f32_16x16x32_bf16 a[192:195], a[144:147], a[0:3], 0
    ds_read_b64_tr_b16 a[136:137], v234 offset:8192
    ds_read_b64_tr_b16 a[138:139], v234 offset:12288
    v_mfma_f32_16x16x32_bf16 a[196:199], a[144:147], a[4:7], 0
    v_add_u32 v244, 0x10000, v236
    v_mfma_f32_16x16x32_bf16 a[204:207], a[148:151], a[4:7], 0
    ds_read_b64_tr_b16 a[140:141], v235 offset:8192
    ds_read_b64_tr_b16 a[142:143], v235 offset:12288
    v_mfma_f32_16x16x32_bf16 a[200:203], a[148:151], a[0:3], 0
    v_add_u32 v245, 0x10000, v237
    s_waitcnt lgkmcnt(8)
    v_mfma_f32_16x16x32_bf16 a[208:211], a[152:155], a[0:3], 0
    ds_read_b64_tr_b16 a[144:145], v236 offset:8192
    ds_read_b64_tr_b16 a[146:147], v236 offset:12288
    v_mfma_f32_16x16x32_bf16 a[212:215], a[152:155], a[4:7], 0
    v_add_u32 v246, 0x10000, v238
    v_mfma_f32_16x16x32_bf16 a[220:223], a[156:159], a[4:7], 0
    ds_read_b64_tr_b16 a[148:149], v237 offset:8192
    ds_read_b64_tr_b16 a[150:151], v237 offset:12288
    v_mfma_f32_16x16x32_bf16 a[216:219], a[156:159], a[0:3], 0
    v_add_u32 v247, 0x10000, v239
    s_waitcnt vmcnt(37)
    s_waitcnt lgkmcnt(8)
    v_mfma_f32_16x16x32_bf16 a[160:163], a[128:131], a[8:11], a[160:163]
    ds_read_b64_tr_b16 a[152:153], v238 offset:8192
    ds_read_b64_tr_b16 a[154:155], v238 offset:12288
    v_mfma_f32_16x16x32_bf16 a[164:167], a[128:131], a[12:15], a[164:167]
    s_lshl_b32 s66, s33, 8
    s_lshl_b32 s67, s32, 3
    s_add_u32 s67, s67, s66
    v_mfma_f32_16x16x32_bf16 a[172:175], a[132:135], a[12:15], a[172:175]
    ds_read_b64_tr_b16 a[156:157], v239 offset:8192
    ds_read_b64_tr_b16 a[158:159], v239 offset:12288
    v_mfma_f32_16x16x32_bf16 a[168:171], a[132:135], a[8:11], a[168:171]
    s_add_u32 s67, s67, 50339840
    s_lshl_b32 s62, s34, 29
    s_add_u32 s67, s67, s62
    s_barrier
    s_waitcnt lgkmcnt(8)
    v_mfma_f32_16x16x32_bf16 a[176:179], a[136:139], a[8:11], a[176:179]
    ds_read_b64_tr_b16 a[128:129], v232 offset:16384
    ds_read_b64_tr_b16 a[130:131], v232 offset:20480
    v_mfma_f32_16x16x32_bf16 a[180:183], a[136:139], a[12:15], a[180:183]
    s_lshr_b32 s66, s15, 1
    s_lshl_b32 s66, s66, 8
    s_add_u32 s66, s66, 50339840
    v_mfma_f32_16x16x32_bf16 a[188:191], a[140:143], a[12:15], a[188:191]
    ds_read_b64_tr_b16 a[132:133], v233 offset:16384
    ds_read_b64_tr_b16 a[134:135], v233 offset:20480
    v_mfma_f32_16x16x32_bf16 a[184:187], a[140:143], a[8:11], a[184:187]
    v_bfe_u32 v65, v1, 3, 2
    s_waitcnt lgkmcnt(8)
    v_mfma_f32_16x16x32_bf16 a[192:195], a[144:147], a[8:11], a[192:195]
    ds_read_b64_tr_b16 a[136:137], v234 offset:16384
    ds_read_b64_tr_b16 a[138:139], v234 offset:20480
    v_mfma_f32_16x16x32_bf16 a[196:199], a[144:147], a[12:15], a[196:199]
    v_lshlrev_b32 v66, 7, v64
    v_mfma_f32_16x16x32_bf16 a[204:207], a[148:151], a[12:15], a[204:207]
    ds_read_b64_tr_b16 a[140:141], v235 offset:16384
    ds_read_b64_tr_b16 a[142:143], v235 offset:20480
    v_mfma_f32_16x16x32_bf16 a[200:203], a[148:151], a[8:11], a[200:203]
    v_lshl_add_u32 v66, v65, 5, v66
    s_waitcnt lgkmcnt(8)
    v_mfma_f32_16x16x32_bf16 a[208:211], a[152:155], a[8:11], a[208:211]
    ds_read_b64_tr_b16 a[144:145], v236 offset:16384
    ds_read_b64_tr_b16 a[146:147], v236 offset:20480
    v_mfma_f32_16x16x32_bf16 a[212:215], a[152:155], a[12:15], a[212:215]
    v_lshl_add_u32 v28, v67, 3, v66
    v_mfma_f32_16x16x32_bf16 a[220:223], a[156:159], a[12:15], a[220:223]
    ds_read_b64_tr_b16 a[148:149], v237 offset:16384
    ds_read_b64_tr_b16 a[150:151], v237 offset:20480
    v_mfma_f32_16x16x32_bf16 a[216:219], a[156:159], a[8:11], a[216:219]
    v_xor_b32 v29, 32, v28
    s_waitcnt vmcnt(35)
    s_waitcnt lgkmcnt(8)
    v_mfma_f32_16x16x32_bf16 a[160:163], a[128:131], a[16:19], a[160:163]
    s_add_u32 m0, s54, 0
    ds_read_b64_tr_b16 a[152:153], v238 offset:16384
    ds_read_b64_tr_b16 a[154:155], v238 offset:20480
    v_mfma_f32_16x16x32_bf16 a[164:167], a[128:131], a[20:23], a[164:167]
    buffer_load_dwordx4 v4, s[80:83], s60 offen lds
    v_mfma_f32_16x16x32_bf16 a[172:175], a[132:135], a[20:23], a[172:175]
    s_add_u32 m0, s54, 1024
    ds_read_b64_tr_b16 a[156:157], v239 offset:16384
    ds_read_b64_tr_b16 a[158:159], v239 offset:20480
    v_mfma_f32_16x16x32_bf16 a[168:171], a[132:135], a[16:19], a[168:171]
    v_xor_b32 v30, 64, v28
    s_waitcnt lgkmcnt(8)
    v_mfma_f32_16x16x32_bf16 a[176:179], a[136:139], a[16:19], a[176:179]
    ds_read_b64_tr_b16 a[128:129], v232 offset:24576
    ds_read_b64_tr_b16 a[130:131], v232 offset:28672
    v_mfma_f32_16x16x32_bf16 a[180:183], a[136:139], a[20:23], a[180:183]
    buffer_load_dwordx4 v5, s[80:83], s60 offen lds
    s_add_u32 s60, s60, 65536
    v_mfma_f32_16x16x32_bf16 a[188:191], a[140:143], a[20:23], a[188:191]
    ds_read_b64_tr_b16 a[132:133], v233 offset:24576
    ds_read_b64_tr_b16 a[134:135], v233 offset:28672
    v_mfma_f32_16x16x32_bf16 a[184:187], a[140:143], a[16:19], a[184:187]
    v_xor_b32 v31, 96, v28
    s_waitcnt lgkmcnt(8)
    v_mfma_f32_16x16x32_bf16 a[192:195], a[144:147], a[16:19], a[192:195]
    ds_read_b64_tr_b16 a[136:137], v234 offset:24576
    ds_read_b64_tr_b16 a[138:139], v234 offset:28672
    v_mfma_f32_16x16x32_bf16 a[196:199], a[144:147], a[20:23], a[196:199]
    buffer_load_dwordx4 a[0:3], v2, s[16:19], s59 offen offset:0 sc1
    v_mfma_f32_16x16x32_bf16 a[204:207], a[148:151], a[20:23], a[204:207]
    ds_read_b64_tr_b16 a[140:141], v235 offset:24576
    ds_read_b64_tr_b16 a[142:143], v235 offset:28672
    v_mfma_f32_16x16x32_bf16 a[200:203], a[148:151], a[16:19], a[200:203]
    v_add_u32 v32, 0x10000, v28
    s_waitcnt lgkmcnt(8)
    v_mfma_f32_16x16x32_bf16 a[208:211], a[152:155], a[16:19], a[208:211]
    ds_read_b64_tr_b16 a[144:145], v236 offset:24576
    ds_read_b64_tr_b16 a[146:147], v236 offset:28672
    v_mfma_f32_16x16x32_bf16 a[212:215], a[152:155], a[20:23], a[212:215]
    buffer_load_dwordx4 a[4:7], v3, s[16:19], s59 offen offset:0 sc1
    v_mfma_f32_16x16x32_bf16 a[220:223], a[156:159], a[20:23], a[220:223]
    ds_read_b64_tr_b16 a[148:149], v237 offset:24576
    ds_read_b64_tr_b16 a[150:151], v237 offset:28672
    v_mfma_f32_16x16x32_bf16 a[216:219], a[156:159], a[16:19], a[216:219]
    v_add_u32 v33, 0x10000, v29
    s_waitcnt vmcnt(35)
    s_waitcnt lgkmcnt(8)
    v_mfma_f32_16x16x32_bf16 a[160:163], a[128:131], a[24:27], a[160:163]
    ds_read_b64_tr_b16 a[152:153], v238 offset:24576
    ds_read_b64_tr_b16 a[154:155], v238 offset:28672
    v_mfma_f32_16x16x32_bf16 a[164:167], a[128:131], a[28:31], a[164:167]
    v_add_u32 v34, 0x10000, v30
    v_mfma_f32_16x16x32_bf16 a[172:175], a[132:135], a[28:31], a[172:175]
    ds_read_b64_tr_b16 a[156:157], v239 offset:24576
    ds_read_b64_tr_b16 a[158:159], v239 offset:28672
    v_mfma_f32_16x16x32_bf16 a[168:171], a[132:135], a[24:27], a[168:171]
    v_add_u32 v35, 0x10000, v31
    s_barrier
    s_waitcnt lgkmcnt(8)
    v_mfma_f32_16x16x32_bf16 a[176:179], a[136:139], a[24:27], a[176:179]
    ds_read_b64_tr_b16 a[128:129], v232 offset:32768
    ds_read_b64_tr_b16 a[130:131], v232 offset:36864
    v_mfma_f32_16x16x32_bf16 a[180:183], a[136:139], a[28:31], a[180:183]
    v_lshrrev_b32 v64, 3, v0
    v_mfma_f32_16x16x32_bf16 a[188:191], a[140:143], a[28:31], a[188:191]
    ds_read_b64_tr_b16 a[132:133], v233 offset:32768
    ds_read_b64_tr_b16 a[134:135], v233 offset:36864
    v_mfma_f32_16x16x32_bf16 a[184:187], a[140:143], a[24:27], a[184:187]
    v_bfe_u32 v65, v0, 1, 2
    s_waitcnt lgkmcnt(8)
    v_mfma_f32_16x16x32_bf16 a[192:195], a[144:147], a[24:27], a[192:195]
    ds_read_b64_tr_b16 a[136:137], v234 offset:32768
    ds_read_b64_tr_b16 a[138:139], v234 offset:36864
    v_mfma_f32_16x16x32_bf16 a[196:199], a[144:147], a[28:31], a[196:199]
    v_bfe_u32 v66, v0, 4, 2
    v_mfma_f32_16x16x32_bf16 a[204:207], a[148:151], a[28:31], a[204:207]
    ds_read_b64_tr_b16 a[140:141], v235 offset:32768
    ds_read_b64_tr_b16 a[142:143], v235 offset:36864
    v_mfma_f32_16x16x32_bf16 a[200:203], a[148:151], a[24:27], a[200:203]
    v_xor_b32 v65, v65, v66
    s_waitcnt lgkmcnt(8)
    v_mfma_f32_16x16x32_bf16 a[208:211], a[152:155], a[24:27], a[208:211]
    ds_read_b64_tr_b16 a[144:145], v236 offset:32768
    ds_read_b64_tr_b16 a[146:147], v236 offset:36864
    v_mfma_f32_16x16x32_bf16 a[212:215], a[152:155], a[28:31], a[212:215]
    v_lshlrev_b32 v64, 11, v64
    v_mfma_f32_16x16x32_bf16 a[220:223], a[156:159], a[28:31], a[220:223]
    ds_read_b64_tr_b16 a[148:149], v237 offset:32768
    ds_read_b64_tr_b16 a[150:151], v237 offset:36864
    v_mfma_f32_16x16x32_bf16 a[216:219], a[156:159], a[24:27], a[216:219]
    v_lshl_add_u32 v64, v65, 5, v64
    s_waitcnt vmcnt(33)
    s_waitcnt lgkmcnt(8)
    v_mfma_f32_16x16x32_bf16 a[160:163], a[128:131], a[32:35], a[160:163]
    s_add_u32 m0, s54, 8192
    ds_read_b64_tr_b16 a[152:153], v238 offset:32768
    ds_read_b64_tr_b16 a[154:155], v238 offset:36864
    v_mfma_f32_16x16x32_bf16 a[164:167], a[128:131], a[36:39], a[164:167]
    buffer_load_dwordx4 v4, s[80:83], s60 offen lds
    v_mfma_f32_16x16x32_bf16 a[172:175], a[132:135], a[36:39], a[172:175]
    s_add_u32 m0, s54, 9216
    ds_read_b64_tr_b16 a[156:157], v239 offset:32768
    ds_read_b64_tr_b16 a[158:159], v239 offset:36864
    v_mfma_f32_16x16x32_bf16 a[168:171], a[132:135], a[32:35], a[168:171]
    v_and_b32 v65, 1, v0
    s_waitcnt lgkmcnt(8)
    v_mfma_f32_16x16x32_bf16 a[176:179], a[136:139], a[32:35], a[176:179]
    ds_read_b64_tr_b16 a[128:129], v232 offset:40960
    ds_read_b64_tr_b16 a[130:131], v232 offset:45056
    v_mfma_f32_16x16x32_bf16 a[180:183], a[136:139], a[36:39], a[180:183]
    buffer_load_dwordx4 v5, s[80:83], s60 offen lds
    s_add_u32 s60, s60, 65536
    v_mfma_f32_16x16x32_bf16 a[188:191], a[140:143], a[36:39], a[188:191]
    ds_read_b64_tr_b16 a[132:133], v233 offset:40960
    ds_read_b64_tr_b16 a[134:135], v233 offset:45056
    v_mfma_f32_16x16x32_bf16 a[184:187], a[140:143], a[32:35], a[184:187]
    v_lshl_add_u32 v64, v65, 4, v64
    s_waitcnt lgkmcnt(8)
    v_mfma_f32_16x16x32_bf16 a[192:195], a[144:147], a[32:35], a[192:195]
    ds_read_b64_tr_b16 a[136:137], v234 offset:40960
    ds_read_b64_tr_b16 a[138:139], v234 offset:45056
    v_mfma_f32_16x16x32_bf16 a[196:199], a[144:147], a[36:39], a[196:199]
    buffer_load_dwordx2 a[8:9], v10, s[16:19], s59 offen offset:1024 sc1
    v_mfma_f32_16x16x32_bf16 a[204:207], a[148:151], a[36:39], a[204:207]
    ds_read_b64_tr_b16 a[140:141], v235 offset:40960
    ds_read_b64_tr_b16 a[142:143], v235 offset:45056
    v_mfma_f32_16x16x32_bf16 a[200:203], a[148:151], a[32:35], a[200:203]
    s_lshl_b32 s47, s31, 7
    v_add_u32 v7, s47, v64
    s_waitcnt lgkmcnt(8)
    v_mfma_f32_16x16x32_bf16 a[208:211], a[152:155], a[32:35], a[208:211]
    ds_read_b64_tr_b16 a[144:145], v236 offset:40960
    ds_read_b64_tr_b16 a[146:147], v236 offset:45056
    v_mfma_f32_16x16x32_bf16 a[212:215], a[152:155], a[36:39], a[212:215]
    buffer_load_dwordx2 a[10:11], v10, s[16:19], s59 offen offset:1536 sc1
    v_mfma_f32_16x16x32_bf16 a[220:223], a[156:159], a[36:39], a[220:223]
    ds_read_b64_tr_b16 a[148:149], v237 offset:40960
    ds_read_b64_tr_b16 a[150:151], v237 offset:45056
    v_mfma_f32_16x16x32_bf16 a[216:219], a[156:159], a[32:35], a[216:219]
    v_lshrrev_b32 v64, 3, v1
    s_waitcnt vmcnt(35)
    s_waitcnt lgkmcnt(8)
    v_mfma_f32_16x16x32_bf16 a[160:163], a[128:131], a[40:43], a[160:163]
    ds_read_b64_tr_b16 a[152:153], v238 offset:40960
    ds_read_b64_tr_b16 a[154:155], v238 offset:45056
    v_mfma_f32_16x16x32_bf16 a[164:167], a[128:131], a[44:47], a[164:167]
    buffer_load_dwordx2 a[12:13], v11, s[16:19], s59 offen offset:1024 sc1
    v_mfma_f32_16x16x32_bf16 a[172:175], a[132:135], a[44:47], a[172:175]
    ds_read_b64_tr_b16 a[156:157], v239 offset:40960
    ds_read_b64_tr_b16 a[158:159], v239 offset:45056
    v_mfma_f32_16x16x32_bf16 a[168:171], a[132:135], a[40:43], a[168:171]
    v_and_b32 v66, 7, v1
    s_barrier
    s_waitcnt lgkmcnt(8)
    v_mfma_f32_16x16x32_bf16 a[176:179], a[136:139], a[40:43], a[176:179]
    ds_read_b64_tr_b16 a[128:129], v232 offset:49152
    ds_read_b64_tr_b16 a[130:131], v232 offset:53248
    v_mfma_f32_16x16x32_bf16 a[180:183], a[136:139], a[44:47], a[180:183]
    buffer_load_dwordx2 a[14:15], v11, s[16:19], s59 offen offset:1536 sc1
    v_mfma_f32_16x16x32_bf16 a[188:191], a[140:143], a[44:47], a[188:191]
    s_add_u32 m0, s54, 16384
    ds_read_b64_tr_b16 a[132:133], v233 offset:49152
    ds_read_b64_tr_b16 a[134:135], v233 offset:53248
    v_mfma_f32_16x16x32_bf16 a[184:187], a[140:143], a[40:43], a[184:187]
    s_mul_i32 s62, s34, 8704
    s_add_u32 s62, s62, 131072
    s_cmp_eq_u32 s34, 3
    s_cselect_b32 s62, 98304, s62
    s_waitcnt lgkmcnt(8)
    v_mfma_f32_16x16x32_bf16 a[192:195], a[144:147], a[40:43], a[192:195]
    ds_read_b64_tr_b16 a[136:137], v234 offset:49152
    ds_read_b64_tr_b16 a[138:139], v234 offset:53248
    v_mfma_f32_16x16x32_bf16 a[196:199], a[144:147], a[44:47], a[196:199]
    buffer_load_dwordx4 v4, s[80:83], s60 offen lds
    v_mfma_f32_16x16x32_bf16 a[204:207], a[148:151], a[44:47], a[204:207]
    s_add_u32 m0, s54, 17408
    ds_read_b64_tr_b16 a[140:141], v235 offset:49152
    ds_read_b64_tr_b16 a[142:143], v235 offset:53248
    v_mfma_f32_16x16x32_bf16 a[200:203], a[148:151], a[40:43], a[200:203]
    v_and_b32 v36, 15, v1
    s_waitcnt lgkmcnt(8)
    v_mfma_f32_16x16x32_bf16 a[208:211], a[152:155], a[40:43], a[208:211]
    ds_read_b64_tr_b16 a[144:145], v236 offset:49152
    ds_read_b64_tr_b16 a[146:147], v236 offset:53248
    v_mfma_f32_16x16x32_bf16 a[212:215], a[152:155], a[44:47], a[212:215]
    buffer_load_dwordx4 v5, s[80:83], s60 offen lds
    s_add_u32 s60, s60, 65536
    v_mfma_f32_16x16x32_bf16 a[220:223], a[156:159], a[44:47], a[220:223]
    ds_read_b64_tr_b16 a[148:149], v237 offset:49152
    ds_read_b64_tr_b16 a[150:151], v237 offset:53248
    v_mfma_f32_16x16x32_bf16 a[216:219], a[156:159], a[40:43], a[216:219]
    v_mul_u32_u24 v36, 272, v36
    s_waitcnt vmcnt(37)
    s_waitcnt lgkmcnt(8)
    v_mfma_f32_16x16x32_bf16 a[160:163], a[128:131], a[48:51], a[160:163]
    ds_read_b64_tr_b16 a[152:153], v238 offset:49152
    ds_read_b64_tr_b16 a[154:155], v238 offset:53248
    v_mfma_f32_16x16x32_bf16 a[164:167], a[128:131], a[52:55], a[164:167]
    buffer_load_dwordx4 a[16:19], v2, s[16:19], s59 offen offset:2048 sc1
    v_mfma_f32_16x16x32_bf16 a[172:175], a[132:135], a[52:55], a[172:175]
    ds_read_b64_tr_b16 a[156:157], v239 offset:49152
    ds_read_b64_tr_b16 a[158:159], v239 offset:53248
    v_mfma_f32_16x16x32_bf16 a[168:171], a[132:135], a[48:51], a[168:171]
    buffer_load_dwordx4 a[20:23], v3, s[16:19], s59 offen offset:2048 sc1
    s_waitcnt lgkmcnt(8)
    v_mfma_f32_16x16x32_bf16 a[176:179], a[136:139], a[48:51], a[176:179]
    s_add_u32 m0, s54, 24576
    ds_read_b64_tr_b16 a[128:129], v232 offset:57344
    ds_read_b64_tr_b16 a[130:131], v232 offset:61440
    v_mfma_f32_16x16x32_bf16 a[180:183], a[136:139], a[52:55], a[180:183]
    buffer_load_dwordx4 v4, s[80:83], s60 offen lds
    v_mfma_f32_16x16x32_bf16 a[188:191], a[140:143], a[52:55], a[188:191]
    s_add_u32 m0, s54, 25600
    ds_read_b64_tr_b16 a[132:133], v233 offset:57344
    ds_read_b64_tr_b16 a[134:135], v233 offset:61440
    v_mfma_f32_16x16x32_bf16 a[184:187], a[140:143], a[48:51], a[184:187]
    v_lshrrev_b32 v65, 4, v1
    s_waitcnt lgkmcnt(8)
    v_mfma_f32_16x16x32_bf16 a[192:195], a[144:147], a[48:51], a[192:195]
    ds_read_b64_tr_b16 a[136:137], v234 offset:57344
    ds_read_b64_tr_b16 a[138:139], v234 offset:61440
    v_mfma_f32_16x16x32_bf16 a[196:199], a[144:147], a[52:55], a[196:199]
    buffer_load_dwordx4 v5, s[80:83], s60 offen lds
    s_add_u32 s60, s60, 65536
    v_mfma_f32_16x16x32_bf16 a[204:207], a[148:151], a[52:55], a[204:207]
    ds_read_b64_tr_b16 a[140:141], v235 offset:57344
    ds_read_b64_tr_b16 a[142:143], v235 offset:61440
    v_mfma_f32_16x16x32_bf16 a[200:203], a[148:151], a[48:51], a[200:203]
    v_lshl_add_u32 v36, v65, 4, v36
    s_waitcnt lgkmcnt(8)
    v_mfma_f32_16x16x32_bf16 a[208:211], a[152:155], a[48:51], a[208:211]
    ds_read_b64_tr_b16 a[144:145], v236 offset:57344
    ds_read_b64_tr_b16 a[146:147], v236 offset:61440
    v_mfma_f32_16x16x32_bf16 a[212:215], a[152:155], a[52:55], a[212:215]
    buffer_load_dwordx4 a[24:27], v2, s[16:19], s59 offen offset:3072 sc1
    v_mfma_f32_16x16x32_bf16 a[220:223], a[156:159], a[52:55], a[220:223]
    ds_read_b64_tr_b16 a[148:149], v237 offset:57344
    ds_read_b64_tr_b16 a[150:151], v237 offset:61440
    v_mfma_f32_16x16x32_bf16 a[216:219], a[156:159], a[48:51], a[216:219]
    v_add_u32 v36, s62, v36
    s_waitcnt vmcnt(40)
    s_waitcnt lgkmcnt(8)
    v_mfma_f32_16x16x32_bf16 a[160:163], a[128:131], a[56:59], a[160:163]
    ds_read_b64_tr_b16 a[152:153], v238 offset:57344
    ds_read_b64_tr_b16 a[154:155], v238 offset:61440
    v_mfma_f32_16x16x32_bf16 a[164:167], a[128:131], a[60:63], a[164:167]
    buffer_load_dwordx4 a[28:31], v3, s[16:19], s59 offen offset:3072 sc1
    s_add_u32 s59, s59, 4096
    v_mfma_f32_16x16x32_bf16 a[172:175], a[132:135], a[60:63], a[172:175]
    s_add_u32 m0, s54, 32768
    ds_read_b64_tr_b16 a[156:157], v239 offset:57344
    ds_read_b64_tr_b16 a[158:159], v239 offset:61440
    v_mfma_f32_16x16x32_bf16 a[168:171], a[132:135], a[56:59], a[168:171]
    v_mul_u32_u24 v37, 272, v64
    s_barrier
    s_waitcnt lgkmcnt(8)
    v_mfma_f32_16x16x32_bf16 a[176:179], a[136:139], a[56:59], a[176:179]
    ds_read_b64_tr_b16 a[128:129], v240 offset:0
    ds_read_b64_tr_b16 a[130:131], v240 offset:4096
    v_mfma_f32_16x16x32_bf16 a[180:183], a[136:139], a[60:63], a[180:183]
    buffer_load_dwordx4 v4, s[80:83], s60 offen lds
    v_mfma_f32_16x16x32_bf16 a[188:191], a[140:143], a[60:63], a[188:191]
    s_add_u32 m0, s54, 33792
    ds_read_b64_tr_b16 a[132:133], v241 offset:0
    ds_read_b64_tr_b16 a[134:135], v241 offset:4096
    v_mfma_f32_16x16x32_bf16 a[184:187], a[140:143], a[56:59], a[184:187]
    v_lshl_add_u32 v37, v66, 5, v37
    s_waitcnt lgkmcnt(8)
    v_mfma_f32_16x16x32_bf16 a[192:195], a[144:147], a[56:59], a[192:195]
    ds_read_b64_tr_b16 a[136:137], v242 offset:0
    ds_read_b64_tr_b16 a[138:139], v242 offset:4096
    v_mfma_f32_16x16x32_bf16 a[196:199], a[144:147], a[60:63], a[196:199]
    buffer_load_dwordx4 v5, s[80:83], s60 offen lds
    s_add_u32 s60, s60, 65536
    v_mfma_f32_16x16x32_bf16 a[204:207], a[148:151], a[60:63], a[204:207]
    ds_read_b64_tr_b16 a[140:141], v243 offset:0
    ds_read_b64_tr_b16 a[142:143], v243 offset:4096
    v_mfma_f32_16x16x32_bf16 a[200:203], a[148:151], a[56:59], a[200:203]
    v_add_u32 v37, s62, v37
    s_waitcnt lgkmcnt(8)
    v_mfma_f32_16x16x32_bf16 a[208:211], a[152:155], a[56:59], a[208:211]
    ds_read_b64_tr_b16 a[144:145], v244 offset:0
    ds_read_b64_tr_b16 a[146:147], v244 offset:4096
    v_mfma_f32_16x16x32_bf16 a[212:215], a[152:155], a[60:63], a[212:215]
    buffer_load_dwordx4 a[32:35], v2, s[16:19], s59 offen offset:0 sc1
    v_mfma_f32_16x16x32_bf16 a[220:223], a[156:159], a[60:63], a[220:223]
    ds_read_b64_tr_b16 a[148:149], v245 offset:0
    ds_read_b64_tr_b16 a[150:151], v245 offset:4096
    v_mfma_f32_16x16x32_bf16 a[216:219], a[156:159], a[56:59], a[216:219]
    s_lshl_b32 s62, s34, 29
    s_lshl_b32 s55, s2, 7
    s_add_u32 s55, s55, 50397184
    s_waitcnt vmcnt(42)
    s_waitcnt lgkmcnt(8)
    v_mfma_f32_16x16x32_bf16 a[160:163], a[128:131], a[64:67], a[160:163]
    ds_read_b64_tr_b16 a[152:153], v246 offset:0
    ds_read_b64_tr_b16 a[154:155], v246 offset:4096
    v_mfma_f32_16x16x32_bf16 a[164:167], a[128:131], a[68:71], a[164:167]
    buffer_load_dwordx4 a[36:39], v3, s[16:19], s59 offen offset:0 sc1
    v_mfma_f32_16x16x32_bf16 a[172:175], a[132:135], a[68:71], a[172:175]
    s_add_u32 m0, s54, 40960
    ds_read_b64_tr_b16 a[156:157], v247 offset:0
    ds_read_b64_tr_b16 a[158:159], v247 offset:4096
    v_mfma_f32_16x16x32_bf16 a[168:171], a[132:135], a[64:67], a[168:171]
    s_xor_b32 s56, s55, 512
    s_add_u32 s55, s55, s62
    s_and_b32 s48, s15, 1
    s_waitcnt lgkmcnt(8)
    v_mfma_f32_16x16x32_bf16 a[176:179], a[136:139], a[64:67], a[176:179]
    ds_read_b64_tr_b16 a[128:129], v240 offset:8192
    ds_read_b64_tr_b16 a[130:131], v240 offset:12288
    v_mfma_f32_16x16x32_bf16 a[180:183], a[136:139], a[68:71], a[180:183]
    buffer_load_dwordx4 v4, s[80:83], s60 offen lds
    v_mfma_f32_16x16x32_bf16 a[188:191], a[140:143], a[68:71], a[188:191]
    s_add_u32 m0, s54, 41984
    ds_read_b64_tr_b16 a[132:133], v241 offset:8192
    ds_read_b64_tr_b16 a[134:135], v241 offset:12288
    v_mfma_f32_16x16x32_bf16 a[184:187], a[140:143], a[64:67], a[184:187]
    s_lshl_b32 s48, s48, 4
    s_add_u32 s48, s48, s31
    s_lshr_b32 s49, s15, 1
    s_waitcnt lgkmcnt(8)
    v_mfma_f32_16x16x32_bf16 a[192:195], a[144:147], a[64:67], a[192:195]
    ds_read_b64_tr_b16 a[136:137], v242 offset:8192
    ds_read_b64_tr_b16 a[138:139], v242 offset:12288
    v_mfma_f32_16x16x32_bf16 a[196:199], a[144:147], a[68:71], a[196:199]
    buffer_load_dwordx4 v5, s[80:83], s60 offen lds
    s_add_u32 s60, s60, 65536
    v_mfma_f32_16x16x32_bf16 a[204:207], a[148:151], a[68:71], a[204:207]
    ds_read_b64_tr_b16 a[140:141], v243 offset:8192
    ds_read_b64_tr_b16 a[142:143], v243 offset:12288
    v_mfma_f32_16x16x32_bf16 a[200:203], a[148:151], a[64:67], a[200:203]
    s_lshl_b32 s50, s34, 12
    s_add_u32 s50, s50, 0
    s_lshl_b32 s57, s49, 19
    s_waitcnt lgkmcnt(8)
    v_mfma_f32_16x16x32_bf16 a[208:211], a[152:155], a[64:67], a[208:211]
    ds_read_b64_tr_b16 a[144:145], v244 offset:8192
    ds_read_b64_tr_b16 a[146:147], v244 offset:12288
    v_mfma_f32_16x16x32_bf16 a[212:215], a[152:155], a[68:71], a[212:215]
    buffer_load_dwordx4 a[40:43], v2, s[16:19], s59 offen offset:1024 sc1
    v_mfma_f32_16x16x32_bf16 a[220:223], a[156:159], a[68:71], a[220:223]
    ds_read_b64_tr_b16 a[148:149], v245 offset:8192
    ds_read_b64_tr_b16 a[150:151], v245 offset:12288
    v_mfma_f32_16x16x32_bf16 a[216:219], a[156:159], a[64:67], a[216:219]
    s_lshl_b32 s58, s48, 14
    s_add_u32 s57, s57, s58
    s_add_u32 s57, s57, s50
    s_waitcnt vmcnt(44)
    s_waitcnt lgkmcnt(8)
    v_mfma_f32_16x16x32_bf16 a[160:163], a[128:131], a[72:75], a[160:163]
    ds_read_b64_tr_b16 a[152:153], v246 offset:8192
    ds_read_b64_tr_b16 a[154:155], v246 offset:12288
    v_mfma_f32_16x16x32_bf16 a[164:167], a[128:131], a[76:79], a[164:167]
    buffer_load_dwordx4 a[44:47], v3, s[16:19], s59 offen offset:1024 sc1
    v_mfma_f32_16x16x32_bf16 a[172:175], a[132:135], a[76:79], a[172:175]
    s_add_u32 m0, s54, 49152
    ds_read_b64_tr_b16 a[156:157], v247 offset:8192
    ds_read_b64_tr_b16 a[158:159], v247 offset:12288
    v_mfma_f32_16x16x32_bf16 a[168:171], a[132:135], a[72:75], a[168:171]
    buffer_load_dwordx4 v4, s[80:83], s60 offen lds
    s_waitcnt vmcnt(27)
    s_barrier
    s_mov_b64 exec, 1
    buffer_store_dwordx2 v[250:251], off, s[16:19], s67 sc1
    s_mov_b64 exec, -1
    s_waitcnt lgkmcnt(8)
    v_mfma_f32_16x16x32_bf16 a[176:179], a[136:139], a[72:75], a[176:179]
    s_add_u32 m0, s54, 50176
    ds_read_b64_tr_b16 a[128:129], v240 offset:16384
    ds_read_b64_tr_b16 a[130:131], v240 offset:20480
    v_mfma_f32_16x16x32_bf16 a[180:183], a[136:139], a[76:79], a[180:183]
    buffer_load_dwordx4 v5, s[80:83], s60 offen lds
    s_add_u32 s60, s60, 65536
    v_mfma_f32_16x16x32_bf16 a[188:191], a[140:143], a[76:79], a[188:191]
    ds_read_b64_tr_b16 a[132:133], v241 offset:16384
    ds_read_b64_tr_b16 a[134:135], v241 offset:20480
    v_mfma_f32_16x16x32_bf16 a[184:187], a[140:143], a[72:75], a[184:187]
    s_xor_b32 s58, s57, 16384
    s_lshl_b32 s48, s48, 17
    s_lshl_b32 s49, s49, 14
    s_waitcnt lgkmcnt(8)
    v_mfma_f32_16x16x32_bf16 a[192:195], a[144:147], a[72:75], a[192:195]
    ds_read_b64_tr_b16 a[136:137], v242 offset:16384
    ds_read_b64_tr_b16 a[138:139], v242 offset:20480
    v_mfma_f32_16x16x32_bf16 a[196:199], a[144:147], a[76:79], a[196:199]
    buffer_load_dwordx4 a[48:51], v2, s[16:19], s59 offen offset:2048 sc1
    v_mfma_f32_16x16x32_bf16 a[204:207], a[148:151], a[76:79], a[204:207]
    ds_read_b64_tr_b16 a[140:141], v243 offset:16384
    ds_read_b64_tr_b16 a[142:143], v243 offset:20480
    v_mfma_f32_16x16x32_bf16 a[200:203], a[148:151], a[72:75], a[200:203]
    s_add_u32 s48, s48, s49
    s_add_u32 s48, s48, s50
    s_add_u32 s48, s48, 4194304
    s_waitcnt lgkmcnt(8)
    v_mfma_f32_16x16x32_bf16 a[208:211], a[152:155], a[72:75], a[208:211]
    ds_read_b64_tr_b16 a[144:145], v244 offset:16384
    ds_read_b64_tr_b16 a[146:147], v244 offset:20480
    v_mfma_f32_16x16x32_bf16 a[212:215], a[152:155], a[76:79], a[212:215]
    buffer_load_dwordx4 a[52:55], v3, s[16:19], s59 offen offset:2048 sc1
    v_mfma_f32_16x16x32_bf16 a[220:223], a[156:159], a[76:79], a[220:223]
    ds_read_b64_tr_b16 a[148:149], v245 offset:16384
    ds_read_b64_tr_b16 a[150:151], v245 offset:20480
    v_mfma_f32_16x16x32_bf16 a[216:219], a[156:159], a[72:75], a[216:219]
    s_xor_b32 s49, s48, 131072
    v_mov_b32 v38, 0
    s_waitcnt lgkmcnt(8)
    v_mfma_f32_16x16x32_bf16 a[160:163], a[128:131], a[80:83], a[160:163]
    ds_read_b64_tr_b16 a[152:153], v246 offset:16384
    ds_read_b64_tr_b16 a[154:155], v246 offset:20480
    v_mfma_f32_16x16x32_bf16 a[164:167], a[128:131], a[84:87], a[164:167]
    global_load_dword a224, v248, s[92:93]
    v_mfma_f32_16x16x32_bf16 a[172:175], a[132:135], a[84:87], a[172:175]
    s_add_u32 m0, s54, 57344
    ds_read_b64_tr_b16 a[156:157], v247 offset:16384
    ds_read_b64_tr_b16 a[158:159], v247 offset:20480
    v_mfma_f32_16x16x32_bf16 a[168:171], a[132:135], a[80:83], a[168:171]
    buffer_load_dwordx4 v4, s[80:83], s60 offen lds
    s_waitcnt lgkmcnt(8)
    v_mfma_f32_16x16x32_bf16 a[176:179], a[136:139], a[80:83], a[176:179]
    s_add_u32 m0, s54, 58368
    ds_read_b64_tr_b16 a[128:129], v240 offset:24576
    ds_read_b64_tr_b16 a[130:131], v240 offset:28672
    v_mfma_f32_16x16x32_bf16 a[180:183], a[136:139], a[84:87], a[180:183]
    buffer_load_dwordx4 v5, s[80:83], s60 offen lds
    s_add_u32 s60, s60, 65536
    v_mfma_f32_16x16x32_bf16 a[188:191], a[140:143], a[84:87], a[188:191]
    ds_read_b64_tr_b16 a[132:133], v241 offset:24576
    ds_read_b64_tr_b16 a[134:135], v241 offset:28672
    v_mfma_f32_16x16x32_bf16 a[184:187], a[140:143], a[80:83], a[184:187]
    s_waitcnt lgkmcnt(8)
    v_mfma_f32_16x16x32_bf16 a[192:195], a[144:147], a[80:83], a[192:195]
    ds_read_b64_tr_b16 a[136:137], v242 offset:24576
    ds_read_b64_tr_b16 a[138:139], v242 offset:28672
    v_mfma_f32_16x16x32_bf16 a[196:199], a[144:147], a[84:87], a[196:199]
    buffer_load_dwordx4 a[56:59], v2, s[16:19], s59 offen offset:3072 sc1
    v_mfma_f32_16x16x32_bf16 a[204:207], a[148:151], a[84:87], a[204:207]
    ds_read_b64_tr_b16 a[140:141], v243 offset:24576
    ds_read_b64_tr_b16 a[142:143], v243 offset:28672
    v_mfma_f32_16x16x32_bf16 a[200:203], a[148:151], a[80:83], a[200:203]
    s_waitcnt lgkmcnt(8)
    v_mfma_f32_16x16x32_bf16 a[208:211], a[152:155], a[80:83], a[208:211]
    ds_read_b64_tr_b16 a[144:145], v244 offset:24576
    ds_read_b64_tr_b16 a[146:147], v244 offset:28672
    v_mfma_f32_16x16x32_bf16 a[212:215], a[152:155], a[84:87], a[212:215]
    buffer_load_dwordx4 a[60:63], v3, s[16:19], s59 offen offset:3072 sc1
    s_add_u32 s59, s59, 4096
    v_mfma_f32_16x16x32_bf16 a[220:223], a[156:159], a[84:87], a[220:223]
    ds_read_b64_tr_b16 a[148:149], v245 offset:24576
    ds_read_b64_tr_b16 a[150:151], v245 offset:28672
    v_mfma_f32_16x16x32_bf16 a[216:219], a[156:159], a[80:83], a[216:219]
    s_waitcnt lgkmcnt(8)
    v_mfma_f32_16x16x32_bf16 a[160:163], a[128:131], a[88:91], a[160:163]
    s_add_u32 m0, s54, 65536
    ds_read_b64_tr_b16 a[152:153], v246 offset:24576
    ds_read_b64_tr_b16 a[154:155], v246 offset:28672
    v_mfma_f32_16x16x32_bf16 a[164:167], a[128:131], a[92:95], a[164:167]
    buffer_load_dwordx4 v4, s[80:83], s60 offen lds
    v_mfma_f32_16x16x32_bf16 a[172:175], a[132:135], a[92:95], a[172:175]
    s_add_u32 m0, s54, 66560
    ds_read_b64_tr_b16 a[156:157], v247 offset:24576
    ds_read_b64_tr_b16 a[158:159], v247 offset:28672
    v_mfma_f32_16x16x32_bf16 a[168:171], a[132:135], a[88:91], a[168:171]
    s_barrier
    s_waitcnt lgkmcnt(8)
    v_mfma_f32_16x16x32_bf16 a[176:179], a[136:139], a[88:91], a[176:179]
    ds_read_b64_tr_b16 a[128:129], v240 offset:32768
    ds_read_b64_tr_b16 a[130:131], v240 offset:36864
    v_mfma_f32_16x16x32_bf16 a[180:183], a[136:139], a[92:95], a[180:183]
    buffer_load_dwordx4 v5, s[80:83], s60 offen lds
    s_add_u32 s60, s60, 65536
    v_mfma_f32_16x16x32_bf16 a[188:191], a[140:143], a[92:95], a[188:191]
    ds_read_b64_tr_b16 a[132:133], v241 offset:32768
    ds_read_b64_tr_b16 a[134:135], v241 offset:36864
    v_mfma_f32_16x16x32_bf16 a[184:187], a[140:143], a[88:91], a[184:187]
    s_waitcnt lgkmcnt(8)
    v_mfma_f32_16x16x32_bf16 a[192:195], a[144:147], a[88:91], a[192:195]
    ds_read_b64_tr_b16 a[136:137], v242 offset:32768
    ds_read_b64_tr_b16 a[138:139], v242 offset:36864
    v_mfma_f32_16x16x32_bf16 a[196:199], a[144:147], a[92:95], a[196:199]
    buffer_load_dwordx2 a[64:65], v10, s[16:19], s59 offen offset:0 sc1
    v_mfma_f32_16x16x32_bf16 a[204:207], a[148:151], a[92:95], a[204:207]
    ds_read_b64_tr_b16 a[140:141], v243 offset:32768
    ds_read_b64_tr_b16 a[142:143], v243 offset:36864
    v_mfma_f32_16x16x32_bf16 a[200:203], a[148:151], a[88:91], a[200:203]
    s_waitcnt lgkmcnt(8)
    v_mfma_f32_16x16x32_bf16 a[208:211], a[152:155], a[88:91], a[208:211]
    ds_read_b64_tr_b16 a[144:145], v244 offset:32768
    ds_read_b64_tr_b16 a[146:147], v244 offset:36864
    v_mfma_f32_16x16x32_bf16 a[212:215], a[152:155], a[92:95], a[212:215]
    buffer_load_dwordx2 a[66:67], v10, s[16:19], s59 offen offset:512 sc1
    v_mfma_f32_16x16x32_bf16 a[220:223], a[156:159], a[92:95], a[220:223]
    ds_read_b64_tr_b16 a[148:149], v245 offset:32768
    ds_read_b64_tr_b16 a[150:151], v245 offset:36864
    v_mfma_f32_16x16x32_bf16 a[216:219], a[156:159], a[88:91], a[216:219]
    s_waitcnt lgkmcnt(8)
    v_mfma_f32_16x16x32_bf16 a[160:163], a[128:131], a[96:99], a[160:163]
    ds_read_b64_tr_b16 a[152:153], v246 offset:32768
    ds_read_b64_tr_b16 a[154:155], v246 offset:36864
    v_mfma_f32_16x16x32_bf16 a[164:167], a[128:131], a[100:103], a[164:167]
    buffer_load_dwordx2 a[68:69], v11, s[16:19], s59 offen offset:0 sc1
    v_mfma_f32_16x16x32_bf16 a[172:175], a[132:135], a[100:103], a[172:175]
    ds_read_b64_tr_b16 a[156:157], v247 offset:32768
    ds_read_b64_tr_b16 a[158:159], v247 offset:36864
    v_mfma_f32_16x16x32_bf16 a[168:171], a[132:135], a[96:99], a[168:171]
    s_waitcnt lgkmcnt(8)
    v_mfma_f32_16x16x32_bf16 a[176:179], a[136:139], a[96:99], a[176:179]
    ds_read_b64_tr_b16 a[128:129], v240 offset:40960
    ds_read_b64_tr_b16 a[130:131], v240 offset:45056
    v_mfma_f32_16x16x32_bf16 a[180:183], a[136:139], a[100:103], a[180:183]
    buffer_load_dwordx2 a[70:71], v11, s[16:19], s59 offen offset:512 sc1
    v_mfma_f32_16x16x32_bf16 a[188:191], a[140:143], a[100:103], a[188:191]
    s_add_u32 m0, s54, 73728
    ds_read_b64_tr_b16 a[132:133], v241 offset:40960
    ds_read_b64_tr_b16 a[134:135], v241 offset:45056
    v_mfma_f32_16x16x32_bf16 a[184:187], a[140:143], a[96:99], a[184:187]
    s_waitcnt lgkmcnt(8)
    v_mfma_f32_16x16x32_bf16 a[192:195], a[144:147], a[96:99], a[192:195]
    ds_read_b64_tr_b16 a[136:137], v242 offset:40960
    ds_read_b64_tr_b16 a[138:139], v242 offset:45056
    v_mfma_f32_16x16x32_bf16 a[196:199], a[144:147], a[100:103], a[196:199]
    buffer_load_dwordx4 v4, s[80:83], s60 offen lds
    v_mfma_f32_16x16x32_bf16 a[204:207], a[148:151], a[100:103], a[204:207]
    s_add_u32 m0, s54, 74752
    ds_read_b64_tr_b16 a[140:141], v243 offset:40960
    ds_read_b64_tr_b16 a[142:143], v243 offset:45056
    v_mfma_f32_16x16x32_bf16 a[200:203], a[148:151], a[96:99], a[200:203]
    s_waitcnt lgkmcnt(8)
    v_mfma_f32_16x16x32_bf16 a[208:211], a[152:155], a[96:99], a[208:211]
    ds_read_b64_tr_b16 a[144:145], v244 offset:40960
    ds_read_b64_tr_b16 a[146:147], v244 offset:45056
    v_mfma_f32_16x16x32_bf16 a[212:215], a[152:155], a[100:103], a[212:215]
    buffer_load_dwordx4 v5, s[80:83], s60 offen lds
    s_add_u32 s60, s60, 65536
    v_mfma_f32_16x16x32_bf16 a[220:223], a[156:159], a[100:103], a[220:223]
    ds_read_b64_tr_b16 a[148:149], v245 offset:40960
    ds_read_b64_tr_b16 a[150:151], v245 offset:45056
    v_mfma_f32_16x16x32_bf16 a[216:219], a[156:159], a[96:99], a[216:219]
    s_waitcnt lgkmcnt(8)
    v_mfma_f32_16x16x32_bf16 a[160:163], a[128:131], a[104:107], a[160:163]
    ds_read_b64_tr_b16 a[152:153], v246 offset:40960
    ds_read_b64_tr_b16 a[154:155], v246 offset:45056
    v_mfma_f32_16x16x32_bf16 a[164:167], a[128:131], a[108:111], a[164:167]
    buffer_load_dwordx4 a[72:75], v2, s[16:19], s59 offen offset:1024 sc1
    v_mfma_f32_16x16x32_bf16 a[172:175], a[132:135], a[108:111], a[172:175]
    ds_read_b64_tr_b16 a[156:157], v247 offset:40960
    ds_read_b64_tr_b16 a[158:159], v247 offset:45056
    v_mfma_f32_16x16x32_bf16 a[168:171], a[132:135], a[104:107], a[168:171]
    buffer_load_dwordx4 a[76:79], v3, s[16:19], s59 offen offset:1024 sc1
    s_barrier
    s_waitcnt lgkmcnt(8)
    v_mfma_f32_16x16x32_bf16 a[176:179], a[136:139], a[104:107], a[176:179]
    s_add_u32 m0, s54, 81920
    ds_read_b64_tr_b16 a[128:129], v240 offset:49152
    ds_read_b64_tr_b16 a[130:131], v240 offset:53248
    v_mfma_f32_16x16x32_bf16 a[180:183], a[136:139], a[108:111], a[180:183]
    buffer_load_dwordx4 v4, s[80:83], s60 offen lds
    v_mfma_f32_16x16x32_bf16 a[188:191], a[140:143], a[108:111], a[188:191]
    s_add_u32 m0, s54, 82944
    ds_read_b64_tr_b16 a[132:133], v241 offset:49152
    ds_read_b64_tr_b16 a[134:135], v241 offset:53248
    v_mfma_f32_16x16x32_bf16 a[184:187], a[140:143], a[104:107], a[184:187]
    s_waitcnt lgkmcnt(8)
    v_mfma_f32_16x16x32_bf16 a[192:195], a[144:147], a[104:107], a[192:195]
    ds_read_b64_tr_b16 a[136:137], v242 offset:49152
    ds_read_b64_tr_b16 a[138:139], v242 offset:53248
    v_mfma_f32_16x16x32_bf16 a[196:199], a[144:147], a[108:111], a[196:199]
    buffer_load_dwordx4 v5, s[80:83], s60 offen lds
    s_add_u32 s60, s60, 65536
    v_mfma_f32_16x16x32_bf16 a[204:207], a[148:151], a[108:111], a[204:207]
    ds_read_b64_tr_b16 a[140:141], v243 offset:49152
    ds_read_b64_tr_b16 a[142:143], v243 offset:53248
    v_mfma_f32_16x16x32_bf16 a[200:203], a[148:151], a[104:107], a[200:203]
    s_waitcnt lgkmcnt(8)
    v_mfma_f32_16x16x32_bf16 a[208:211], a[152:155], a[104:107], a[208:211]
    ds_read_b64_tr_b16 a[144:145], v244 offset:49152
    ds_read_b64_tr_b16 a[146:147], v244 offset:53248
    v_mfma_f32_16x16x32_bf16 a[212:215], a[152:155], a[108:111], a[212:215]
    buffer_load_dwordx4 a[80:83], v2, s[16:19], s59 offen offset:2048 sc1
    v_mfma_f32_16x16x32_bf16 a[220:223], a[156:159], a[108:111], a[220:223]
    ds_read_b64_tr_b16 a[148:149], v245 offset:49152
    ds_read_b64_tr_b16 a[150:151], v245 offset:53248
    v_mfma_f32_16x16x32_bf16 a[216:219], a[156:159], a[104:107], a[216:219]
    s_waitcnt lgkmcnt(8)
    v_mfma_f32_16x16x32_bf16 a[160:163], a[128:131], a[112:115], a[160:163]
    ds_read_b64_tr_b16 a[152:153], v246 offset:49152
    ds_read_b64_tr_b16 a[154:155], v246 offset:53248
    v_mfma_f32_16x16x32_bf16 a[164:167], a[128:131], a[116:119], a[164:167]
    buffer_load_dwordx4 a[84:87], v3, s[16:19], s59 offen offset:2048 sc1
    v_mfma_f32_16x16x32_bf16 a[172:175], a[132:135], a[116:119], a[172:175]
    s_add_u32 m0, s54, 90112
    ds_read_b64_tr_b16 a[156:157], v247 offset:49152
    ds_read_b64_tr_b16 a[158:159], v247 offset:53248
    v_mfma_f32_16x16x32_bf16 a[168:171], a[132:135], a[112:115], a[168:171]
    s_waitcnt lgkmcnt(8)
    v_mfma_f32_16x16x32_bf16 a[176:179], a[136:139], a[112:115], a[176:179]
    ds_read_b64_tr_b16 a[128:129], v240 offset:57344
    ds_read_b64_tr_b16 a[130:131], v240 offset:61440
    v_mfma_f32_16x16x32_bf16 a[180:183], a[136:139], a[116:119], a[180:183]
    buffer_load_dwordx4 v4, s[80:83], s60 offen lds
    v_mfma_f32_16x16x32_bf16 a[188:191], a[140:143], a[116:119], a[188:191]
    s_add_u32 m0, s54, 91136
    ds_read_b64_tr_b16 a[132:133], v241 offset:57344
    ds_read_b64_tr_b16 a[134:135], v241 offset:61440
    v_mfma_f32_16x16x32_bf16 a[184:187], a[140:143], a[112:115], a[184:187]
    s_waitcnt lgkmcnt(8)
    v_mfma_f32_16x16x32_bf16 a[192:195], a[144:147], a[112:115], a[192:195]
    ds_read_b64_tr_b16 a[136:137], v242 offset:57344
    ds_read_b64_tr_b16 a[138:139], v242 offset:61440
    v_mfma_f32_16x16x32_bf16 a[196:199], a[144:147], a[116:119], a[196:199]
    buffer_load_dwordx4 v5, s[80:83], s60 offen lds
    s_add_u32 s60, s60, 65536
    v_mfma_f32_16x16x32_bf16 a[204:207], a[148:151], a[116:119], a[204:207]
    ds_read_b64_tr_b16 a[140:141], v243 offset:57344
    ds_read_b64_tr_b16 a[142:143], v243 offset:61440
    v_mfma_f32_16x16x32_bf16 a[200:203], a[148:151], a[112:115], a[200:203]
    s_waitcnt lgkmcnt(8)
    v_mfma_f32_16x16x32_bf16 a[208:211], a[152:155], a[112:115], a[208:211]
    ds_read_b64_tr_b16 a[144:145], v244 offset:57344
    ds_read_b64_tr_b16 a[146:147], v244 offset:61440
    v_mfma_f32_16x16x32_bf16 a[212:215], a[152:155], a[116:119], a[212:215]
    buffer_load_dwordx4 a[88:91], v2, s[16:19], s59 offen offset:3072 sc1
    v_mfma_f32_16x16x32_bf16 a[220:223], a[156:159], a[116:119], a[220:223]
    ds_read_b64_tr_b16 a[148:149], v245 offset:57344
    ds_read_b64_tr_b16 a[150:151], v245 offset:61440
    v_mfma_f32_16x16x32_bf16 a[216:219], a[156:159], a[112:115], a[216:219]
    s_waitcnt lgkmcnt(8)
    v_mfma_f32_16x16x32_bf16 a[160:163], a[128:131], a[120:123], a[160:163]
    ds_read_b64_tr_b16 a[152:153], v246 offset:57344
    ds_read_b64_tr_b16 a[154:155], v246 offset:61440
    v_mfma_f32_16x16x32_bf16 a[164:167], a[128:131], a[124:127], a[164:167]
    buffer_load_dwordx4 a[92:95], v3, s[16:19], s59 offen offset:3072 sc1
    s_add_u32 s59, s59, 4096
    v_mfma_f32_16x16x32_bf16 a[172:175], a[132:135], a[124:127], a[172:175]
    s_add_u32 m0, s54, 98304
    ds_read_b64_tr_b16 a[156:157], v247 offset:57344
    ds_read_b64_tr_b16 a[158:159], v247 offset:61440
    v_mfma_f32_16x16x32_bf16 a[168:171], a[132:135], a[120:123], a[168:171]
    s_waitcnt vmcnt(48)
    s_barrier
    s_waitcnt lgkmcnt(8)
    v_mfma_f32_16x16x32_bf16 a[176:179], a[136:139], a[120:123], a[176:179]
    ds_read_b64_tr_b16 a[128:129], v232 offset:0
    ds_read_b64_tr_b16 a[130:131], v232 offset:4096
    v_mfma_f32_16x16x32_bf16 a[180:183], a[136:139], a[124:127], a[180:183]
    buffer_load_dwordx4 v4, s[80:83], s60 offen lds
    v_mfma_f32_16x16x32_bf16 a[188:191], a[140:143], a[124:127], a[188:191]
    s_add_u32 m0, s54, 99328
    ds_read_b64_tr_b16 a[132:133], v233 offset:0
    ds_read_b64_tr_b16 a[134:135], v233 offset:4096
    v_mfma_f32_16x16x32_bf16 a[184:187], a[140:143], a[120:123], a[184:187]
    s_waitcnt lgkmcnt(8)
    v_mfma_f32_16x16x32_bf16 a[192:195], a[144:147], a[120:123], a[192:195]
    ds_read_b64_tr_b16 a[136:137], v234 offset:0
    ds_read_b64_tr_b16 a[138:139], v234 offset:4096
    v_mfma_f32_16x16x32_bf16 a[196:199], a[144:147], a[124:127], a[196:199]
    buffer_load_dwordx4 v5, s[80:83], s60 offen lds
    s_add_u32 s60, s60, 65536
    v_mfma_f32_16x16x32_bf16 a[204:207], a[148:151], a[124:127], a[204:207]
    ds_read_b64_tr_b16 a[140:141], v235 offset:0
    ds_read_b64_tr_b16 a[142:143], v235 offset:4096
    v_mfma_f32_16x16x32_bf16 a[200:203], a[148:151], a[120:123], a[200:203]
    s_waitcnt lgkmcnt(8)
    v_mfma_f32_16x16x32_bf16 a[208:211], a[152:155], a[120:123], a[208:211]
    ds_read_b64_tr_b16 a[144:145], v236 offset:0
    ds_read_b64_tr_b16 a[146:147], v236 offset:4096
    v_mfma_f32_16x16x32_bf16 a[212:215], a[152:155], a[124:127], a[212:215]
    buffer_load_dwordx4 a[96:99], v2, s[16:19], s59 offen offset:0 sc1
    v_mfma_f32_16x16x32_bf16 a[220:223], a[156:159], a[124:127], a[220:223]
    ds_read_b64_tr_b16 a[148:149], v237 offset:0
    ds_read_b64_tr_b16 a[150:151], v237 offset:4096
    v_mfma_f32_16x16x32_bf16 a[216:219], a[156:159], a[120:123], a[216:219]
    s_waitcnt lgkmcnt(8)
    v_mfma_f32_16x16x32_bf16 a[160:163], a[128:131], a[0:3], a[160:163]
    ds_read_b64_tr_b16 a[152:153], v238 offset:0
    ds_read_b64_tr_b16 a[154:155], v238 offset:4096
    v_mfma_f32_16x16x32_bf16 a[164:167], a[128:131], a[4:7], a[164:167]
    buffer_load_dwordx4 a[100:103], v3, s[16:19], s59 offen offset:0 sc1
    v_mfma_f32_16x16x32_bf16 a[172:175], a[132:135], a[4:7], a[172:175]
    s_add_u32 m0, s54, 106496
    ds_read_b64_tr_b16 a[156:157], v239 offset:0
    ds_read_b64_tr_b16 a[158:159], v239 offset:4096
    v_mfma_f32_16x16x32_bf16 a[168:171], a[132:135], a[0:3], a[168:171]
    buffer_load_dwordx4 v4, s[80:83], s60 offen lds
    s_waitcnt lgkmcnt(8)
    v_mfma_f32_16x16x32_bf16 a[176:179], a[136:139], a[0:3], a[176:179]
    s_add_u32 m0, s54, 107520
    ds_read_b64_tr_b16 a[128:129], v232 offset:8192
    ds_read_b64_tr_b16 a[130:131], v232 offset:12288
    v_mfma_f32_16x16x32_bf16 a[180:183], a[136:139], a[4:7], a[180:183]
    buffer_load_dwordx4 v5, s[80:83], s60 offen lds
    s_add_u32 s60, s60, 65536
    v_mfma_f32_16x16x32_bf16 a[188:191], a[140:143], a[4:7], a[188:191]
    ds_read_b64_tr_b16 a[132:133], v233 offset:8192
    ds_read_b64_tr_b16 a[134:135], v233 offset:12288
    v_mfma_f32_16x16x32_bf16 a[184:187], a[140:143], a[0:3], a[184:187]
    s_waitcnt lgkmcnt(8)
    v_mfma_f32_16x16x32_bf16 a[192:195], a[144:147], a[0:3], a[192:195]
    ds_read_b64_tr_b16 a[136:137], v234 offset:8192
    ds_read_b64_tr_b16 a[138:139], v234 offset:12288
    v_mfma_f32_16x16x32_bf16 a[196:199], a[144:147], a[4:7], a[196:199]
    buffer_load_dwordx4 a[104:107], v2, s[16:19], s59 offen offset:1024 sc1
    v_mfma_f32_16x16x32_bf16 a[204:207], a[148:151], a[4:7], a[204:207]
    ds_read_b64_tr_b16 a[140:141], v235 offset:8192
    ds_read_b64_tr_b16 a[142:143], v235 offset:12288
    v_mfma_f32_16x16x32_bf16 a[200:203], a[148:151], a[0:3], a[200:203]
    s_waitcnt lgkmcnt(8)
    v_mfma_f32_16x16x32_bf16 a[208:211], a[152:155], a[0:3], a[208:211]
    ds_read_b64_tr_b16 a[144:145], v236 offset:8192
    ds_read_b64_tr_b16 a[146:147], v236 offset:12288
    v_mfma_f32_16x16x32_bf16 a[212:215], a[152:155], a[4:7], a[212:215]
    buffer_load_dwordx4 a[108:111], v3, s[16:19], s59 offen offset:1024 sc1
    v_mfma_f32_16x16x32_bf16 a[220:223], a[156:159], a[4:7], a[220:223]
    ds_read_b64_tr_b16 a[148:149], v237 offset:8192
    ds_read_b64_tr_b16 a[150:151], v237 offset:12288
    v_mfma_f32_16x16x32_bf16 a[216:219], a[156:159], a[0:3], a[216:219]
    s_waitcnt vmcnt(52)
    s_waitcnt lgkmcnt(8)
    v_mfma_f32_16x16x32_bf16 a[160:163], a[128:131], a[8:11], a[160:163]
    s_add_u32 m0, s54, 114688
    ds_read_b64_tr_b16 a[152:153], v238 offset:8192
    ds_read_b64_tr_b16 a[154:155], v238 offset:12288
    v_mfma_f32_16x16x32_bf16 a[164:167], a[128:131], a[12:15], a[164:167]
    buffer_load_dwordx4 v4, s[80:83], s60 offen lds
    v_mfma_f32_16x16x32_bf16 a[172:175], a[132:135], a[12:15], a[172:175]
    s_add_u32 m0, s54, 115712
    ds_read_b64_tr_b16 a[156:157], v239 offset:8192
    ds_read_b64_tr_b16 a[158:159], v239 offset:12288
    v_mfma_f32_16x16x32_bf16 a[168:171], a[132:135], a[8:11], a[168:171]
    s_waitcnt vmcnt(47)
    s_barrier
    s_waitcnt lgkmcnt(8)
    v_mfma_f32_16x16x32_bf16 a[176:179], a[136:139], a[8:11], a[176:179]
    ds_read_b64_tr_b16 a[128:129], v232 offset:16384
    ds_read_b64_tr_b16 a[130:131], v232 offset:20480
    v_mfma_f32_16x16x32_bf16 a[180:183], a[136:139], a[12:15], a[180:183]
    buffer_load_dwordx4 v5, s[80:83], s60 offen lds
    s_add_u32 s60, s60, 65536
    v_mfma_f32_16x16x32_bf16 a[188:191], a[140:143], a[12:15], a[188:191]
    ds_read_b64_tr_b16 a[132:133], v233 offset:16384
    ds_read_b64_tr_b16 a[134:135], v233 offset:20480
    v_mfma_f32_16x16x32_bf16 a[184:187], a[140:143], a[8:11], a[184:187]
    s_waitcnt lgkmcnt(8)
    v_mfma_f32_16x16x32_bf16 a[192:195], a[144:147], a[8:11], a[192:195]
    ds_read_b64_tr_b16 a[136:137], v234 offset:16384
    ds_read_b64_tr_b16 a[138:139], v234 offset:20480
    v_mfma_f32_16x16x32_bf16 a[196:199], a[144:147], a[12:15], a[196:199]
    buffer_load_dwordx4 a[112:115], v2, s[16:19], s59 offen offset:2048 sc1
    v_mfma_f32_16x16x32_bf16 a[204:207], a[148:151], a[12:15], a[204:207]
    ds_read_b64_tr_b16 a[140:141], v235 offset:16384
    ds_read_b64_tr_b16 a[142:143], v235 offset:20480
    v_mfma_f32_16x16x32_bf16 a[200:203], a[148:151], a[8:11], a[200:203]
    s_waitcnt lgkmcnt(8)
    v_mfma_f32_16x16x32_bf16 a[208:211], a[152:155], a[8:11], a[208:211]
    ds_read_b64_tr_b16 a[144:145], v236 offset:16384
    ds_read_b64_tr_b16 a[146:147], v236 offset:20480
    v_mfma_f32_16x16x32_bf16 a[212:215], a[152:155], a[12:15], a[212:215]
    buffer_load_dwordx4 a[116:119], v3, s[16:19], s59 offen offset:2048 sc1
    v_mfma_f32_16x16x32_bf16 a[220:223], a[156:159], a[12:15], a[220:223]
    ds_read_b64_tr_b16 a[148:149], v237 offset:16384
    ds_read_b64_tr_b16 a[150:151], v237 offset:20480
    v_mfma_f32_16x16x32_bf16 a[216:219], a[156:159], a[8:11], a[216:219]
    s_waitcnt lgkmcnt(8)
    v_mfma_f32_16x16x32_bf16 a[160:163], a[128:131], a[16:19], a[160:163]
    s_add_u32 m0, s54, 122880
    ds_read_b64_tr_b16 a[152:153], v238 offset:16384
    ds_read_b64_tr_b16 a[154:155], v238 offset:20480
    v_mfma_f32_16x16x32_bf16 a[164:167], a[128:131], a[20:23], a[164:167]
    buffer_load_dwordx4 v4, s[80:83], s60 offen lds
    v_mfma_f32_16x16x32_bf16 a[172:175], a[132:135], a[20:23], a[172:175]
    s_add_u32 m0, s54, 123904
    ds_read_b64_tr_b16 a[156:157], v239 offset:16384
    ds_read_b64_tr_b16 a[158:159], v239 offset:20480
    v_mfma_f32_16x16x32_bf16 a[168:171], a[132:135], a[16:19], a[168:171]
    s_waitcnt lgkmcnt(8)
    v_mfma_f32_16x16x32_bf16 a[176:179], a[136:139], a[16:19], a[176:179]
    ds_read_b64_tr_b16 a[128:129], v232 offset:24576
    ds_read_b64_tr_b16 a[130:131], v232 offset:28672
    v_mfma_f32_16x16x32_bf16 a[180:183], a[136:139], a[20:23], a[180:183]
    buffer_load_dwordx4 v5, s[80:83], s60 offen lds
    s_add_u32 s60, s60, 65536
    v_mfma_f32_16x16x32_bf16 a[188:191], a[140:143], a[20:23], a[188:191]
    ds_read_b64_tr_b16 a[132:133], v233 offset:24576
    ds_read_b64_tr_b16 a[134:135], v233 offset:28672
    v_mfma_f32_16x16x32_bf16 a[184:187], a[140:143], a[16:19], a[184:187]
    s_waitcnt lgkmcnt(8)
    v_mfma_f32_16x16x32_bf16 a[192:195], a[144:147], a[16:19], a[192:195]
    ds_read_b64_tr_b16 a[136:137], v234 offset:24576
    ds_read_b64_tr_b16 a[138:139], v234 offset:28672
    v_mfma_f32_16x16x32_bf16 a[196:199], a[144:147], a[20:23], a[196:199]
    buffer_load_dwordx2 a[120:121], v10, s[16:19], s59 offen offset:3072 sc1
    v_mfma_f32_16x16x32_bf16 a[204:207], a[148:151], a[20:23], a[204:207]
    ds_read_b64_tr_b16 a[140:141], v235 offset:24576
    ds_read_b64_tr_b16 a[142:143], v235 offset:28672
    v_mfma_f32_16x16x32_bf16 a[200:203], a[148:151], a[16:19], a[200:203]
    s_waitcnt lgkmcnt(8)
    v_mfma_f32_16x16x32_bf16 a[208:211], a[152:155], a[16:19], a[208:211]
    ds_read_b64_tr_b16 a[144:145], v236 offset:24576
    ds_read_b64_tr_b16 a[146:147], v236 offset:28672
    v_mfma_f32_16x16x32_bf16 a[212:215], a[152:155], a[20:23], a[212:215]
    buffer_load_dwordx2 a[122:123], v10, s[16:19], s59 offen offset:3584 sc1
    v_mfma_f32_16x16x32_bf16 a[220:223], a[156:159], a[20:23], a[220:223]
    ds_read_b64_tr_b16 a[148:149], v237 offset:24576
    ds_read_b64_tr_b16 a[150:151], v237 offset:28672
    v_mfma_f32_16x16x32_bf16 a[216:219], a[156:159], a[16:19], a[216:219]
    s_waitcnt vmcnt(52)
    s_waitcnt lgkmcnt(8)
    v_mfma_f32_16x16x32_bf16 a[160:163], a[128:131], a[24:27], a[160:163]
    ds_read_b64_tr_b16 a[152:153], v238 offset:24576
    ds_read_b64_tr_b16 a[154:155], v238 offset:28672
    v_mfma_f32_16x16x32_bf16 a[164:167], a[128:131], a[28:31], a[164:167]
    buffer_load_dwordx2 a[124:125], v11, s[16:19], s59 offen offset:3072 sc1
    v_mfma_f32_16x16x32_bf16 a[172:175], a[132:135], a[28:31], a[172:175]
    ds_read_b64_tr_b16 a[156:157], v239 offset:24576
    ds_read_b64_tr_b16 a[158:159], v239 offset:28672
    v_mfma_f32_16x16x32_bf16 a[168:171], a[132:135], a[24:27], a[168:171]
    buffer_load_dwordx2 a[126:127], v11, s[16:19], s59 offen offset:3584 sc1
    s_add_u32 s59, s59, 4096
    s_waitcnt vmcnt(48)
    s_barrier
    s_waitcnt lgkmcnt(8)
    v_mfma_f32_16x16x32_bf16 a[176:179], a[136:139], a[24:27], a[176:179]
    s_add_u32 m0, s54, 0
    ds_read_b64_tr_b16 a[128:129], v232 offset:32768
    ds_read_b64_tr_b16 a[130:131], v232 offset:36864
    v_mfma_f32_16x16x32_bf16 a[180:183], a[136:139], a[28:31], a[180:183]
    buffer_load_dwordx4 v4, s[80:83], s60 offen lds
    v_mfma_f32_16x16x32_bf16 a[188:191], a[140:143], a[28:31], a[188:191]
    s_add_u32 m0, s54, 1024
    ds_read_b64_tr_b16 a[132:133], v233 offset:32768
    ds_read_b64_tr_b16 a[134:135], v233 offset:36864
    v_mfma_f32_16x16x32_bf16 a[184:187], a[140:143], a[24:27], a[184:187]
    s_waitcnt lgkmcnt(8)
    v_mfma_f32_16x16x32_bf16 a[192:195], a[144:147], a[24:27], a[192:195]
    ds_read_b64_tr_b16 a[136:137], v234 offset:32768
    ds_read_b64_tr_b16 a[138:139], v234 offset:36864
    v_mfma_f32_16x16x32_bf16 a[196:199], a[144:147], a[28:31], a[196:199]
    buffer_load_dwordx4 v5, s[80:83], s60 offen lds
    s_add_u32 s60, s60, 65536
    v_mfma_f32_16x16x32_bf16 a[204:207], a[148:151], a[28:31], a[204:207]
    ds_read_b64_tr_b16 a[140:141], v235 offset:32768
    ds_read_b64_tr_b16 a[142:143], v235 offset:36864
    v_mfma_f32_16x16x32_bf16 a[200:203], a[148:151], a[24:27], a[200:203]
    s_waitcnt lgkmcnt(8)
    v_mfma_f32_16x16x32_bf16 a[208:211], a[152:155], a[24:27], a[208:211]
    ds_read_b64_tr_b16 a[144:145], v236 offset:32768
    ds_read_b64_tr_b16 a[146:147], v236 offset:36864
    v_mfma_f32_16x16x32_bf16 a[212:215], a[152:155], a[28:31], a[212:215]
    buffer_load_dwordx4 a[0:3], v2, s[16:19], s59 offen offset:0 sc1
    v_mfma_f32_16x16x32_bf16 a[220:223], a[156:159], a[28:31], a[220:223]
    ds_read_b64_tr_b16 a[148:149], v237 offset:32768
    ds_read_b64_tr_b16 a[150:151], v237 offset:36864
    v_mfma_f32_16x16x32_bf16 a[216:219], a[156:159], a[24:27], a[216:219]
    s_waitcnt lgkmcnt(8)
    v_mfma_f32_16x16x32_bf16 a[160:163], a[128:131], a[32:35], a[160:163]
    ds_read_b64_tr_b16 a[152:153], v238 offset:32768
    ds_read_b64_tr_b16 a[154:155], v238 offset:36864
    v_mfma_f32_16x16x32_bf16 a[164:167], a[128:131], a[36:39], a[164:167]
    buffer_load_dword a224, v40, s[80:83], s4 offen
    s_add_u32 s4, s4, 2097152
    v_mfma_f32_16x16x32_bf16 a[172:175], a[132:135], a[36:39], a[172:175]
    ds_read_b64_tr_b16 a[156:157], v239 offset:32768
    ds_read_b64_tr_b16 a[158:159], v239 offset:36864
    v_mfma_f32_16x16x32_bf16 a[168:171], a[132:135], a[32:35], a[168:171]
    buffer_load_dwordx4 a[4:7], v3, s[16:19], s59 offen offset:0 sc1
    s_waitcnt lgkmcnt(8)
    v_mfma_f32_16x16x32_bf16 a[176:179], a[136:139], a[32:35], a[176:179]
    s_add_u32 m0, s54, 8192
    ds_read_b64_tr_b16 a[128:129], v232 offset:40960
    ds_read_b64_tr_b16 a[130:131], v232 offset:45056
    v_mfma_f32_16x16x32_bf16 a[180:183], a[136:139], a[36:39], a[180:183]
    buffer_load_dwordx4 v4, s[80:83], s60 offen lds
    v_mfma_f32_16x16x32_bf16 a[188:191], a[140:143], a[36:39], a[188:191]
    s_add_u32 m0, s54, 9216
    ds_read_b64_tr_b16 a[132:133], v233 offset:40960
    ds_read_b64_tr_b16 a[134:135], v233 offset:45056
    v_mfma_f32_16x16x32_bf16 a[184:187], a[140:143], a[32:35], a[184:187]
    s_waitcnt lgkmcnt(8)
    v_mfma_f32_16x16x32_bf16 a[192:195], a[144:147], a[32:35], a[192:195]
    ds_read_b64_tr_b16 a[136:137], v234 offset:40960
    ds_read_b64_tr_b16 a[138:139], v234 offset:45056
    v_mfma_f32_16x16x32_bf16 a[196:199], a[144:147], a[36:39], a[196:199]
    buffer_load_dwordx4 v5, s[80:83], s60 offen lds
    s_add_u32 s60, s60, 65536
    v_mfma_f32_16x16x32_bf16 a[204:207], a[148:151], a[36:39], a[204:207]
    ds_read_b64_tr_b16 a[140:141], v235 offset:40960
    ds_read_b64_tr_b16 a[142:143], v235 offset:45056
    v_mfma_f32_16x16x32_bf16 a[200:203], a[148:151], a[32:35], a[200:203]
    s_waitcnt lgkmcnt(8)
    v_mfma_f32_16x16x32_bf16 a[208:211], a[152:155], a[32:35], a[208:211]
    ds_read_b64_tr_b16 a[144:145], v236 offset:40960
    ds_read_b64_tr_b16 a[146:147], v236 offset:45056
    v_mfma_f32_16x16x32_bf16 a[212:215], a[152:155], a[36:39], a[212:215]
    buffer_load_dwordx4 a[8:11], v2, s[16:19], s59 offen offset:1024 sc1
    v_mfma_f32_16x16x32_bf16 a[220:223], a[156:159], a[36:39], a[220:223]
    ds_read_b64_tr_b16 a[148:149], v237 offset:40960
    ds_read_b64_tr_b16 a[150:151], v237 offset:45056
    v_mfma_f32_16x16x32_bf16 a[216:219], a[156:159], a[32:35], a[216:219]
    s_waitcnt vmcnt(54)
    s_waitcnt lgkmcnt(8)
    v_mfma_f32_16x16x32_bf16 a[160:163], a[128:131], a[40:43], a[160:163]
    ds_read_b64_tr_b16 a[152:153], v238 offset:40960
    ds_read_b64_tr_b16 a[154:155], v238 offset:45056
    v_mfma_f32_16x16x32_bf16 a[164:167], a[128:131], a[44:47], a[164:167]
    buffer_load_dwordx4 a[12:15], v3, s[16:19], s59 offen offset:1024 sc1
    v_mfma_f32_16x16x32_bf16 a[172:175], a[132:135], a[44:47], a[172:175]
    s_add_u32 m0, s54, 16384
    ds_read_b64_tr_b16 a[156:157], v239 offset:40960
    ds_read_b64_tr_b16 a[158:159], v239 offset:45056
    v_mfma_f32_16x16x32_bf16 a[168:171], a[132:135], a[40:43], a[168:171]
    s_waitcnt vmcnt(47)
    s_barrier
    s_waitcnt lgkmcnt(8)
    v_mfma_f32_16x16x32_bf16 a[176:179], a[136:139], a[40:43], a[176:179]
    ds_read_b64_tr_b16 a[128:129], v232 offset:49152
    ds_read_b64_tr_b16 a[130:131], v232 offset:53248
    v_mfma_f32_16x16x32_bf16 a[180:183], a[136:139], a[44:47], a[180:183]
    buffer_load_dwordx4 v4, s[80:83], s60 offen lds
    v_mfma_f32_16x16x32_bf16 a[188:191], a[140:143], a[44:47], a[188:191]
    s_add_u32 m0, s54, 17408
    ds_read_b64_tr_b16 a[132:133], v233 offset:49152
    ds_read_b64_tr_b16 a[134:135], v233 offset:53248
    v_mfma_f32_16x16x32_bf16 a[184:187], a[140:143], a[40:43], a[184:187]
    s_waitcnt lgkmcnt(8)
    v_mfma_f32_16x16x32_bf16 a[192:195], a[144:147], a[40:43], a[192:195]
    ds_read_b64_tr_b16 a[136:137], v234 offset:49152
    ds_read_b64_tr_b16 a[138:139], v234 offset:53248
    v_mfma_f32_16x16x32_bf16 a[196:199], a[144:147], a[44:47], a[196:199]
    buffer_load_dwordx4 v5, s[80:83], s60 offen lds
    s_add_u32 s60, s60, 65536
    v_mfma_f32_16x16x32_bf16 a[204:207], a[148:151], a[44:47], a[204:207]
    ds_read_b64_tr_b16 a[140:141], v235 offset:49152
    ds_read_b64_tr_b16 a[142:143], v235 offset:53248
    v_mfma_f32_16x16x32_bf16 a[200:203], a[148:151], a[40:43], a[200:203]
    s_waitcnt lgkmcnt(8)
    v_mfma_f32_16x16x32_bf16 a[208:211], a[152:155], a[40:43], a[208:211]
    ds_read_b64_tr_b16 a[144:145], v236 offset:49152
    ds_read_b64_tr_b16 a[146:147], v236 offset:53248
    v_mfma_f32_16x16x32_bf16 a[212:215], a[152:155], a[44:47], a[212:215]
    buffer_load_dwordx4 a[16:19], v2, s[16:19], s59 offen offset:2048 sc1
    v_mfma_f32_16x16x32_bf16 a[220:223], a[156:159], a[44:47], a[220:223]
    ds_read_b64_tr_b16 a[148:149], v237 offset:49152
    ds_read_b64_tr_b16 a[150:151], v237 offset:53248
    v_mfma_f32_16x16x32_bf16 a[216:219], a[156:159], a[40:43], a[216:219]
    s_waitcnt lgkmcnt(8)
    v_mfma_f32_16x16x32_bf16 a[160:163], a[128:131], a[48:51], a[160:163]
    ds_read_b64_tr_b16 a[152:153], v238 offset:49152
    ds_read_b64_tr_b16 a[154:155], v238 offset:53248
    v_mfma_f32_16x16x32_bf16 a[164:167], a[128:131], a[52:55], a[164:167]
    buffer_load_dwordx4 a[20:23], v3, s[16:19], s59 offen offset:2048 sc1
    v_mfma_f32_16x16x32_bf16 a[172:175], a[132:135], a[52:55], a[172:175]
    s_add_u32 m0, s54, 24576
    ds_read_b64_tr_b16 a[156:157], v239 offset:49152
    ds_read_b64_tr_b16 a[158:159], v239 offset:53248
    v_mfma_f32_16x16x32_bf16 a[168:171], a[132:135], a[48:51], a[168:171]
    s_waitcnt lgkmcnt(8)
    v_mfma_f32_16x16x32_bf16 a[176:179], a[136:139], a[48:51], a[176:179]
    ds_read_b64_tr_b16 a[128:129], v232 offset:57344
    ds_read_b64_tr_b16 a[130:131], v232 offset:61440
    v_mfma_f32_16x16x32_bf16 a[180:183], a[136:139], a[52:55], a[180:183]
    buffer_load_dwordx4 v4, s[80:83], s60 offen lds
    v_mfma_f32_16x16x32_bf16 a[188:191], a[140:143], a[52:55], a[188:191]
    s_add_u32 m0, s54, 25600
    ds_read_b64_tr_b16 a[132:133], v233 offset:57344
    ds_read_b64_tr_b16 a[134:135], v233 offset:61440
    v_mfma_f32_16x16x32_bf16 a[184:187], a[140:143], a[48:51], a[184:187]
    s_waitcnt lgkmcnt(8)
    v_mfma_f32_16x16x32_bf16 a[192:195], a[144:147], a[48:51], a[192:195]
    ds_read_b64_tr_b16 a[136:137], v234 offset:57344
    ds_read_b64_tr_b16 a[138:139], v234 offset:61440
    v_mfma_f32_16x16x32_bf16 a[196:199], a[144:147], a[52:55], a[196:199]
    buffer_load_dwordx4 v5, s[80:83], s60 offen lds
    s_add_u32 s60, s60, 65536
    v_mfma_f32_16x16x32_bf16 a[204:207], a[148:151], a[52:55], a[204:207]
    ds_read_b64_tr_b16 a[140:141], v235 offset:57344
    ds_read_b64_tr_b16 a[142:143], v235 offset:61440
    v_mfma_f32_16x16x32_bf16 a[200:203], a[148:151], a[48:51], a[200:203]
    s_waitcnt lgkmcnt(8)
    v_mfma_f32_16x16x32_bf16 a[208:211], a[152:155], a[48:51], a[208:211]
    ds_read_b64_tr_b16 a[144:145], v236 offset:57344
    ds_read_b64_tr_b16 a[146:147], v236 offset:61440
    v_mfma_f32_16x16x32_bf16 a[212:215], a[152:155], a[52:55], a[212:215]
    buffer_load_dwordx4 a[24:27], v2, s[16:19], s59 offen offset:3072 sc1
    v_mfma_f32_16x16x32_bf16 a[220:223], a[156:159], a[52:55], a[220:223]
    ds_read_b64_tr_b16 a[148:149], v237 offset:57344
    ds_read_b64_tr_b16 a[150:151], v237 offset:61440
    v_mfma_f32_16x16x32_bf16 a[216:219], a[156:159], a[48:51], a[216:219]
    s_waitcnt vmcnt(52)
    s_waitcnt lgkmcnt(8)
    v_mfma_f32_16x16x32_bf16 a[160:163], a[128:131], a[56:59], a[160:163]
    ds_read_b64_tr_b16 a[152:153], v238 offset:57344
    ds_read_b64_tr_b16 a[154:155], v238 offset:61440
    v_mfma_f32_16x16x32_bf16 a[164:167], a[128:131], a[60:63], a[164:167]
    buffer_load_dwordx4 a[28:31], v3, s[16:19], s59 offen offset:3072 sc1
    s_add_u32 s59, s59, 4096
    v_mfma_f32_16x16x32_bf16 a[172:175], a[132:135], a[60:63], a[172:175]
    s_add_u32 m0, s54, 32768
    ds_read_b64_tr_b16 a[156:157], v239 offset:57344
    ds_read_b64_tr_b16 a[158:159], v239 offset:61440
    v_mfma_f32_16x16x32_bf16 a[168:171], a[132:135], a[56:59], a[168:171]
    buffer_load_dwordx4 v4, s[80:83], s60 offen lds
    s_waitcnt vmcnt(46)
    s_barrier
    s_waitcnt lgkmcnt(8)
    v_mfma_f32_16x16x32_bf16 a[176:179], a[136:139], a[56:59], a[176:179]
    s_add_u32 m0, s54, 33792
    ds_read_b64_tr_b16 a[128:129], v240 offset:0
    ds_read_b64_tr_b16 a[130:131], v240 offset:4096
    v_mfma_f32_16x16x32_bf16 a[180:183], a[136:139], a[60:63], a[180:183]
    buffer_load_dwordx4 v5, s[80:83], s60 offen lds
    s_add_u32 s60, s60, 65536
    v_mfma_f32_16x16x32_bf16 a[188:191], a[140:143], a[60:63], a[188:191]
    ds_read_b64_tr_b16 a[132:133], v241 offset:0
    ds_read_b64_tr_b16 a[134:135], v241 offset:4096
    v_mfma_f32_16x16x32_bf16 a[184:187], a[140:143], a[56:59], a[184:187]
    s_waitcnt lgkmcnt(8)
    v_mfma_f32_16x16x32_bf16 a[192:195], a[144:147], a[56:59], a[192:195]
    ds_read_b64_tr_b16 a[136:137], v242 offset:0
    ds_read_b64_tr_b16 a[138:139], v242 offset:4096
    v_mfma_f32_16x16x32_bf16 a[196:199], a[144:147], a[60:63], a[196:199]
    buffer_load_dwordx4 a[32:35], v2, s[16:19], s59 offen offset:0 sc1
    v_mfma_f32_16x16x32_bf16 a[204:207], a[148:151], a[60:63], a[204:207]
    ds_read_b64_tr_b16 a[140:141], v243 offset:0
    ds_read_b64_tr_b16 a[142:143], v243 offset:4096
    v_mfma_f32_16x16x32_bf16 a[200:203], a[148:151], a[56:59], a[200:203]
    s_waitcnt lgkmcnt(8)
    v_mfma_f32_16x16x32_bf16 a[208:211], a[152:155], a[56:59], a[208:211]
    ds_read_b64_tr_b16 a[144:145], v244 offset:0
    ds_read_b64_tr_b16 a[146:147], v244 offset:4096
    v_mfma_f32_16x16x32_bf16 a[212:215], a[152:155], a[60:63], a[212:215]
    buffer_load_dwordx4 a[36:39], v3, s[16:19], s59 offen offset:0 sc1
    v_mfma_f32_16x16x32_bf16 a[220:223], a[156:159], a[60:63], a[220:223]
    ds_read_b64_tr_b16 a[148:149], v245 offset:0
    ds_read_b64_tr_b16 a[150:151], v245 offset:4096
    v_mfma_f32_16x16x32_bf16 a[216:219], a[156:159], a[56:59], a[216:219]
    s_waitcnt lgkmcnt(8)
    v_mfma_f32_16x16x32_bf16 a[160:163], a[128:131], a[64:67], a[160:163]
    ds_read_b64_tr_b16 a[152:153], v246 offset:0
    ds_read_b64_tr_b16 a[154:155], v246 offset:4096
    v_mfma_f32_16x16x32_bf16 a[164:167], a[128:131], a[68:71], a[164:167]
    global_load_dword a224, v248, s[92:93]
    v_mfma_f32_16x16x32_bf16 a[172:175], a[132:135], a[68:71], a[172:175]
    s_add_u32 m0, s54, 40960
    ds_read_b64_tr_b16 a[156:157], v247 offset:0
    ds_read_b64_tr_b16 a[158:159], v247 offset:4096
    v_mfma_f32_16x16x32_bf16 a[168:171], a[132:135], a[64:67], a[168:171]
    buffer_load_dwordx4 v4, s[80:83], s60 offen lds
    s_waitcnt lgkmcnt(8)
    v_mfma_f32_16x16x32_bf16 a[176:179], a[136:139], a[64:67], a[176:179]
    s_add_u32 m0, s54, 41984
    ds_read_b64_tr_b16 a[128:129], v240 offset:8192
    ds_read_b64_tr_b16 a[130:131], v240 offset:12288
    v_mfma_f32_16x16x32_bf16 a[180:183], a[136:139], a[68:71], a[180:183]
    buffer_load_dwordx4 v5, s[80:83], s60 offen lds
    s_add_u32 s60, s60, 65536
    v_mfma_f32_16x16x32_bf16 a[188:191], a[140:143], a[68:71], a[188:191]
    ds_read_b64_tr_b16 a[132:133], v241 offset:8192
    ds_read_b64_tr_b16 a[134:135], v241 offset:12288
    v_mfma_f32_16x16x32_bf16 a[184:187], a[140:143], a[64:67], a[184:187]
    s_waitcnt lgkmcnt(8)
    v_mfma_f32_16x16x32_bf16 a[192:195], a[144:147], a[64:67], a[192:195]
    ds_read_b64_tr_b16 a[136:137], v242 offset:8192
    ds_read_b64_tr_b16 a[138:139], v242 offset:12288
    v_mfma_f32_16x16x32_bf16 a[196:199], a[144:147], a[68:71], a[196:199]
    buffer_load_dwordx4 a[40:43], v2, s[16:19], s59 offen offset:1024 sc1
    v_mfma_f32_16x16x32_bf16 a[204:207], a[148:151], a[68:71], a[204:207]
    ds_read_b64_tr_b16 a[140:141], v243 offset:8192
    ds_read_b64_tr_b16 a[142:143], v243 offset:12288
    v_mfma_f32_16x16x32_bf16 a[200:203], a[148:151], a[64:67], a[200:203]
    s_waitcnt lgkmcnt(8)
    v_mfma_f32_16x16x32_bf16 a[208:211], a[152:155], a[64:67], a[208:211]
    ds_read_b64_tr_b16 a[144:145], v244 offset:8192
    ds_read_b64_tr_b16 a[146:147], v244 offset:12288
    v_mfma_f32_16x16x32_bf16 a[212:215], a[152:155], a[68:71], a[212:215]
    buffer_load_dwordx4 a[44:47], v3, s[16:19], s59 offen offset:1024 sc1
    v_mfma_f32_16x16x32_bf16 a[220:223], a[156:159], a[68:71], a[220:223]
    ds_read_b64_tr_b16 a[148:149], v245 offset:8192
    ds_read_b64_tr_b16 a[150:151], v245 offset:12288
    v_mfma_f32_16x16x32_bf16 a[216:219], a[156:159], a[64:67], a[216:219]
    s_waitcnt vmcnt(52)
    s_waitcnt lgkmcnt(8)
    v_mfma_f32_16x16x32_bf16 a[160:163], a[128:131], a[72:75], a[160:163]
    s_add_u32 m0, s54, 49152
    ds_read_b64_tr_b16 a[152:153], v246 offset:8192
    ds_read_b64_tr_b16 a[154:155], v246 offset:12288
    v_mfma_f32_16x16x32_bf16 a[164:167], a[128:131], a[76:79], a[164:167]
    buffer_load_dwordx4 v4, s[80:83], s60 offen lds
    v_mfma_f32_16x16x32_bf16 a[172:175], a[132:135], a[76:79], a[172:175]
    s_add_u32 m0, s54, 50176
    ds_read_b64_tr_b16 a[156:157], v247 offset:8192
    ds_read_b64_tr_b16 a[158:159], v247 offset:12288
    v_mfma_f32_16x16x32_bf16 a[168:171], a[132:135], a[72:75], a[168:171]
    s_waitcnt vmcnt(47)
    s_barrier
    s_waitcnt lgkmcnt(8)
    v_mfma_f32_16x16x32_bf16 a[176:179], a[136:139], a[72:75], a[176:179]
    ds_read_b64_tr_b16 a[128:129], v240 offset:16384
    ds_read_b64_tr_b16 a[130:131], v240 offset:20480
    v_mfma_f32_16x16x32_bf16 a[180:183], a[136:139], a[76:79], a[180:183]
    buffer_load_dwordx4 v5, s[80:83], s60 offen lds
    s_add_u32 s60, s60, 65536
    v_mfma_f32_16x16x32_bf16 a[188:191], a[140:143], a[76:79], a[188:191]
    ds_read_b64_tr_b16 a[132:133], v241 offset:16384
    ds_read_b64_tr_b16 a[134:135], v241 offset:20480
    v_mfma_f32_16x16x32_bf16 a[184:187], a[140:143], a[72:75], a[184:187]
    s_waitcnt lgkmcnt(8)
    v_mfma_f32_16x16x32_bf16 a[192:195], a[144:147], a[72:75], a[192:195]
    ds_read_b64_tr_b16 a[136:137], v242 offset:16384
    ds_read_b64_tr_b16 a[138:139], v242 offset:20480
    v_mfma_f32_16x16x32_bf16 a[196:199], a[144:147], a[76:79], a[196:199]
    buffer_load_dwordx2 a[48:49], v10, s[16:19], s59 offen offset:2048 sc1
    v_mfma_f32_16x16x32_bf16 a[204:207], a[148:151], a[76:79], a[204:207]
    ds_read_b64_tr_b16 a[140:141], v243 offset:16384
    ds_read_b64_tr_b16 a[142:143], v243 offset:20480
    v_mfma_f32_16x16x32_bf16 a[200:203], a[148:151], a[72:75], a[200:203]
    s_waitcnt lgkmcnt(8)
    v_mfma_f32_16x16x32_bf16 a[208:211], a[152:155], a[72:75], a[208:211]
    ds_read_b64_tr_b16 a[144:145], v244 offset:16384
    ds_read_b64_tr_b16 a[146:147], v244 offset:20480
    v_mfma_f32_16x16x32_bf16 a[212:215], a[152:155], a[76:79], a[212:215]
    buffer_load_dwordx2 a[50:51], v10, s[16:19], s59 offen offset:2560 sc1
    v_mfma_f32_16x16x32_bf16 a[220:223], a[156:159], a[76:79], a[220:223]
    ds_read_b64_tr_b16 a[148:149], v245 offset:16384
    ds_read_b64_tr_b16 a[150:151], v245 offset:20480
    v_mfma_f32_16x16x32_bf16 a[216:219], a[156:159], a[72:75], a[216:219]
    s_waitcnt lgkmcnt(8)
    v_mfma_f32_16x16x32_bf16 a[160:163], a[128:131], a[80:83], a[160:163]
    ds_read_b64_tr_b16 a[152:153], v246 offset:16384
    ds_read_b64_tr_b16 a[154:155], v246 offset:20480
    v_mfma_f32_16x16x32_bf16 a[164:167], a[128:131], a[84:87], a[164:167]
    buffer_load_dwordx2 a[52:53], v11, s[16:19], s59 offen offset:2048 sc1
    v_mfma_f32_16x16x32_bf16 a[172:175], a[132:135], a[84:87], a[172:175]
    ds_read_b64_tr_b16 a[156:157], v247 offset:16384
    ds_read_b64_tr_b16 a[158:159], v247 offset:20480
    v_mfma_f32_16x16x32_bf16 a[168:171], a[132:135], a[80:83], a[168:171]
    buffer_load_dwordx2 a[54:55], v11, s[16:19], s59 offen offset:2560 sc1
    s_waitcnt lgkmcnt(8)
    v_mfma_f32_16x16x32_bf16 a[176:179], a[136:139], a[80:83], a[176:179]
    s_add_u32 m0, s54, 57344
    ds_read_b64_tr_b16 a[128:129], v240 offset:24576
    ds_read_b64_tr_b16 a[130:131], v240 offset:28672
    v_mfma_f32_16x16x32_bf16 a[180:183], a[136:139], a[84:87], a[180:183]
    buffer_load_dwordx4 v4, s[80:83], s60 offen lds
    v_mfma_f32_16x16x32_bf16 a[188:191], a[140:143], a[84:87], a[188:191]
    s_add_u32 m0, s54, 58368
    ds_read_b64_tr_b16 a[132:133], v241 offset:24576
    ds_read_b64_tr_b16 a[134:135], v241 offset:28672
    v_mfma_f32_16x16x32_bf16 a[184:187], a[140:143], a[80:83], a[184:187]
    s_waitcnt lgkmcnt(8)
    v_mfma_f32_16x16x32_bf16 a[192:195], a[144:147], a[80:83], a[192:195]
    ds_read_b64_tr_b16 a[136:137], v242 offset:24576
    ds_read_b64_tr_b16 a[138:139], v242 offset:28672
    v_mfma_f32_16x16x32_bf16 a[196:199], a[144:147], a[84:87], a[196:199]
    buffer_load_dwordx4 v5, s[80:83], s60 offen lds
    s_add_u32 s60, s60, 65536
    v_mfma_f32_16x16x32_bf16 a[204:207], a[148:151], a[84:87], a[204:207]
    ds_read_b64_tr_b16 a[140:141], v243 offset:24576
    ds_read_b64_tr_b16 a[142:143], v243 offset:28672
    v_mfma_f32_16x16x32_bf16 a[200:203], a[148:151], a[80:83], a[200:203]
    s_waitcnt lgkmcnt(8)
    v_mfma_f32_16x16x32_bf16 a[208:211], a[152:155], a[80:83], a[208:211]
    ds_read_b64_tr_b16 a[144:145], v244 offset:24576
    ds_read_b64_tr_b16 a[146:147], v244 offset:28672
    v_mfma_f32_16x16x32_bf16 a[212:215], a[152:155], a[84:87], a[212:215]
    buffer_load_dwordx4 a[56:59], v2, s[16:19], s59 offen offset:3072 sc1
    v_mfma_f32_16x16x32_bf16 a[220:223], a[156:159], a[84:87], a[220:223]
    ds_read_b64_tr_b16 a[148:149], v245 offset:24576
    ds_read_b64_tr_b16 a[150:151], v245 offset:28672
    v_mfma_f32_16x16x32_bf16 a[216:219], a[156:159], a[80:83], a[216:219]
    s_waitcnt vmcnt(53)
    s_waitcnt lgkmcnt(8)
    v_mfma_f32_16x16x32_bf16 a[160:163], a[128:131], a[88:91], a[160:163]
    ds_read_b64_tr_b16 a[152:153], v246 offset:24576
    ds_read_b64_tr_b16 a[154:155], v246 offset:28672
    v_mfma_f32_16x16x32_bf16 a[164:167], a[128:131], a[92:95], a[164:167]
    buffer_load_dwordx4 a[60:63], v3, s[16:19], s59 offen offset:3072 sc1
    s_add_u32 s59, s59, 4096
    v_mfma_f32_16x16x32_bf16 a[172:175], a[132:135], a[92:95], a[172:175]
    s_add_u32 m0, s54, 65536
    ds_read_b64_tr_b16 a[156:157], v247 offset:24576
    ds_read_b64_tr_b16 a[158:159], v247 offset:28672
    v_mfma_f32_16x16x32_bf16 a[168:171], a[132:135], a[88:91], a[168:171]
    s_waitcnt vmcnt(48)
    s_barrier
    s_waitcnt lgkmcnt(8)
    v_mfma_f32_16x16x32_bf16 a[176:179], a[136:139], a[88:91], a[176:179]
    ds_read_b64_tr_b16 a[128:129], v240 offset:32768
    ds_read_b64_tr_b16 a[130:131], v240 offset:36864
    v_mfma_f32_16x16x32_bf16 a[180:183], a[136:139], a[92:95], a[180:183]
    buffer_load_dwordx4 v4, s[80:83], s60 offen lds
    v_mfma_f32_16x16x32_bf16 a[188:191], a[140:143], a[92:95], a[188:191]
    s_add_u32 m0, s54, 66560
    ds_read_b64_tr_b16 a[132:133], v241 offset:32768
    ds_read_b64_tr_b16 a[134:135], v241 offset:36864
    v_mfma_f32_16x16x32_bf16 a[184:187], a[140:143], a[88:91], a[184:187]
    s_waitcnt lgkmcnt(8)
    v_mfma_f32_16x16x32_bf16 a[192:195], a[144:147], a[88:91], a[192:195]
    ds_read_b64_tr_b16 a[136:137], v242 offset:32768
    ds_read_b64_tr_b16 a[138:139], v242 offset:36864
    v_mfma_f32_16x16x32_bf16 a[196:199], a[144:147], a[92:95], a[196:199]
    buffer_load_dwordx4 v5, s[80:83], s60 offen lds
    s_add_u32 s60, s60, 65536
    v_mfma_f32_16x16x32_bf16 a[204:207], a[148:151], a[92:95], a[204:207]
    ds_read_b64_tr_b16 a[140:141], v243 offset:32768
    ds_read_b64_tr_b16 a[142:143], v243 offset:36864
    v_mfma_f32_16x16x32_bf16 a[200:203], a[148:151], a[88:91], a[200:203]
    s_waitcnt lgkmcnt(8)
    v_mfma_f32_16x16x32_bf16 a[208:211], a[152:155], a[88:91], a[208:211]
    ds_read_b64_tr_b16 a[144:145], v244 offset:32768
    ds_read_b64_tr_b16 a[146:147], v244 offset:36864
    v_mfma_f32_16x16x32_bf16 a[212:215], a[152:155], a[92:95], a[212:215]
    buffer_load_dwordx4 a[64:67], v2, s[16:19], s59 offen offset:0 sc1
    v_mfma_f32_16x16x32_bf16 a[220:223], a[156:159], a[92:95], a[220:223]
    ds_read_b64_tr_b16 a[148:149], v245 offset:32768
    ds_read_b64_tr_b16 a[150:151], v245 offset:36864
    v_mfma_f32_16x16x32_bf16 a[216:219], a[156:159], a[88:91], a[216:219]
    s_waitcnt lgkmcnt(8)
    v_mfma_f32_16x16x32_bf16 a[160:163], a[128:131], a[96:99], a[160:163]
    ds_read_b64_tr_b16 a[152:153], v246 offset:32768
    ds_read_b64_tr_b16 a[154:155], v246 offset:36864
    v_mfma_f32_16x16x32_bf16 a[164:167], a[128:131], a[100:103], a[164:167]
    buffer_load_dwordx4 a[68:71], v3, s[16:19], s59 offen offset:0 sc1
    v_mfma_f32_16x16x32_bf16 a[172:175], a[132:135], a[100:103], a[172:175]
    s_add_u32 m0, s54, 73728
    ds_read_b64_tr_b16 a[156:157], v247 offset:32768
    ds_read_b64_tr_b16 a[158:159], v247 offset:36864
    v_mfma_f32_16x16x32_bf16 a[168:171], a[132:135], a[96:99], a[168:171]
    s_waitcnt lgkmcnt(8)
    v_mfma_f32_16x16x32_bf16 a[176:179], a[136:139], a[96:99], a[176:179]
    ds_read_b64_tr_b16 a[128:129], v240 offset:40960
    ds_read_b64_tr_b16 a[130:131], v240 offset:45056
    v_mfma_f32_16x16x32_bf16 a[180:183], a[136:139], a[100:103], a[180:183]
    buffer_load_dwordx4 v4, s[80:83], s60 offen lds
    v_mfma_f32_16x16x32_bf16 a[188:191], a[140:143], a[100:103], a[188:191]
    s_add_u32 m0, s54, 74752
    ds_read_b64_tr_b16 a[132:133], v241 offset:40960
    ds_read_b64_tr_b16 a[134:135], v241 offset:45056
    v_mfma_f32_16x16x32_bf16 a[184:187], a[140:143], a[96:99], a[184:187]
    s_waitcnt lgkmcnt(8)
    v_mfma_f32_16x16x32_bf16 a[192:195], a[144:147], a[96:99], a[192:195]
    ds_read_b64_tr_b16 a[136:137], v242 offset:40960
    ds_read_b64_tr_b16 a[138:139], v242 offset:45056
    v_mfma_f32_16x16x32_bf16 a[196:199], a[144:147], a[100:103], a[196:199]
    buffer_load_dwordx4 v5, s[80:83], s60 offen lds
    s_add_u32 s60, s60, 65536
    v_mfma_f32_16x16x32_bf16 a[204:207], a[148:151], a[100:103], a[204:207]
    ds_read_b64_tr_b16 a[140:141], v243 offset:40960
    ds_read_b64_tr_b16 a[142:143], v243 offset:45056
    v_mfma_f32_16x16x32_bf16 a[200:203], a[148:151], a[96:99], a[200:203]
    s_waitcnt lgkmcnt(8)
    v_mfma_f32_16x16x32_bf16 a[208:211], a[152:155], a[96:99], a[208:211]
    ds_read_b64_tr_b16 a[144:145], v244 offset:40960
    ds_read_b64_tr_b16 a[146:147], v244 offset:45056
    v_mfma_f32_16x16x32_bf16 a[212:215], a[152:155], a[100:103], a[212:215]
    buffer_load_dwordx4 a[72:75], v2, s[16:19], s59 offen offset:1024 sc1
    v_mfma_f32_16x16x32_bf16 a[220:223], a[156:159], a[100:103], a[220:223]
    ds_read_b64_tr_b16 a[148:149], v245 offset:40960
    ds_read_b64_tr_b16 a[150:151], v245 offset:45056
    v_mfma_f32_16x16x32_bf16 a[216:219], a[156:159], a[96:99], a[216:219]
    s_waitcnt vmcnt(53)
    s_waitcnt lgkmcnt(8)
    v_mfma_f32_16x16x32_bf16 a[160:163], a[128:131], a[104:107], a[160:163]
    ds_read_b64_tr_b16 a[152:153], v246 offset:40960
    ds_read_b64_tr_b16 a[154:155], v246 offset:45056
    v_mfma_f32_16x16x32_bf16 a[164:167], a[128:131], a[108:111], a[164:167]
    buffer_load_dwordx4 a[76:79], v3, s[16:19], s59 offen offset:1024 sc1
    v_mfma_f32_16x16x32_bf16 a[172:175], a[132:135], a[108:111], a[172:175]
    s_add_u32 m0, s54, 81920
    ds_read_b64_tr_b16 a[156:157], v247 offset:40960
    ds_read_b64_tr_b16 a[158:159], v247 offset:45056
    v_mfma_f32_16x16x32_bf16 a[168:171], a[132:135], a[104:107], a[168:171]
    buffer_load_dwordx4 v4, s[80:83], s60 offen lds
    s_waitcnt vmcnt(49)
    s_barrier
    s_waitcnt lgkmcnt(8)
    v_mfma_f32_16x16x32_bf16 a[176:179], a[136:139], a[104:107], a[176:179]
    s_add_u32 m0, s54, 82944
    ds_read_b64_tr_b16 a[128:129], v240 offset:49152
    ds_read_b64_tr_b16 a[130:131], v240 offset:53248
    v_mfma_f32_16x16x32_bf16 a[180:183], a[136:139], a[108:111], a[180:183]
    buffer_load_dwordx4 v5, s[80:83], s60 offen lds
    s_add_u32 s60, s60, 65536
    v_mfma_f32_16x16x32_bf16 a[188:191], a[140:143], a[108:111], a[188:191]
    ds_read_b64_tr_b16 a[132:133], v241 offset:49152
    ds_read_b64_tr_b16 a[134:135], v241 offset:53248
    v_mfma_f32_16x16x32_bf16 a[184:187], a[140:143], a[104:107], a[184:187]
    s_waitcnt lgkmcnt(8)
    v_mfma_f32_16x16x32_bf16 a[192:195], a[144:147], a[104:107], a[192:195]
    ds_read_b64_tr_b16 a[136:137], v242 offset:49152
    ds_read_b64_tr_b16 a[138:139], v242 offset:53248
    v_mfma_f32_16x16x32_bf16 a[196:199], a[144:147], a[108:111], a[196:199]
    buffer_load_dwordx4 a[80:83], v2, s[16:19], s59 offen offset:2048 sc1
    v_mfma_f32_16x16x32_bf16 a[204:207], a[148:151], a[108:111], a[204:207]
    ds_read_b64_tr_b16 a[140:141], v243 offset:49152
    ds_read_b64_tr_b16 a[142:143], v243 offset:53248
    v_mfma_f32_16x16x32_bf16 a[200:203], a[148:151], a[104:107], a[200:203]
    s_waitcnt lgkmcnt(8)
    v_mfma_f32_16x16x32_bf16 a[208:211], a[152:155], a[104:107], a[208:211]
    ds_read_b64_tr_b16 a[144:145], v244 offset:49152
    ds_read_b64_tr_b16 a[146:147], v244 offset:53248
    v_mfma_f32_16x16x32_bf16 a[212:215], a[152:155], a[108:111], a[212:215]
    buffer_load_dwordx4 a[84:87], v3, s[16:19], s59 offen offset:2048 sc1
    v_mfma_f32_16x16x32_bf16 a[220:223], a[156:159], a[108:111], a[220:223]
    ds_read_b64_tr_b16 a[148:149], v245 offset:49152
    ds_read_b64_tr_b16 a[150:151], v245 offset:53248
    v_mfma_f32_16x16x32_bf16 a[216:219], a[156:159], a[104:107], a[216:219]
    s_waitcnt lgkmcnt(8)
    v_mfma_f32_16x16x32_bf16 a[160:163], a[128:131], a[112:115], a[160:163]
    s_add_u32 m0, s54, 90112
    ds_read_b64_tr_b16 a[152:153], v246 offset:49152
    ds_read_b64_tr_b16 a[154:155], v246 offset:53248
    v_mfma_f32_16x16x32_bf16 a[164:167], a[128:131], a[116:119], a[164:167]
    buffer_load_dwordx4 v4, s[80:83], s60 offen lds
    v_mfma_f32_16x16x32_bf16 a[172:175], a[132:135], a[116:119], a[172:175]
    s_add_u32 m0, s54, 91136
    ds_read_b64_tr_b16 a[156:157], v247 offset:49152
    ds_read_b64_tr_b16 a[158:159], v247 offset:53248
    v_mfma_f32_16x16x32_bf16 a[168:171], a[132:135], a[112:115], a[168:171]
    s_waitcnt lgkmcnt(8)
    v_mfma_f32_16x16x32_bf16 a[176:179], a[136:139], a[112:115], a[176:179]
    ds_read_b64_tr_b16 a[128:129], v240 offset:57344
    ds_read_b64_tr_b16 a[130:131], v240 offset:61440
    v_mfma_f32_16x16x32_bf16 a[180:183], a[136:139], a[116:119], a[180:183]
    buffer_load_dwordx4 v5, s[80:83], s60 offen lds
    s_add_u32 s60, s60, 65536
    v_mfma_f32_16x16x32_bf16 a[188:191], a[140:143], a[116:119], a[188:191]
    ds_read_b64_tr_b16 a[132:133], v241 offset:57344
    ds_read_b64_tr_b16 a[134:135], v241 offset:61440
    v_mfma_f32_16x16x32_bf16 a[184:187], a[140:143], a[112:115], a[184:187]
    s_waitcnt lgkmcnt(8)
    v_mfma_f32_16x16x32_bf16 a[192:195], a[144:147], a[112:115], a[192:195]
    ds_read_b64_tr_b16 a[136:137], v242 offset:57344
    ds_read_b64_tr_b16 a[138:139], v242 offset:61440
    v_mfma_f32_16x16x32_bf16 a[196:199], a[144:147], a[116:119], a[196:199]
    buffer_load_dwordx4 a[88:91], v2, s[16:19], s59 offen offset:3072 sc1
    v_mfma_f32_16x16x32_bf16 a[204:207], a[148:151], a[116:119], a[204:207]
    ds_read_b64_tr_b16 a[140:141], v243 offset:57344
    ds_read_b64_tr_b16 a[142:143], v243 offset:61440
    v_mfma_f32_16x16x32_bf16 a[200:203], a[148:151], a[112:115], a[200:203]
    s_waitcnt lgkmcnt(8)
    v_mfma_f32_16x16x32_bf16 a[208:211], a[152:155], a[112:115], a[208:211]
    ds_read_b64_tr_b16 a[144:145], v244 offset:57344
    ds_read_b64_tr_b16 a[146:147], v244 offset:61440
    v_mfma_f32_16x16x32_bf16 a[212:215], a[152:155], a[116:119], a[212:215]
    buffer_load_dwordx4 a[92:95], v3, s[16:19], s59 offen offset:3072 sc1
    s_add_u32 s59, s59, 4096
    v_mfma_f32_16x16x32_bf16 a[220:223], a[156:159], a[116:119], a[220:223]
    ds_read_b64_tr_b16 a[148:149], v245 offset:57344
    ds_read_b64_tr_b16 a[150:151], v245 offset:61440
    v_mfma_f32_16x16x32_bf16 a[216:219], a[156:159], a[112:115], a[216:219]
    s_waitcnt vmcnt(52)
    s_waitcnt lgkmcnt(8)
    v_mfma_f32_16x16x32_bf16 a[160:163], a[128:131], a[120:123], a[160:163]
    s_add_u32 m0, s54, 98304
    ds_read_b64_tr_b16 a[152:153], v246 offset:57344
    ds_read_b64_tr_b16 a[154:155], v246 offset:61440
    v_mfma_f32_16x16x32_bf16 a[164:167], a[128:131], a[124:127], a[164:167]
    buffer_load_dwordx4 v4, s[80:83], s60 offen lds
    v_mfma_f32_16x16x32_bf16 a[172:175], a[132:135], a[124:127], a[172:175]
    s_add_u32 m0, s54, 99328
    ds_read_b64_tr_b16 a[156:157], v247 offset:57344
    ds_read_b64_tr_b16 a[158:159], v247 offset:61440
    v_mfma_f32_16x16x32_bf16 a[168:171], a[132:135], a[120:123], a[168:171]
    s_waitcnt vmcnt(46)
    s_barrier
    s_waitcnt lgkmcnt(8)
    v_mfma_f32_16x16x32_bf16 a[176:179], a[136:139], a[120:123], a[176:179]
    ds_read_b64_tr_b16 a[128:129], v232 offset:0
    ds_read_b64_tr_b16 a[130:131], v232 offset:4096
    v_mfma_f32_16x16x32_bf16 a[180:183], a[136:139], a[124:127], a[180:183]
    buffer_load_dwordx4 v5, s[80:83], s60 offen lds
    s_add_u32 s60, s60, 65536
    v_mfma_f32_16x16x32_bf16 a[188:191], a[140:143], a[124:127], a[188:191]
    ds_read_b64_tr_b16 a[132:133], v233 offset:0
    ds_read_b64_tr_b16 a[134:135], v233 offset:4096
    v_mfma_f32_16x16x32_bf16 a[184:187], a[140:143], a[120:123], a[184:187]
    s_waitcnt lgkmcnt(8)
    v_mfma_f32_16x16x32_bf16 a[192:195], a[144:147], a[120:123], a[192:195]
    ds_read_b64_tr_b16 a[136:137], v234 offset:0
    ds_read_b64_tr_b16 a[138:139], v234 offset:4096
    v_mfma_f32_16x16x32_bf16 a[196:199], a[144:147], a[124:127], a[196:199]
    buffer_load_dwordx4 a[96:99], v2, s[16:19], s59 offen offset:0 sc1
    v_mfma_f32_16x16x32_bf16 a[204:207], a[148:151], a[124:127], a[204:207]
    ds_read_b64_tr_b16 a[140:141], v235 offset:0
    ds_read_b64_tr_b16 a[142:143], v235 offset:4096
    v_mfma_f32_16x16x32_bf16 a[200:203], a[148:151], a[120:123], a[200:203]
    s_waitcnt lgkmcnt(8)
    v_mfma_f32_16x16x32_bf16 a[208:211], a[152:155], a[120:123], a[208:211]
    ds_read_b64_tr_b16 a[144:145], v236 offset:0
    ds_read_b64_tr_b16 a[146:147], v236 offset:4096
    v_mfma_f32_16x16x32_bf16 a[212:215], a[152:155], a[124:127], a[212:215]
    buffer_load_dwordx4 a[100:103], v3, s[16:19], s59 offen offset:0 sc1
    v_mfma_f32_16x16x32_bf16 a[220:223], a[156:159], a[124:127], a[220:223]
    ds_read_b64_tr_b16 a[148:149], v237 offset:0
    ds_read_b64_tr_b16 a[150:151], v237 offset:4096
    v_mfma_f32_16x16x32_bf16 a[216:219], a[156:159], a[120:123], a[216:219]
    s_waitcnt lgkmcnt(8)
    v_mfma_f32_16x16x32_bf16 a[160:163], a[128:131], a[0:3], a[160:163]
    ds_read_b64_tr_b16 a[152:153], v238 offset:0
    ds_read_b64_tr_b16 a[154:155], v238 offset:4096
    v_mfma_f32_16x16x32_bf16 a[164:167], a[128:131], a[4:7], a[164:167]
    buffer_load_dword a224, v40, s[84:87], s5 offen
    s_add_u32 s5, s5, 2097152
    v_mfma_f32_16x16x32_bf16 a[172:175], a[132:135], a[4:7], a[172:175]
    s_add_u32 m0, s54, 106496
    ds_read_b64_tr_b16 a[156:157], v239 offset:0
    ds_read_b64_tr_b16 a[158:159], v239 offset:4096
    v_mfma_f32_16x16x32_bf16 a[168:171], a[132:135], a[0:3], a[168:171]
    buffer_load_dwordx4 v4, s[80:83], s60 offen lds
    s_waitcnt lgkmcnt(8)
    v_mfma_f32_16x16x32_bf16 a[176:179], a[136:139], a[0:3], a[176:179]
    s_add_u32 m0, s54, 107520
    ds_read_b64_tr_b16 a[128:129], v232 offset:8192
    ds_read_b64_tr_b16 a[130:131], v232 offset:12288
    v_mfma_f32_16x16x32_bf16 a[180:183], a[136:139], a[4:7], a[180:183]
    buffer_load_dwordx4 v5, s[80:83], s60 offen lds
    s_add_u32 s60, s60, 65536
    v_mfma_f32_16x16x32_bf16 a[188:191], a[140:143], a[4:7], a[188:191]
    ds_read_b64_tr_b16 a[132:133], v233 offset:8192
    ds_read_b64_tr_b16 a[134:135], v233 offset:12288
    v_mfma_f32_16x16x32_bf16 a[184:187], a[140:143], a[0:3], a[184:187]
    s_waitcnt lgkmcnt(8)
    v_mfma_f32_16x16x32_bf16 a[192:195], a[144:147], a[0:3], a[192:195]
    ds_read_b64_tr_b16 a[136:137], v234 offset:8192
    ds_read_b64_tr_b16 a[138:139], v234 offset:12288
    v_mfma_f32_16x16x32_bf16 a[196:199], a[144:147], a[4:7], a[196:199]
    buffer_load_dwordx2 a[104:105], v10, s[16:19], s59 offen offset:1024 sc1
    v_mfma_f32_16x16x32_bf16 a[204:207], a[148:151], a[4:7], a[204:207]
    ds_read_b64_tr_b16 a[140:141], v235 offset:8192
    ds_read_b64_tr_b16 a[142:143], v235 offset:12288
    v_mfma_f32_16x16x32_bf16 a[200:203], a[148:151], a[0:3], a[200:203]
    s_waitcnt lgkmcnt(8)
    v_mfma_f32_16x16x32_bf16 a[208:211], a[152:155], a[0:3], a[208:211]
    ds_read_b64_tr_b16 a[144:145], v236 offset:8192
    ds_read_b64_tr_b16 a[146:147], v236 offset:12288
    v_mfma_f32_16x16x32_bf16 a[212:215], a[152:155], a[4:7], a[212:215]
    buffer_load_dwordx2 a[106:107], v10, s[16:19], s59 offen offset:1536 sc1
    v_mfma_f32_16x16x32_bf16 a[220:223], a[156:159], a[4:7], a[220:223]
    ds_read_b64_tr_b16 a[148:149], v237 offset:8192
    ds_read_b64_tr_b16 a[150:151], v237 offset:12288
    v_mfma_f32_16x16x32_bf16 a[216:219], a[156:159], a[0:3], a[216:219]
    s_waitcnt vmcnt(52)
    s_waitcnt lgkmcnt(8)
    v_mfma_f32_16x16x32_bf16 a[160:163], a[128:131], a[8:11], a[160:163]
    ds_read_b64_tr_b16 a[152:153], v238 offset:8192
    ds_read_b64_tr_b16 a[154:155], v238 offset:12288
    v_mfma_f32_16x16x32_bf16 a[164:167], a[128:131], a[12:15], a[164:167]
    buffer_load_dwordx2 a[108:109], v11, s[16:19], s59 offen offset:1024 sc1
    v_mfma_f32_16x16x32_bf16 a[172:175], a[132:135], a[12:15], a[172:175]
    ds_read_b64_tr_b16 a[156:157], v239 offset:8192
    ds_read_b64_tr_b16 a[158:159], v239 offset:12288
    v_mfma_f32_16x16x32_bf16 a[168:171], a[132:135], a[8:11], a[168:171]
    buffer_load_dwordx2 a[110:111], v11, s[16:19], s59 offen offset:1536 sc1
    s_waitcnt vmcnt(48)
    s_barrier
    s_waitcnt lgkmcnt(8)
    v_mfma_f32_16x16x32_bf16 a[176:179], a[136:139], a[8:11], a[176:179]
    s_add_u32 m0, s54, 114688
    ds_read_b64_tr_b16 a[128:129], v232 offset:16384
    ds_read_b64_tr_b16 a[130:131], v232 offset:20480
    v_mfma_f32_16x16x32_bf16 a[180:183], a[136:139], a[12:15], a[180:183]
    buffer_load_dwordx4 v4, s[80:83], s60 offen lds
    v_mfma_f32_16x16x32_bf16 a[188:191], a[140:143], a[12:15], a[188:191]
    s_add_u32 m0, s54, 115712
    ds_read_b64_tr_b16 a[132:133], v233 offset:16384
    ds_read_b64_tr_b16 a[134:135], v233 offset:20480
    v_mfma_f32_16x16x32_bf16 a[184:187], a[140:143], a[8:11], a[184:187]
    s_waitcnt lgkmcnt(8)
    v_mfma_f32_16x16x32_bf16 a[192:195], a[144:147], a[8:11], a[192:195]
    ds_read_b64_tr_b16 a[136:137], v234 offset:16384
    ds_read_b64_tr_b16 a[138:139], v234 offset:20480
    v_mfma_f32_16x16x32_bf16 a[196:199], a[144:147], a[12:15], a[196:199]
    buffer_load_dwordx4 v5, s[80:83], s60 offen lds
    s_add_u32 s60, s60, 65536
    v_mfma_f32_16x16x32_bf16 a[204:207], a[148:151], a[12:15], a[204:207]
    ds_read_b64_tr_b16 a[140:141], v235 offset:16384
    ds_read_b64_tr_b16 a[142:143], v235 offset:20480
    v_mfma_f32_16x16x32_bf16 a[200:203], a[148:151], a[8:11], a[200:203]
    s_waitcnt lgkmcnt(8)
    v_mfma_f32_16x16x32_bf16 a[208:211], a[152:155], a[8:11], a[208:211]
    ds_read_b64_tr_b16 a[144:145], v236 offset:16384
    ds_read_b64_tr_b16 a[146:147], v236 offset:20480
    v_mfma_f32_16x16x32_bf16 a[212:215], a[152:155], a[12:15], a[212:215]
    buffer_load_dwordx4 a[112:115], v2, s[16:19], s59 offen offset:2048 sc1
    v_mfma_f32_16x16x32_bf16 a[220:223], a[156:159], a[12:15], a[220:223]
    ds_read_b64_tr_b16 a[148:149], v237 offset:16384
    ds_read_b64_tr_b16 a[150:151], v237 offset:20480
    v_mfma_f32_16x16x32_bf16 a[216:219], a[156:159], a[8:11], a[216:219]
    s_waitcnt lgkmcnt(8)
    v_mfma_f32_16x16x32_bf16 a[160:163], a[128:131], a[16:19], a[160:163]
    ds_read_b64_tr_b16 a[152:153], v238 offset:16384
    ds_read_b64_tr_b16 a[154:155], v238 offset:20480
    v_mfma_f32_16x16x32_bf16 a[164:167], a[128:131], a[20:23], a[164:167]
    buffer_load_dwordx4 a[116:119], v3, s[16:19], s59 offen offset:2048 sc1
    v_mfma_f32_16x16x32_bf16 a[172:175], a[132:135], a[20:23], a[172:175]
    s_add_u32 m0, s54, 122880
    ds_read_b64_tr_b16 a[156:157], v239 offset:16384
    ds_read_b64_tr_b16 a[158:159], v239 offset:20480
    v_mfma_f32_16x16x32_bf16 a[168:171], a[132:135], a[16:19], a[168:171]
    s_waitcnt lgkmcnt(8)
    v_mfma_f32_16x16x32_bf16 a[176:179], a[136:139], a[16:19], a[176:179]
    ds_read_b64_tr_b16 a[128:129], v232 offset:24576
    ds_read_b64_tr_b16 a[130:131], v232 offset:28672
    v_mfma_f32_16x16x32_bf16 a[180:183], a[136:139], a[20:23], a[180:183]
    buffer_load_dwordx4 v4, s[80:83], s60 offen lds
    v_mfma_f32_16x16x32_bf16 a[188:191], a[140:143], a[20:23], a[188:191]
    s_add_u32 m0, s54, 123904
    ds_read_b64_tr_b16 a[132:133], v233 offset:24576
    ds_read_b64_tr_b16 a[134:135], v233 offset:28672
    v_mfma_f32_16x16x32_bf16 a[184:187], a[140:143], a[16:19], a[184:187]
    s_waitcnt lgkmcnt(8)
    v_mfma_f32_16x16x32_bf16 a[192:195], a[144:147], a[16:19], a[192:195]
    ds_read_b64_tr_b16 a[136:137], v234 offset:24576
    ds_read_b64_tr_b16 a[138:139], v234 offset:28672
    v_mfma_f32_16x16x32_bf16 a[196:199], a[144:147], a[20:23], a[196:199]
    buffer_load_dwordx4 v5, s[80:83], s60 offen lds
    s_add_u32 s60, s60, 65536
    v_mfma_f32_16x16x32_bf16 a[204:207], a[148:151], a[20:23], a[204:207]
    ds_read_b64_tr_b16 a[140:141], v235 offset:24576
    ds_read_b64_tr_b16 a[142:143], v235 offset:28672
    v_mfma_f32_16x16x32_bf16 a[200:203], a[148:151], a[16:19], a[200:203]
    s_waitcnt lgkmcnt(8)
    v_mfma_f32_16x16x32_bf16 a[208:211], a[152:155], a[16:19], a[208:211]
    ds_read_b64_tr_b16 a[144:145], v236 offset:24576
    ds_read_b64_tr_b16 a[146:147], v236 offset:28672
    v_mfma_f32_16x16x32_bf16 a[212:215], a[152:155], a[20:23], a[212:215]
    buffer_load_dwordx4 a[120:123], v2, s[16:19], s59 offen offset:3072 sc1
    v_mfma_f32_16x16x32_bf16 a[220:223], a[156:159], a[20:23], a[220:223]
    ds_read_b64_tr_b16 a[148:149], v237 offset:24576
    ds_read_b64_tr_b16 a[150:151], v237 offset:28672
    v_mfma_f32_16x16x32_bf16 a[216:219], a[156:159], a[16:19], a[216:219]
    s_waitcnt vmcnt(53)
    s_waitcnt lgkmcnt(8)
    v_mfma_f32_16x16x32_bf16 a[160:163], a[128:131], a[24:27], a[160:163]
    ds_read_b64_tr_b16 a[152:153], v238 offset:24576
    ds_read_b64_tr_b16 a[154:155], v238 offset:28672
    v_mfma_f32_16x16x32_bf16 a[164:167], a[128:131], a[28:31], a[164:167]
    buffer_load_dwordx4 a[124:127], v3, s[16:19], s59 offen offset:3072 sc1
    s_add_u32 s59, s59, 4096
    v_mfma_f32_16x16x32_bf16 a[172:175], a[132:135], a[28:31], a[172:175]
    s_add_u32 m0, s54, 0
    ds_read_b64_tr_b16 a[156:157], v239 offset:24576
    ds_read_b64_tr_b16 a[158:159], v239 offset:28672
    v_mfma_f32_16x16x32_bf16 a[168:171], a[132:135], a[24:27], a[168:171]
    s_waitcnt vmcnt(47)
    s_barrier
    s_waitcnt lgkmcnt(8)
    v_mfma_f32_16x16x32_bf16 a[176:179], a[136:139], a[24:27], a[176:179]
    ds_read_b64_tr_b16 a[128:129], v232 offset:32768
    ds_read_b64_tr_b16 a[130:131], v232 offset:36864
    v_mfma_f32_16x16x32_bf16 a[180:183], a[136:139], a[28:31], a[180:183]
    buffer_load_dwordx4 v4, s[80:83], s60 offen lds
    v_mfma_f32_16x16x32_bf16 a[188:191], a[140:143], a[28:31], a[188:191]
    s_add_u32 m0, s54, 1024
    ds_read_b64_tr_b16 a[132:133], v233 offset:32768
    ds_read_b64_tr_b16 a[134:135], v233 offset:36864
    v_mfma_f32_16x16x32_bf16 a[184:187], a[140:143], a[24:27], a[184:187]
    s_waitcnt lgkmcnt(8)
    v_mfma_f32_16x16x32_bf16 a[192:195], a[144:147], a[24:27], a[192:195]
    ds_read_b64_tr_b16 a[136:137], v234 offset:32768
    ds_read_b64_tr_b16 a[138:139], v234 offset:36864
    v_mfma_f32_16x16x32_bf16 a[196:199], a[144:147], a[28:31], a[196:199]
    buffer_load_dwordx4 v5, s[80:83], s60 offen lds
    s_add_u32 s60, s60, 65536
    v_mfma_f32_16x16x32_bf16 a[204:207], a[148:151], a[28:31], a[204:207]
    ds_read_b64_tr_b16 a[140:141], v235 offset:32768
    ds_read_b64_tr_b16 a[142:143], v235 offset:36864
    v_mfma_f32_16x16x32_bf16 a[200:203], a[148:151], a[24:27], a[200:203]
    s_waitcnt lgkmcnt(8)
    v_mfma_f32_16x16x32_bf16 a[208:211], a[152:155], a[24:27], a[208:211]
    ds_read_b64_tr_b16 a[144:145], v236 offset:32768
    ds_read_b64_tr_b16 a[146:147], v236 offset:36864
    v_mfma_f32_16x16x32_bf16 a[212:215], a[152:155], a[28:31], a[212:215]
    buffer_load_dwordx4 a[0:3], v2, s[16:19], s59 offen offset:0 sc1
    v_mfma_f32_16x16x32_bf16 a[220:223], a[156:159], a[28:31], a[220:223]
    ds_read_b64_tr_b16 a[148:149], v237 offset:32768
    ds_read_b64_tr_b16 a[150:151], v237 offset:36864
    v_mfma_f32_16x16x32_bf16 a[216:219], a[156:159], a[24:27], a[216:219]
    s_waitcnt lgkmcnt(8)
    v_mfma_f32_16x16x32_bf16 a[160:163], a[128:131], a[32:35], a[160:163]
    ds_read_b64_tr_b16 a[152:153], v238 offset:32768
    ds_read_b64_tr_b16 a[154:155], v238 offset:36864
    v_mfma_f32_16x16x32_bf16 a[164:167], a[128:131], a[36:39], a[164:167]
    buffer_load_dwordx2 v[8:9], v6, s[16:19], s66 offen sc1
    v_mfma_f32_16x16x32_bf16 a[172:175], a[132:135], a[36:39], a[172:175]
    ds_read_b64_tr_b16 a[156:157], v239 offset:32768
    ds_read_b64_tr_b16 a[158:159], v239 offset:36864
    v_mfma_f32_16x16x32_bf16 a[168:171], a[132:135], a[32:35], a[168:171]
    buffer_load_dwordx4 a[4:7], v3, s[16:19], s59 offen offset:0 sc1
    s_waitcnt lgkmcnt(8)
    v_mfma_f32_16x16x32_bf16 a[176:179], a[136:139], a[32:35], a[176:179]
    s_add_u32 m0, s54, 8192
    ds_read_b64_tr_b16 a[128:129], v232 offset:40960
    ds_read_b64_tr_b16 a[130:131], v232 offset:45056
    v_mfma_f32_16x16x32_bf16 a[180:183], a[136:139], a[36:39], a[180:183]
    buffer_load_dwordx4 v4, s[80:83], s60 offen lds
    v_mfma_f32_16x16x32_bf16 a[188:191], a[140:143], a[36:39], a[188:191]
    s_add_u32 m0, s54, 9216
    ds_read_b64_tr_b16 a[132:133], v233 offset:40960
    ds_read_b64_tr_b16 a[134:135], v233 offset:45056
    v_mfma_f32_16x16x32_bf16 a[184:187], a[140:143], a[32:35], a[184:187]
    buffer_load_dwordx4 v5, s[80:83], s60 offen lds
    s_add_u32 s60, s60, 65536
    s_waitcnt lgkmcnt(8)
    v_mfma_f32_16x16x32_bf16 a[192:195], a[144:147], a[32:35], a[192:195]
    ds_read_b64_tr_b16 a[136:137], v234 offset:40960
    ds_read_b64_tr_b16 a[138:139], v234 offset:45056
    v_mfma_f32_16x16x32_bf16 a[196:199], a[144:147], a[36:39], a[196:199]
    buffer_load_dwordx4 a[8:11], v2, s[16:19], s59 offen offset:1024 sc1
    v_mfma_f32_16x16x32_bf16 a[204:207], a[148:151], a[36:39], a[204:207]
    ds_read_b64_tr_b16 a[140:141], v235 offset:40960
    ds_read_b64_tr_b16 a[142:143], v235 offset:45056
    v_mfma_f32_16x16x32_bf16 a[200:203], a[148:151], a[32:35], a[200:203]
    s_waitcnt lgkmcnt(8)
    v_mfma_f32_16x16x32_bf16 a[208:211], a[152:155], a[32:35], a[208:211]
    ds_read_b64_tr_b16 a[144:145], v236 offset:40960
    ds_read_b64_tr_b16 a[146:147], v236 offset:45056
    v_mfma_f32_16x16x32_bf16 a[212:215], a[152:155], a[36:39], a[212:215]
    buffer_load_dwordx4 a[12:15], v3, s[16:19], s59 offen offset:1024 sc1
    v_mfma_f32_16x16x32_bf16 a[220:223], a[156:159], a[36:39], a[220:223]
    ds_read_b64_tr_b16 a[148:149], v237 offset:40960
    ds_read_b64_tr_b16 a[150:151], v237 offset:45056
    v_mfma_f32_16x16x32_bf16 a[216:219], a[156:159], a[32:35], a[216:219]
    s_waitcnt vmcnt(54)
    s_waitcnt lgkmcnt(8)
    v_mfma_f32_16x16x32_bf16 a[160:163], a[128:131], a[40:43], a[160:163]
    s_add_u32 m0, s54, 16384
    ds_read_b64_tr_b16 a[152:153], v238 offset:40960
    ds_read_b64_tr_b16 a[154:155], v238 offset:45056
    v_mfma_f32_16x16x32_bf16 a[164:167], a[128:131], a[44:47], a[164:167]
    buffer_load_dwordx4 v4, s[80:83], s60 offen lds
    v_mfma_f32_16x16x32_bf16 a[172:175], a[132:135], a[44:47], a[172:175]
    s_add_u32 m0, s54, 17408
    ds_read_b64_tr_b16 a[156:157], v239 offset:40960
    ds_read_b64_tr_b16 a[158:159], v239 offset:45056
    v_mfma_f32_16x16x32_bf16 a[168:171], a[132:135], a[40:43], a[168:171]
    s_waitcnt vmcnt(47)
    s_barrier
    s_waitcnt lgkmcnt(8)
    v_mfma_f32_16x16x32_bf16 a[176:179], a[136:139], a[40:43], a[176:179]
    ds_read_b64_tr_b16 a[128:129], v232 offset:49152
    ds_read_b64_tr_b16 a[130:131], v232 offset:53248
    v_mfma_f32_16x16x32_bf16 a[180:183], a[136:139], a[44:47], a[180:183]
    buffer_load_dwordx4 v5, s[80:83], s60 offen lds
    s_add_u32 s60, s60, 65536
    v_mfma_f32_16x16x32_bf16 a[188:191], a[140:143], a[44:47], a[188:191]
    ds_read_b64_tr_b16 a[132:133], v233 offset:49152
    ds_read_b64_tr_b16 a[134:135], v233 offset:53248
    v_mfma_f32_16x16x32_bf16 a[184:187], a[140:143], a[40:43], a[184:187]
    s_waitcnt lgkmcnt(8)
    v_mfma_f32_16x16x32_bf16 a[192:195], a[144:147], a[40:43], a[192:195]
    ds_read_b64_tr_b16 a[136:137], v234 offset:49152
    ds_read_b64_tr_b16 a[138:139], v234 offset:53248
    v_mfma_f32_16x16x32_bf16 a[196:199], a[144:147], a[44:47], a[196:199]
    buffer_load_dwordx4 a[16:19], v2, s[16:19], s59 offen offset:2048 sc1
    v_mfma_f32_16x16x32_bf16 a[204:207], a[148:151], a[44:47], a[204:207]
    ds_read_b64_tr_b16 a[140:141], v235 offset:49152
    ds_read_b64_tr_b16 a[142:143], v235 offset:53248
    v_mfma_f32_16x16x32_bf16 a[200:203], a[148:151], a[40:43], a[200:203]
    s_waitcnt lgkmcnt(8)
    v_mfma_f32_16x16x32_bf16 a[208:211], a[152:155], a[40:43], a[208:211]
    ds_read_b64_tr_b16 a[144:145], v236 offset:49152
    ds_read_b64_tr_b16 a[146:147], v236 offset:53248
    v_mfma_f32_16x16x32_bf16 a[212:215], a[152:155], a[44:47], a[212:215]
    buffer_load_dwordx4 a[20:23], v3, s[16:19], s59 offen offset:2048 sc1
    v_mfma_f32_16x16x32_bf16 a[220:223], a[156:159], a[44:47], a[220:223]
    ds_read_b64_tr_b16 a[148:149], v237 offset:49152
    ds_read_b64_tr_b16 a[150:151], v237 offset:53248
    v_mfma_f32_16x16x32_bf16 a[216:219], a[156:159], a[40:43], a[216:219]
    s_waitcnt lgkmcnt(8)
    v_mfma_f32_16x16x32_bf16 a[160:163], a[128:131], a[48:51], a[160:163]
    ds_read_b64_tr_b16 a[152:153], v238 offset:49152
    ds_read_b64_tr_b16 a[154:155], v238 offset:53248
    v_mfma_f32_16x16x32_bf16 a[164:167], a[128:131], a[52:55], a[164:167]
    global_load_dword a224, v248, s[92:93]
    v_mfma_f32_16x16x32_bf16 a[172:175], a[132:135], a[52:55], a[172:175]
    s_add_u32 m0, s54, 24576
    ds_read_b64_tr_b16 a[156:157], v239 offset:49152
    ds_read_b64_tr_b16 a[158:159], v239 offset:53248
    v_mfma_f32_16x16x32_bf16 a[168:171], a[132:135], a[48:51], a[168:171]
    buffer_load_dwordx4 v4, s[80:83], s60 offen lds
    s_waitcnt lgkmcnt(8)
    v_mfma_f32_16x16x32_bf16 a[176:179], a[136:139], a[48:51], a[176:179]
    s_add_u32 m0, s54, 25600
    ds_read_b64_tr_b16 a[128:129], v232 offset:57344
    ds_read_b64_tr_b16 a[130:131], v232 offset:61440
    v_mfma_f32_16x16x32_bf16 a[180:183], a[136:139], a[52:55], a[180:183]
    buffer_load_dwordx4 v5, s[80:83], s60 offen lds
    s_add_u32 s60, s60, 65536
    v_mfma_f32_16x16x32_bf16 a[188:191], a[140:143], a[52:55], a[188:191]
    ds_read_b64_tr_b16 a[132:133], v233 offset:57344
    ds_read_b64_tr_b16 a[134:135], v233 offset:61440
    v_mfma_f32_16x16x32_bf16 a[184:187], a[140:143], a[48:51], a[184:187]
    s_waitcnt lgkmcnt(8)
    v_mfma_f32_16x16x32_bf16 a[192:195], a[144:147], a[48:51], a[192:195]
    ds_read_b64_tr_b16 a[136:137], v234 offset:57344
    ds_read_b64_tr_b16 a[138:139], v234 offset:61440
    v_mfma_f32_16x16x32_bf16 a[196:199], a[144:147], a[52:55], a[196:199]
    buffer_load_dwordx4 a[24:27], v2, s[16:19], s59 offen offset:3072 sc1
    v_mfma_f32_16x16x32_bf16 a[204:207], a[148:151], a[52:55], a[204:207]
    ds_read_b64_tr_b16 a[140:141], v235 offset:57344
    ds_read_b64_tr_b16 a[142:143], v235 offset:61440
    v_mfma_f32_16x16x32_bf16 a[200:203], a[148:151], a[48:51], a[200:203]
    s_waitcnt lgkmcnt(8)
    v_mfma_f32_16x16x32_bf16 a[208:211], a[152:155], a[48:51], a[208:211]
    ds_read_b64_tr_b16 a[144:145], v236 offset:57344
    ds_read_b64_tr_b16 a[146:147], v236 offset:61440
    v_mfma_f32_16x16x32_bf16 a[212:215], a[152:155], a[52:55], a[212:215]
    buffer_load_dwordx4 a[28:31], v3, s[16:19], s59 offen offset:3072 sc1
    s_add_u32 s59, s59, 4096
    v_mfma_f32_16x16x32_bf16 a[220:223], a[156:159], a[52:55], a[220:223]
    ds_read_b64_tr_b16 a[148:149], v237 offset:57344
    ds_read_b64_tr_b16 a[150:151], v237 offset:61440
    v_mfma_f32_16x16x32_bf16 a[216:219], a[156:159], a[48:51], a[216:219]
    s_waitcnt vmcnt(53)
    s_waitcnt lgkmcnt(8)
    v_mfma_f32_16x16x32_bf16 a[160:163], a[128:131], a[56:59], a[160:163]
    s_add_u32 m0, s54, 32768
    ds_read_b64_tr_b16 a[152:153], v238 offset:57344
    ds_read_b64_tr_b16 a[154:155], v238 offset:61440
    v_mfma_f32_16x16x32_bf16 a[164:167], a[128:131], a[60:63], a[164:167]
    buffer_load_dwordx4 v4, s[80:83], s60 offen lds
    v_mfma_f32_16x16x32_bf16 a[172:175], a[132:135], a[60:63], a[172:175]
    s_add_u32 m0, s54, 33792
    ds_read_b64_tr_b16 a[156:157], v239 offset:57344
    ds_read_b64_tr_b16 a[158:159], v239 offset:61440
    v_mfma_f32_16x16x32_bf16 a[168:171], a[132:135], a[56:59], a[168:171]
    buffer_load_dwordx4 v5, s[80:83], s60 offen lds
    s_add_u32 s60, s60, 65536
    s_waitcnt vmcnt(49)
    s_barrier
    s_waitcnt lgkmcnt(8)
    v_mfma_f32_16x16x32_bf16 a[176:179], a[136:139], a[56:59], a[176:179]
    ds_read_b64_tr_b16 a[128:129], v240 offset:0
    ds_read_b64_tr_b16 a[130:131], v240 offset:4096
    v_mfma_f32_16x16x32_bf16 a[180:183], a[136:139], a[60:63], a[180:183]
    buffer_load_dwordx2 a[32:33], v10, s[16:19], s59 offen offset:0 sc1
    v_mfma_f32_16x16x32_bf16 a[188:191], a[140:143], a[60:63], a[188:191]
    ds_read_b64_tr_b16 a[132:133], v241 offset:0
    ds_read_b64_tr_b16 a[134:135], v241 offset:4096
    v_mfma_f32_16x16x32_bf16 a[184:187], a[140:143], a[56:59], a[184:187]
    s_waitcnt lgkmcnt(8)
    v_mfma_f32_16x16x32_bf16 a[192:195], a[144:147], a[56:59], a[192:195]
    ds_read_b64_tr_b16 a[136:137], v242 offset:0
    ds_read_b64_tr_b16 a[138:139], v242 offset:4096
    v_mfma_f32_16x16x32_bf16 a[196:199], a[144:147], a[60:63], a[196:199]
    buffer_load_dwordx2 a[34:35], v10, s[16:19], s59 offen offset:512 sc1
    v_mfma_f32_16x16x32_bf16 a[204:207], a[148:151], a[60:63], a[204:207]
    ds_read_b64_tr_b16 a[140:141], v243 offset:0
    ds_read_b64_tr_b16 a[142:143], v243 offset:4096
    v_mfma_f32_16x16x32_bf16 a[200:203], a[148:151], a[56:59], a[200:203]
    s_waitcnt lgkmcnt(8)
    v_mfma_f32_16x16x32_bf16 a[208:211], a[152:155], a[56:59], a[208:211]
    ds_read_b64_tr_b16 a[144:145], v244 offset:0
    ds_read_b64_tr_b16 a[146:147], v244 offset:4096
    v_mfma_f32_16x16x32_bf16 a[212:215], a[152:155], a[60:63], a[212:215]
    buffer_load_dwordx2 a[36:37], v11, s[16:19], s59 offen offset:0 sc1
    v_mfma_f32_16x16x32_bf16 a[220:223], a[156:159], a[60:63], a[220:223]
    ds_read_b64_tr_b16 a[148:149], v245 offset:0
    ds_read_b64_tr_b16 a[150:151], v245 offset:4096
    v_mfma_f32_16x16x32_bf16 a[216:219], a[156:159], a[56:59], a[216:219]
    s_waitcnt lgkmcnt(8)
    v_mfma_f32_16x16x32_bf16 a[160:163], a[128:131], a[64:67], a[160:163]
    ds_read_b64_tr_b16 a[152:153], v246 offset:0
    ds_read_b64_tr_b16 a[154:155], v246 offset:4096
    v_mfma_f32_16x16x32_bf16 a[164:167], a[128:131], a[68:71], a[164:167]
    buffer_load_dwordx2 a[38:39], v11, s[16:19], s59 offen offset:512 sc1
    v_mfma_f32_16x16x32_bf16 a[172:175], a[132:135], a[68:71], a[172:175]
    s_add_u32 m0, s54, 40960
    ds_read_b64_tr_b16 a[156:157], v247 offset:0
    ds_read_b64_tr_b16 a[158:159], v247 offset:4096
    v_mfma_f32_16x16x32_bf16 a[168:171], a[132:135], a[64:67], a[168:171]
    s_waitcnt lgkmcnt(8)
    v_mfma_f32_16x16x32_bf16 a[176:179], a[136:139], a[64:67], a[176:179]
    ds_read_b64_tr_b16 a[128:129], v240 offset:8192
    ds_read_b64_tr_b16 a[130:131], v240 offset:12288
    v_mfma_f32_16x16x32_bf16 a[180:183], a[136:139], a[68:71], a[180:183]
    buffer_load_dwordx4 v4, s[80:83], s60 offen lds
    v_mfma_f32_16x16x32_bf16 a[188:191], a[140:143], a[68:71], a[188:191]
    s_add_u32 m0, s54, 41984
    ds_read_b64_tr_b16 a[132:133], v241 offset:8192
    ds_read_b64_tr_b16 a[134:135], v241 offset:12288
    v_mfma_f32_16x16x32_bf16 a[184:187], a[140:143], a[64:67], a[184:187]
    s_waitcnt lgkmcnt(8)
    v_mfma_f32_16x16x32_bf16 a[192:195], a[144:147], a[64:67], a[192:195]
    ds_read_b64_tr_b16 a[136:137], v242 offset:8192
    ds_read_b64_tr_b16 a[138:139], v242 offset:12288
    v_mfma_f32_16x16x32_bf16 a[196:199], a[144:147], a[68:71], a[196:199]
    buffer_load_dwordx4 v5, s[80:83], s60 offen lds
    s_add_u32 s60, s60, 65536
    v_mfma_f32_16x16x32_bf16 a[204:207], a[148:151], a[68:71], a[204:207]
    ds_read_b64_tr_b16 a[140:141], v243 offset:8192
    ds_read_b64_tr_b16 a[142:143], v243 offset:12288
    v_mfma_f32_16x16x32_bf16 a[200:203], a[148:151], a[64:67], a[200:203]
    s_waitcnt lgkmcnt(8)
    v_mfma_f32_16x16x32_bf16 a[208:211], a[152:155], a[64:67], a[208:211]
    ds_read_b64_tr_b16 a[144:145], v244 offset:8192
    ds_read_b64_tr_b16 a[146:147], v244 offset:12288
    v_mfma_f32_16x16x32_bf16 a[212:215], a[152:155], a[68:71], a[212:215]
    buffer_load_dwordx4 a[40:43], v2, s[16:19], s59 offen offset:1024 sc1
    v_mfma_f32_16x16x32_bf16 a[220:223], a[156:159], a[68:71], a[220:223]
    ds_read_b64_tr_b16 a[148:149], v245 offset:8192
    ds_read_b64_tr_b16 a[150:151], v245 offset:12288
    v_mfma_f32_16x16x32_bf16 a[216:219], a[156:159], a[64:67], a[216:219]
    s_waitcnt vmcnt(54)
    s_waitcnt lgkmcnt(8)
    v_mfma_f32_16x16x32_bf16 a[160:163], a[128:131], a[72:75], a[160:163]
    ds_read_b64_tr_b16 a[152:153], v246 offset:8192
    ds_read_b64_tr_b16 a[154:155], v246 offset:12288
    v_mfma_f32_16x16x32_bf16 a[164:167], a[128:131], a[76:79], a[164:167]
    buffer_load_dwordx4 a[44:47], v3, s[16:19], s59 offen offset:1024 sc1
    v_mfma_f32_16x16x32_bf16 a[172:175], a[132:135], a[76:79], a[172:175]
    s_add_u32 m0, s54, 49152
    ds_read_b64_tr_b16 a[156:157], v247 offset:8192
    ds_read_b64_tr_b16 a[158:159], v247 offset:12288
    v_mfma_f32_16x16x32_bf16 a[168:171], a[132:135], a[72:75], a[168:171]
    s_waitcnt vmcnt(49)
    s_barrier
    s_waitcnt lgkmcnt(8)
    v_mfma_f32_16x16x32_bf16 a[176:179], a[136:139], a[72:75], a[176:179]
    ds_read_b64_tr_b16 a[128:129], v240 offset:16384
    ds_read_b64_tr_b16 a[130:131], v240 offset:20480
    v_mfma_f32_16x16x32_bf16 a[180:183], a[136:139], a[76:79], a[180:183]
    buffer_load_dwordx4 v4, s[80:83], s60 offen lds
    v_mfma_f32_16x16x32_bf16 a[188:191], a[140:143], a[76:79], a[188:191]
    s_add_u32 m0, s54, 50176
    ds_read_b64_tr_b16 a[132:133], v241 offset:16384
    ds_read_b64_tr_b16 a[134:135], v241 offset:20480
    v_mfma_f32_16x16x32_bf16 a[184:187], a[140:143], a[72:75], a[184:187]
    s_waitcnt lgkmcnt(8)
    v_mfma_f32_16x16x32_bf16 a[192:195], a[144:147], a[72:75], a[192:195]
    ds_read_b64_tr_b16 a[136:137], v242 offset:16384
    ds_read_b64_tr_b16 a[138:139], v242 offset:20480
    v_mfma_f32_16x16x32_bf16 a[196:199], a[144:147], a[76:79], a[196:199]
    buffer_load_dwordx4 v5, s[80:83], s60 offen lds
    s_add_u32 s60, s60, 65536
    v_mfma_f32_16x16x32_bf16 a[204:207], a[148:151], a[76:79], a[204:207]
    ds_read_b64_tr_b16 a[140:141], v243 offset:16384
    ds_read_b64_tr_b16 a[142:143], v243 offset:20480
    v_mfma_f32_16x16x32_bf16 a[200:203], a[148:151], a[72:75], a[200:203]
    s_waitcnt lgkmcnt(8)
    v_mfma_f32_16x16x32_bf16 a[208:211], a[152:155], a[72:75], a[208:211]
    ds_read_b64_tr_b16 a[144:145], v244 offset:16384
    ds_read_b64_tr_b16 a[146:147], v244 offset:20480
    v_mfma_f32_16x16x32_bf16 a[212:215], a[152:155], a[76:79], a[212:215]
    buffer_load_dwordx4 a[48:51], v2, s[16:19], s59 offen offset:2048 sc1
    v_mfma_f32_16x16x32_bf16 a[220:223], a[156:159], a[76:79], a[220:223]
    ds_read_b64_tr_b16 a[148:149], v245 offset:16384
    ds_read_b64_tr_b16 a[150:151], v245 offset:20480
    v_mfma_f32_16x16x32_bf16 a[216:219], a[156:159], a[72:75], a[216:219]
    s_waitcnt lgkmcnt(8)
    v_mfma_f32_16x16x32_bf16 a[160:163], a[128:131], a[80:83], a[160:163]
    ds_read_b64_tr_b16 a[152:153], v246 offset:16384
    ds_read_b64_tr_b16 a[154:155], v246 offset:20480
    v_mfma_f32_16x16x32_bf16 a[164:167], a[128:131], a[84:87], a[164:167]
    buffer_load_dwordx4 a[52:55], v3, s[16:19], s59 offen offset:2048 sc1
    v_mfma_f32_16x16x32_bf16 a[172:175], a[132:135], a[84:87], a[172:175]
    s_add_u32 m0, s54, 57344
    ds_read_b64_tr_b16 a[156:157], v247 offset:16384
    ds_read_b64_tr_b16 a[158:159], v247 offset:20480
    v_mfma_f32_16x16x32_bf16 a[168:171], a[132:135], a[80:83], a[168:171]
    s_waitcnt lgkmcnt(8)
    v_mfma_f32_16x16x32_bf16 a[176:179], a[136:139], a[80:83], a[176:179]
    ds_read_b64_tr_b16 a[128:129], v240 offset:24576
    ds_read_b64_tr_b16 a[130:131], v240 offset:28672
    v_mfma_f32_16x16x32_bf16 a[180:183], a[136:139], a[84:87], a[180:183]
    buffer_load_dwordx4 v4, s[80:83], s60 offen lds
    v_mfma_f32_16x16x32_bf16 a[188:191], a[140:143], a[84:87], a[188:191]
    s_add_u32 m0, s54, 58368
    ds_read_b64_tr_b16 a[132:133], v241 offset:24576
    ds_read_b64_tr_b16 a[134:135], v241 offset:28672
    v_mfma_f32_16x16x32_bf16 a[184:187], a[140:143], a[80:83], a[184:187]
    s_waitcnt lgkmcnt(8)
    v_mfma_f32_16x16x32_bf16 a[192:195], a[144:147], a[80:83], a[192:195]
    ds_read_b64_tr_b16 a[136:137], v242 offset:24576
    ds_read_b64_tr_b16 a[138:139], v242 offset:28672
    v_mfma_f32_16x16x32_bf16 a[196:199], a[144:147], a[84:87], a[196:199]
    buffer_load_dwordx4 v5, s[80:83], s60 offen lds
    s_mov_b32 s60, 0
    v_mfma_f32_16x16x32_bf16 a[204:207], a[148:151], a[84:87], a[204:207]
    ds_read_b64_tr_b16 a[140:141], v243 offset:24576
    ds_read_b64_tr_b16 a[142:143], v243 offset:28672
    v_mfma_f32_16x16x32_bf16 a[200:203], a[148:151], a[80:83], a[200:203]
    s_waitcnt lgkmcnt(8)
    v_mfma_f32_16x16x32_bf16 a[208:211], a[152:155], a[80:83], a[208:211]
    ds_read_b64_tr_b16 a[144:145], v244 offset:24576
    ds_read_b64_tr_b16 a[146:147], v244 offset:28672
    v_mfma_f32_16x16x32_bf16 a[212:215], a[152:155], a[84:87], a[212:215]
    buffer_load_dwordx4 a[56:59], v2, s[16:19], s59 offen offset:3072 sc1
    v_mfma_f32_16x16x32_bf16 a[220:223], a[156:159], a[84:87], a[220:223]
    ds_read_b64_tr_b16 a[148:149], v245 offset:24576
    ds_read_b64_tr_b16 a[150:151], v245 offset:28672
    v_mfma_f32_16x16x32_bf16 a[216:219], a[156:159], a[80:83], a[216:219]
    s_waitcnt vmcnt(31)
    v_cmp_ne_u32 vcc, s52, v8
    v_cmp_ne_u32 s[64:65], s53, v9
    s_nop 1
    s_or_b64 s[64:65], vcc, s[64:65]
    s_and_b32 s64, s64, 0xffffffff
    s_cbranch_scc1 L_o_slow
L_o_ok:
    s_waitcnt lgkmcnt(8)
    v_mfma_f32_16x16x32_bf16 a[160:163], a[128:131], a[88:91], a[160:163]
    ds_read_b64_tr_b16 a[152:153], v246 offset:24576
    ds_read_b64_tr_b16 a[154:155], v246 offset:28672
    v_mfma_f32_16x16x32_bf16 a[164:167], a[128:131], a[92:95], a[164:167]
    buffer_load_dwordx4 a[60:63], v3, s[16:19], s59 offen offset:3072 sc1
    s_mov_b32 s59, 114688
    v_mfma_f32_16x16x32_bf16 a[172:175], a[132:135], a[92:95], a[172:175]
    s_add_u32 m0, s38, 65536
    ds_read_b64_tr_b16 a[156:157], v247 offset:24576
    ds_read_b64_tr_b16 a[158:159], v247 offset:28672
    v_mfma_f32_16x16x32_bf16 a[168:171], a[132:135], a[88:91], a[168:171]
    buffer_load_dwordx4 v7, s[84:87], s60 offen lds
    s_add_u32 s60, s60, 65536
    s_barrier
    s_waitcnt lgkmcnt(8)
    v_mfma_f32_16x16x32_bf16 a[176:179], a[136:139], a[88:91], a[176:179]
    s_add_u32 m0, s38, 69632
    ds_read_b64_tr_b16 a[128:129], v240 offset:32768
    ds_read_b64_tr_b16 a[130:131], v240 offset:36864
    v_mfma_f32_16x16x32_bf16 a[180:183], a[136:139], a[92:95], a[180:183]
    buffer_load_dwordx4 v7, s[84:87], s60 offen lds
    s_add_u32 s60, s60, 65536
    v_mfma_f32_16x16x32_bf16 a[188:191], a[140:143], a[92:95], a[188:191]
    ds_read_b64_tr_b16 a[132:133], v241 offset:32768
    ds_read_b64_tr_b16 a[134:135], v241 offset:36864
    v_mfma_f32_16x16x32_bf16 a[184:187], a[140:143], a[88:91], a[184:187]
    s_waitcnt lgkmcnt(8)
    v_mfma_f32_16x16x32_bf16 a[192:195], a[144:147], a[88:91], a[192:195]
    ds_read_b64_tr_b16 a[136:137], v242 offset:32768
    ds_read_b64_tr_b16 a[138:139], v242 offset:36864
    v_mfma_f32_16x16x32_bf16 a[196:199], a[144:147], a[92:95], a[196:199]
    buffer_load_dwordx4 v[72:75], v2, s[16:19], s59 offen offset:0 sc1
    v_mfma_f32_16x16x32_bf16 a[204:207], a[148:151], a[92:95], a[204:207]
    ds_read_b64_tr_b16 a[140:141], v243 offset:32768
    ds_read_b64_tr_b16 a[142:143], v243 offset:36864
    v_mfma_f32_16x16x32_bf16 a[200:203], a[148:151], a[88:91], a[200:203]
    s_waitcnt lgkmcnt(8)
    v_mfma_f32_16x16x32_bf16 a[208:211], a[152:155], a[88:91], a[208:211]
    ds_read_b64_tr_b16 a[144:145], v244 offset:32768
    ds_read_b64_tr_b16 a[146:147], v244 offset:36864
    v_mfma_f32_16x16x32_bf16 a[212:215], a[152:155], a[92:95], a[212:215]
    buffer_load_dwordx4 v[76:79], v3, s[16:19], s59 offen offset:0 sc1
    v_mfma_f32_16x16x32_bf16 a[220:223], a[156:159], a[92:95], a[220:223]
    ds_read_b64_tr_b16 a[148:149], v245 offset:32768
    ds_read_b64_tr_b16 a[150:151], v245 offset:36864
    v_mfma_f32_16x16x32_bf16 a[216:219], a[156:159], a[88:91], a[216:219]
    s_waitcnt lgkmcnt(8)
    v_mfma_f32_16x16x32_bf16 a[160:163], a[128:131], a[96:99], a[160:163]
    ds_read_b64_tr_b16 a[152:153], v246 offset:32768
    ds_read_b64_tr_b16 a[154:155], v246 offset:36864
    v_mfma_f32_16x16x32_bf16 a[164:167], a[128:131], a[100:103], a[164:167]
    buffer_load_dwordx4 v[80:83], v2, s[16:19], s59 offen offset:1024 sc1
    v_mfma_f32_16x16x32_bf16 a[172:175], a[132:135], a[100:103], a[172:175]
    ds_read_b64_tr_b16 a[156:157], v247 offset:32768
    ds_read_b64_tr_b16 a[158:159], v247 offset:36864
    v_mfma_f32_16x16x32_bf16 a[168:171], a[132:135], a[96:99], a[168:171]
    s_waitcnt lgkmcnt(8)
    v_mfma_f32_16x16x32_bf16 a[176:179], a[136:139], a[96:99], a[176:179]
    ds_read_b64_tr_b16 a[128:129], v240 offset:40960
    ds_read_b64_tr_b16 a[130:131], v240 offset:45056
    v_mfma_f32_16x16x32_bf16 a[180:183], a[136:139], a[100:103], a[180:183]
    buffer_load_dwordx4 v[84:87], v3, s[16:19], s59 offen offset:1024 sc1
    v_mfma_f32_16x16x32_bf16 a[188:191], a[140:143], a[100:103], a[188:191]
    s_add_u32 m0, s38, 73728
    ds_read_b64_tr_b16 a[132:133], v241 offset:40960
    ds_read_b64_tr_b16 a[134:135], v241 offset:45056
    v_mfma_f32_16x16x32_bf16 a[184:187], a[140:143], a[96:99], a[184:187]
    s_waitcnt lgkmcnt(8)
    v_mfma_f32_16x16x32_bf16 a[192:195], a[144:147], a[96:99], a[192:195]
    ds_read_b64_tr_b16 a[136:137], v242 offset:40960
    ds_read_b64_tr_b16 a[138:139], v242 offset:45056
    v_mfma_f32_16x16x32_bf16 a[196:199], a[144:147], a[100:103], a[196:199]
    buffer_load_dwordx4 v7, s[84:87], s60 offen lds
    s_add_u32 s60, s60, 65536
    v_mfma_f32_16x16x32_bf16 a[204:207], a[148:151], a[100:103], a[204:207]
    s_add_u32 m0, s38, 77824
    ds_read_b64_tr_b16 a[140:141], v243 offset:40960
    ds_read_b64_tr_b16 a[142:143], v243 offset:45056
    v_mfma_f32_16x16x32_bf16 a[200:203], a[148:151], a[96:99], a[200:203]
    s_waitcnt lgkmcnt(8)
    v_mfma_f32_16x16x32_bf16 a[208:211], a[152:155], a[96:99], a[208:211]
    ds_read_b64_tr_b16 a[144:145], v244 offset:40960
    ds_read_b64_tr_b16 a[146:147], v244 offset:45056
    v_mfma_f32_16x16x32_bf16 a[212:215], a[152:155], a[100:103], a[212:215]
    buffer_load_dwordx4 v7, s[84:87], s60 offen lds
    s_add_u32 s60, s60, 65536
    v_mfma_f32_16x16x32_bf16 a[220:223], a[156:159], a[100:103], a[220:223]
    ds_read_b64_tr_b16 a[148:149], v245 offset:40960
    ds_read_b64_tr_b16 a[150:151], v245 offset:45056
    v_mfma_f32_16x16x32_bf16 a[216:219], a[156:159], a[96:99], a[216:219]
    s_waitcnt lgkmcnt(8)
    v_mfma_f32_16x16x32_bf16 a[160:163], a[128:131], a[104:107], a[160:163]
    ds_read_b64_tr_b16 a[152:153], v246 offset:40960
    ds_read_b64_tr_b16 a[154:155], v246 offset:45056
    v_mfma_f32_16x16x32_bf16 a[164:167], a[128:131], a[108:111], a[164:167]
    buffer_load_dwordx4 v[88:91], v2, s[16:19], s59 offen offset:2048 sc1
    v_mfma_f32_16x16x32_bf16 a[172:175], a[132:135], a[108:111], a[172:175]
    ds_read_b64_tr_b16 a[156:157], v247 offset:40960
    ds_read_b64_tr_b16 a[158:159], v247 offset:45056
    v_mfma_f32_16x16x32_bf16 a[168:171], a[132:135], a[104:107], a[168:171]
    s_barrier
    s_waitcnt lgkmcnt(8)
    v_mfma_f32_16x16x32_bf16 a[176:179], a[136:139], a[104:107], a[176:179]
    ds_read_b64_tr_b16 a[128:129], v240 offset:49152
    ds_read_b64_tr_b16 a[130:131], v240 offset:53248
    v_mfma_f32_16x16x32_bf16 a[180:183], a[136:139], a[108:111], a[180:183]
    buffer_load_dwordx4 v[92:95], v3, s[16:19], s59 offen offset:2048 sc1
    v_mfma_f32_16x16x32_bf16 a[188:191], a[140:143], a[108:111], a[188:191]
    ds_read_b64_tr_b16 a[132:133], v241 offset:49152
    ds_read_b64_tr_b16 a[134:135], v241 offset:53248
    v_mfma_f32_16x16x32_bf16 a[184:187], a[140:143], a[104:107], a[184:187]
    s_waitcnt lgkmcnt(8)
    v_mfma_f32_16x16x32_bf16 a[192:195], a[144:147], a[104:107], a[192:195]
    ds_read_b64_tr_b16 a[136:137], v242 offset:49152
    ds_read_b64_tr_b16 a[138:139], v242 offset:53248
    v_mfma_f32_16x16x32_bf16 a[196:199], a[144:147], a[108:111], a[196:199]
    buffer_load_dwordx4 v[96:99], v2, s[16:19], s59 offen offset:3072 sc1
    v_mfma_f32_16x16x32_bf16 a[204:207], a[148:151], a[108:111], a[204:207]
    ds_read_b64_tr_b16 a[140:141], v243 offset:49152
    ds_read_b64_tr_b16 a[142:143], v243 offset:53248
    v_mfma_f32_16x16x32_bf16 a[200:203], a[148:151], a[104:107], a[200:203]
    s_waitcnt lgkmcnt(8)
    v_mfma_f32_16x16x32_bf16 a[208:211], a[152:155], a[104:107], a[208:211]
    ds_read_b64_tr_b16 a[144:145], v244 offset:49152
    ds_read_b64_tr_b16 a[146:147], v244 offset:53248
    v_mfma_f32_16x16x32_bf16 a[212:215], a[152:155], a[108:111], a[212:215]
    buffer_load_dwordx4 v[100:103], v3, s[16:19], s59 offen offset:3072 sc1
    s_add_u32 s59, s59, 4096
    v_mfma_f32_16x16x32_bf16 a[220:223], a[156:159], a[108:111], a[220:223]
    ds_read_b64_tr_b16 a[148:149], v245 offset:49152
    ds_read_b64_tr_b16 a[150:151], v245 offset:53248
    v_mfma_f32_16x16x32_bf16 a[216:219], a[156:159], a[104:107], a[216:219]
    s_waitcnt lgkmcnt(8)
    v_mfma_f32_16x16x32_bf16 a[160:163], a[128:131], a[112:115], a[160:163]
    s_add_u32 m0, s38, 81920
    ds_read_b64_tr_b16 a[152:153], v246 offset:49152
    ds_read_b64_tr_b16 a[154:155], v246 offset:53248
    v_mfma_f32_16x16x32_bf16 a[164:167], a[128:131], a[116:119], a[164:167]
    buffer_load_dwordx4 v7, s[84:87], s60 offen lds
    s_add_u32 s60, s60, 65536
    v_mfma_f32_16x16x32_bf16 a[172:175], a[132:135], a[116:119], a[172:175]
    s_add_u32 m0, s38, 86016
    ds_read_b64_tr_b16 a[156:157], v247 offset:49152
    ds_read_b64_tr_b16 a[158:159], v247 offset:53248
    v_mfma_f32_16x16x32_bf16 a[168:171], a[132:135], a[112:115], a[168:171]
    buffer_load_dwordx4 v7, s[84:87], s60 offen lds
    s_add_u32 s60, s60, 65536
    s_waitcnt lgkmcnt(8)
    v_mfma_f32_16x16x32_bf16 a[176:179], a[136:139], a[112:115], a[176:179]
    ds_read_b64_tr_b16 a[128:129], v240 offset:57344
    ds_read_b64_tr_b16 a[130:131], v240 offset:61440
    v_mfma_f32_16x16x32_bf16 a[180:183], a[136:139], a[116:119], a[180:183]
    buffer_load_dwordx4 v[104:107], v2, s[16:19], s59 offen offset:0 sc1
    v_mfma_f32_16x16x32_bf16 a[188:191], a[140:143], a[116:119], a[188:191]
    ds_read_b64_tr_b16 a[132:133], v241 offset:57344
    ds_read_b64_tr_b16 a[134:135], v241 offset:61440
    v_mfma_f32_16x16x32_bf16 a[184:187], a[140:143], a[112:115], a[184:187]
    s_waitcnt lgkmcnt(8)
    v_mfma_f32_16x16x32_bf16 a[192:195], a[144:147], a[112:115], a[192:195]
    ds_read_b64_tr_b16 a[136:137], v242 offset:57344
    ds_read_b64_tr_b16 a[138:139], v242 offset:61440
    v_mfma_f32_16x16x32_bf16 a[196:199], a[144:147], a[116:119], a[196:199]
    buffer_load_dwordx4 v[108:111], v3, s[16:19], s59 offen offset:0 sc1
    v_mfma_f32_16x16x32_bf16 a[204:207], a[148:151], a[116:119], a[204:207]
    ds_read_b64_tr_b16 a[140:141], v243 offset:57344
    ds_read_b64_tr_b16 a[142:143], v243 offset:61440
    v_mfma_f32_16x16x32_bf16 a[200:203], a[148:151], a[112:115], a[200:203]
    s_waitcnt lgkmcnt(8)
    v_mfma_f32_16x16x32_bf16 a[208:211], a[152:155], a[112:115], a[208:211]
    ds_read_b64_tr_b16 a[144:145], v244 offset:57344
    ds_read_b64_tr_b16 a[146:147], v244 offset:61440
    v_mfma_f32_16x16x32_bf16 a[212:215], a[152:155], a[116:119], a[212:215]
    buffer_load_dwordx4 v[112:115], v2, s[16:19], s59 offen offset:1024 sc1
    v_mfma_f32_16x16x32_bf16 a[220:223], a[156:159], a[116:119], a[220:223]
    ds_read_b64_tr_b16 a[148:149], v245 offset:57344
    ds_read_b64_tr_b16 a[150:151], v245 offset:61440
    v_mfma_f32_16x16x32_bf16 a[216:219], a[156:159], a[112:115], a[216:219]
    s_waitcnt lgkmcnt(8)
    v_mfma_f32_16x16x32_bf16 a[160:163], a[128:131], a[120:123], a[160:163]
    ds_read_b64_tr_b16 a[152:153], v246 offset:57344
    ds_read_b64_tr_b16 a[154:155], v246 offset:61440
    v_mfma_f32_16x16x32_bf16 a[164:167], a[128:131], a[124:127], a[164:167]
    buffer_load_dwordx4 v[116:119], v3, s[16:19], s59 offen offset:1024 sc1
    v_mfma_f32_16x16x32_bf16 a[172:175], a[132:135], a[124:127], a[172:175]
    s_add_u32 m0, s38, 90112
    ds_read_b64_tr_b16 a[156:157], v247 offset:57344
    ds_read_b64_tr_b16 a[158:159], v247 offset:61440
    v_mfma_f32_16x16x32_bf16 a[168:171], a[132:135], a[120:123], a[168:171]
    s_waitcnt vmcnt(38)
    s_barrier
    s_waitcnt lgkmcnt(8)
    v_mfma_f32_16x16x32_bf16 a[176:179], a[136:139], a[120:123], a[176:179]
    ds_read_b64_tr_b16 a[128:129], v236 offset:0
    ds_read_b64_tr_b16 a[130:131], v236 offset:4096
    v_mfma_f32_16x16x32_bf16 a[180:183], a[136:139], a[124:127], a[180:183]
    buffer_load_dwordx4 v7, s[84:87], s60 offen lds
    s_add_u32 s60, s60, 65536
    v_mfma_f32_16x16x32_bf16 a[188:191], a[140:143], a[124:127], a[188:191]
    s_add_u32 m0, s38, 94208
    ds_read_b64_tr_b16 a[132:133], v237 offset:0
    ds_read_b64_tr_b16 a[134:135], v237 offset:4096
    v_mfma_f32_16x16x32_bf16 a[184:187], a[140:143], a[120:123], a[184:187]
    s_waitcnt lgkmcnt(8)
    v_mfma_f32_16x16x32_bf16 a[192:195], a[144:147], a[120:123], a[192:195]
    ds_read_b64_tr_b16 a[136:137], v238 offset:0
    ds_read_b64_tr_b16 a[138:139], v238 offset:4096
    v_mfma_f32_16x16x32_bf16 a[196:199], a[144:147], a[124:127], a[196:199]
    buffer_load_dwordx4 v7, s[84:87], s60 offen lds
    s_add_u32 s60, s60, 65536
    v_mfma_f32_16x16x32_bf16 a[204:207], a[148:151], a[124:127], a[204:207]
    ds_read_b64_tr_b16 a[140:141], v239 offset:0
    ds_read_b64_tr_b16 a[142:143], v239 offset:4096
    v_mfma_f32_16x16x32_bf16 a[200:203], a[148:151], a[120:123], a[200:203]
    s_waitcnt lgkmcnt(8)
    v_mfma_f32_16x16x32_bf16 a[208:211], a[152:155], a[120:123], a[208:211]
    ds_read_b64_tr_b16 a[144:145], v236 offset:8192
    ds_read_b64_tr_b16 a[146:147], v236 offset:12288
    v_mfma_f32_16x16x32_bf16 a[212:215], a[152:155], a[124:127], a[212:215]
    buffer_load_dwordx4 v[120:123], v2, s[16:19], s59 offen offset:2048 sc1
    v_mfma_f32_16x16x32_bf16 a[220:223], a[156:159], a[124:127], a[220:223]
    ds_read_b64_tr_b16 a[148:149], v237 offset:8192
    ds_read_b64_tr_b16 a[150:151], v237 offset:12288
    v_mfma_f32_16x16x32_bf16 a[216:219], a[156:159], a[120:123], a[216:219]
    s_waitcnt lgkmcnt(8)
    v_mfma_f32_16x16x32_bf16 a[192:195], a[128:131], a[0:3], a[192:195]
    ds_read_b64_tr_b16 a[152:153], v238 offset:8192
    ds_read_b64_tr_b16 a[154:155], v238 offset:12288
    v_mfma_f32_16x16x32_bf16 a[196:199], a[128:131], a[4:7], a[196:199]
    buffer_load_dwordx4 v[124:127], v3, s[16:19], s59 offen offset:2048 sc1
    v_mfma_f32_16x16x32_bf16 a[204:207], a[132:135], a[4:7], a[204:207]
    ds_read_b64_tr_b16 a[156:157], v239 offset:8192
    ds_read_b64_tr_b16 a[158:159], v239 offset:12288
    v_mfma_f32_16x16x32_bf16 a[200:203], a[132:135], a[0:3], a[200:203]
    s_waitcnt lgkmcnt(8)
    v_mfma_f32_16x16x32_bf16 a[208:211], a[136:139], a[0:3], a[208:211]
    ds_read_b64_tr_b16 a[128:129], v236 offset:16384
    ds_read_b64_tr_b16 a[130:131], v236 offset:20480
    v_mfma_f32_16x16x32_bf16 a[212:215], a[136:139], a[4:7], a[212:215]
    buffer_load_dwordx4 v[128:131], v2, s[16:19], s59 offen offset:3072 sc1
    v_mfma_f32_16x16x32_bf16 a[220:223], a[140:143], a[4:7], a[220:223]
    ds_read_b64_tr_b16 a[132:133], v237 offset:16384
    ds_read_b64_tr_b16 a[134:135], v237 offset:20480
    v_mfma_f32_16x16x32_bf16 a[216:219], a[140:143], a[0:3], a[216:219]
    s_waitcnt lgkmcnt(8)
    v_mfma_f32_16x16x32_bf16 a[192:195], a[144:147], a[8:11], a[192:195]
    ds_read_b64_tr_b16 a[136:137], v238 offset:16384
    ds_read_b64_tr_b16 a[138:139], v238 offset:20480
    v_mfma_f32_16x16x32_bf16 a[196:199], a[144:147], a[12:15], a[196:199]
    buffer_load_dwordx4 v[132:135], v3, s[16:19], s59 offen offset:3072 sc1
    s_add_u32 s59, s59, 4096
    v_mfma_f32_16x16x32_bf16 a[204:207], a[148:151], a[12:15], a[204:207]
    s_add_u32 m0, s38, 98304
    ds_read_b64_tr_b16 a[140:141], v239 offset:16384
    ds_read_b64_tr_b16 a[142:143], v239 offset:20480
    v_mfma_f32_16x16x32_bf16 a[200:203], a[148:151], a[8:11], a[200:203]
    s_waitcnt lgkmcnt(8)
    v_mfma_f32_16x16x32_bf16 a[208:211], a[152:155], a[8:11], a[208:211]
    ds_read_b64_tr_b16 a[144:145], v236 offset:24576
    ds_read_b64_tr_b16 a[146:147], v236 offset:28672
    v_mfma_f32_16x16x32_bf16 a[212:215], a[152:155], a[12:15], a[212:215]
    buffer_load_dwordx4 v7, s[84:87], s60 offen lds
    s_add_u32 s60, s60, 65536
    v_mfma_f32_16x16x32_bf16 a[220:223], a[156:159], a[12:15], a[220:223]
    ds_read_b64_tr_b16 a[148:149], v237 offset:24576
    ds_read_b64_tr_b16 a[150:151], v237 offset:28672
    v_mfma_f32_16x16x32_bf16 a[216:219], a[156:159], a[8:11], a[216:219]
    s_waitcnt lgkmcnt(8)
    v_mfma_f32_16x16x32_bf16 a[192:195], a[128:131], a[16:19], a[192:195]
    s_add_u32 m0, s38, 102400
    ds_read_b64_tr_b16 a[152:153], v238 offset:24576
    ds_read_b64_tr_b16 a[154:155], v238 offset:28672
    v_mfma_f32_16x16x32_bf16 a[196:199], a[128:131], a[20:23], a[196:199]
    buffer_load_dwordx4 v7, s[84:87], s60 offen lds
    s_add_u32 s60, s60, 65536
    v_mfma_f32_16x16x32_bf16 a[204:207], a[132:135], a[20:23], a[204:207]
    ds_read_b64_tr_b16 a[156:157], v239 offset:24576
    ds_read_b64_tr_b16 a[158:159], v239 offset:28672
    v_mfma_f32_16x16x32_bf16 a[200:203], a[132:135], a[16:19], a[200:203]
    buffer_load_dwordx4 v[136:139], v2, s[16:19], s59 offen offset:0 sc1
    s_waitcnt vmcnt(29)
    s_barrier
    s_waitcnt lgkmcnt(8)
    v_mfma_f32_16x16x32_bf16 a[208:211], a[136:139], a[16:19], a[208:211]
    ds_read_b64_tr_b16 a[128:129], v236 offset:32768
    ds_read_b64_tr_b16 a[130:131], v236 offset:36864
    v_mfma_f32_16x16x32_bf16 a[212:215], a[136:139], a[20:23], a[212:215]
    buffer_load_dwordx4 v[140:143], v3, s[16:19], s59 offen offset:0 sc1
    v_mfma_f32_16x16x32_bf16 a[220:223], a[140:143], a[20:23], a[220:223]
    ds_read_b64_tr_b16 a[132:133], v237 offset:32768
    ds_read_b64_tr_b16 a[134:135], v237 offset:36864
    v_mfma_f32_16x16x32_bf16 a[216:219], a[140:143], a[16:19], a[216:219]
    s_waitcnt lgkmcnt(8)
    v_mfma_f32_16x16x32_bf16 a[192:195], a[144:147], a[24:27], a[192:195]
    ds_read_b64_tr_b16 a[136:137], v238 offset:32768
    ds_read_b64_tr_b16 a[138:139], v238 offset:36864
    v_mfma_f32_16x16x32_bf16 a[196:199], a[144:147], a[28:31], a[196:199]
    buffer_load_dwordx4 v[144:147], v2, s[16:19], s59 offen offset:1024 sc1
    v_mfma_f32_16x16x32_bf16 a[204:207], a[148:151], a[28:31], a[204:207]
    ds_read_b64_tr_b16 a[140:141], v239 offset:32768
    ds_read_b64_tr_b16 a[142:143], v239 offset:36864
    v_mfma_f32_16x16x32_bf16 a[200:203], a[148:151], a[24:27], a[200:203]
    s_waitcnt lgkmcnt(8)
    v_mfma_f32_16x16x32_bf16 a[208:211], a[152:155], a[24:27], a[208:211]
    ds_read_b64_tr_b16 a[144:145], v236 offset:40960
    ds_read_b64_tr_b16 a[146:147], v236 offset:45056
    v_mfma_f32_16x16x32_bf16 a[212:215], a[152:155], a[28:31], a[212:215]
    buffer_load_dwordx4 v[148:151], v3, s[16:19], s59 offen offset:1024 sc1
    v_mfma_f32_16x16x32_bf16 a[220:223], a[156:159], a[28:31], a[220:223]
    ds_read_b64_tr_b16 a[148:149], v237 offset:40960
    ds_read_b64_tr_b16 a[150:151], v237 offset:45056
    v_mfma_f32_16x16x32_bf16 a[216:219], a[156:159], a[24:27], a[216:219]
    s_waitcnt lgkmcnt(8)
    v_mfma_f32_16x16x32_bf16 a[192:195], a[128:131], a[32:35], a[192:195]
    s_add_u32 m0, s38, 106496
    ds_read_b64_tr_b16 a[152:153], v238 offset:40960
    ds_read_b64_tr_b16 a[154:155], v238 offset:45056
    v_mfma_f32_16x16x32_bf16 a[196:199], a[128:131], a[36:39], a[196:199]
    buffer_load_dwordx4 v7, s[84:87], s60 offen lds
    s_add_u32 s60, s60, 65536
    v_mfma_f32_16x16x32_bf16 a[204:207], a[132:135], a[36:39], a[204:207]
    s_add_u32 m0, s38, 110592
    ds_read_b64_tr_b16 a[156:157], v239 offset:40960
    ds_read_b64_tr_b16 a[158:159], v239 offset:45056
    v_mfma_f32_16x16x32_bf16 a[200:203], a[132:135], a[32:35], a[200:203]
    s_waitcnt lgkmcnt(8)
    v_mfma_f32_16x16x32_bf16 a[208:211], a[136:139], a[32:35], a[208:211]
    ds_read_b64_tr_b16 a[128:129], v236 offset:49152
    ds_read_b64_tr_b16 a[130:131], v236 offset:53248
    v_mfma_f32_16x16x32_bf16 a[212:215], a[136:139], a[36:39], a[212:215]
    buffer_load_dwordx4 v7, s[84:87], s60 offen lds
    s_add_u32 s60, s60, 65536
    v_mfma_f32_16x16x32_bf16 a[220:223], a[140:143], a[36:39], a[220:223]
    ds_read_b64_tr_b16 a[132:133], v237 offset:49152
    ds_read_b64_tr_b16 a[134:135], v237 offset:53248
    v_mfma_f32_16x16x32_bf16 a[216:219], a[140:143], a[32:35], a[216:219]
    s_waitcnt lgkmcnt(8)
    v_mfma_f32_16x16x32_bf16 a[192:195], a[144:147], a[40:43], a[192:195]
    ds_read_b64_tr_b16 a[136:137], v238 offset:49152
    ds_read_b64_tr_b16 a[138:139], v238 offset:53248
    v_mfma_f32_16x16x32_bf16 a[196:199], a[144:147], a[44:47], a[196:199]
    buffer_load_dwordx4 v[152:155], v2, s[16:19], s59 offen offset:2048 sc1
    v_mfma_f32_16x16x32_bf16 a[204:207], a[148:151], a[44:47], a[204:207]
    ds_read_b64_tr_b16 a[140:141], v239 offset:49152
    ds_read_b64_tr_b16 a[142:143], v239 offset:53248
    v_mfma_f32_16x16x32_bf16 a[200:203], a[148:151], a[40:43], a[200:203]
    s_waitcnt lgkmcnt(8)
    v_mfma_f32_16x16x32_bf16 a[208:211], a[152:155], a[40:43], a[208:211]
    ds_read_b64_tr_b16 a[144:145], v236 offset:57344
    ds_read_b64_tr_b16 a[146:147], v236 offset:61440
    v_mfma_f32_16x16x32_bf16 a[212:215], a[152:155], a[44:47], a[212:215]
    buffer_load_dwordx4 v[156:159], v3, s[16:19], s59 offen offset:2048 sc1
    v_mfma_f32_16x16x32_bf16 a[220:223], a[156:159], a[44:47], a[220:223]
    ds_read_b64_tr_b16 a[148:149], v237 offset:57344
    ds_read_b64_tr_b16 a[150:151], v237 offset:61440
    v_mfma_f32_16x16x32_bf16 a[216:219], a[156:159], a[40:43], a[216:219]
    s_waitcnt lgkmcnt(8)
    v_mfma_f32_16x16x32_bf16 a[192:195], a[128:131], a[48:51], a[192:195]
    ds_read_b64_tr_b16 a[152:153], v238 offset:57344
    ds_read_b64_tr_b16 a[154:155], v238 offset:61440
    v_mfma_f32_16x16x32_bf16 a[196:199], a[128:131], a[52:55], a[196:199]
    buffer_load_dwordx4 v[160:163], v2, s[16:19], s59 offen offset:3072 sc1
    v_mfma_f32_16x16x32_bf16 a[204:207], a[132:135], a[52:55], a[204:207]
    ds_read_b64_tr_b16 a[156:157], v239 offset:57344
    ds_read_b64_tr_b16 a[158:159], v239 offset:61440
    v_mfma_f32_16x16x32_bf16 a[200:203], a[132:135], a[48:51], a[200:203]
    s_barrier
    s_waitcnt lgkmcnt(8)
    v_mfma_f32_16x16x32_bf16 a[208:211], a[136:139], a[48:51], a[208:211]
    ds_read_b64_tr_b16 a[128:129], v232 offset:0
    ds_read_b64_tr_b16 a[130:131], v232 offset:4096
    v_mfma_f32_16x16x32_bf16 a[212:215], a[136:139], a[52:55], a[212:215]
    buffer_load_dwordx4 v[164:167], v3, s[16:19], s59 offen offset:3072 sc1
    s_add_u32 s59, s59, 4096
    v_mfma_f32_16x16x32_bf16 a[220:223], a[140:143], a[52:55], a[220:223]
    s_add_u32 m0, s38, 114688
    ds_read_b64_tr_b16 a[132:133], v233 offset:0
    ds_read_b64_tr_b16 a[134:135], v233 offset:4096
    v_mfma_f32_16x16x32_bf16 a[216:219], a[140:143], a[48:51], a[216:219]
    s_waitcnt vmcnt(36)
    s_waitcnt lgkmcnt(8)
    v_mfma_f32_16x16x32_bf16 a[192:195], a[144:147], a[56:59], a[192:195]
    ds_read_b64_tr_b16 a[136:137], v234 offset:0
    ds_read_b64_tr_b16 a[138:139], v234 offset:4096
    v_mfma_f32_16x16x32_bf16 a[196:199], a[144:147], a[60:63], a[196:199]
    buffer_load_dwordx4 v7, s[84:87], s60 offen lds
    s_add_u32 s60, s60, 65536
    v_mfma_f32_16x16x32_bf16 a[204:207], a[148:151], a[60:63], a[204:207]
    s_add_u32 m0, s38, 118784
    ds_read_b64_tr_b16 a[140:141], v235 offset:0
    ds_read_b64_tr_b16 a[142:143], v235 offset:4096
    v_mfma_f32_16x16x32_bf16 a[200:203], a[148:151], a[56:59], a[200:203]
    s_waitcnt lgkmcnt(8)
    v_mfma_f32_16x16x32_bf16 a[208:211], a[152:155], a[56:59], a[208:211]
    ds_read_b64_tr_b16 a[144:145], v232 offset:8192
    ds_read_b64_tr_b16 a[146:147], v232 offset:12288
    v_mfma_f32_16x16x32_bf16 a[212:215], a[152:155], a[60:63], a[212:215]
    buffer_load_dwordx4 v7, s[84:87], s60 offen lds
    s_add_u32 s60, s60, 65536
    v_mfma_f32_16x16x32_bf16 a[220:223], a[156:159], a[60:63], a[220:223]
    ds_read_b64_tr_b16 a[148:149], v233 offset:8192
    ds_read_b64_tr_b16 a[150:151], v233 offset:12288
    v_mfma_f32_16x16x32_bf16 a[216:219], a[156:159], a[56:59], a[216:219]
    s_waitcnt lgkmcnt(8)
    v_mfma_f32_16x16x32_bf16 a[160:163], a[128:131], a[0:3], a[160:163]
    ds_read_b64_tr_b16 a[152:153], v234 offset:8192
    ds_read_b64_tr_b16 a[154:155], v234 offset:12288
    v_mfma_f32_16x16x32_bf16 a[164:167], a[128:131], a[4:7], a[164:167]
    v_mfma_f32_16x16x32_bf16 a[172:175], a[132:135], a[4:7], a[172:175]
    ds_read_b64_tr_b16 a[156:157], v235 offset:8192
    ds_read_b64_tr_b16 a[158:159], v235 offset:12288
    v_mfma_f32_16x16x32_bf16 a[168:171], a[132:135], a[0:3], a[168:171]
    s_waitcnt lgkmcnt(8)
    v_mfma_f32_16x16x32_bf16 a[176:179], a[136:139], a[0:3], a[176:179]
    ds_read_b64_tr_b16 a[128:129], v232 offset:16384
    ds_read_b64_tr_b16 a[130:131], v232 offset:20480
    v_mfma_f32_16x16x32_bf16 a[180:183], a[136:139], a[4:7], a[180:183]
    buffer_store_dwordx4 a[192:195], v252, s[16:19], s58 offen offset:0 sc1
    v_mfma_f32_16x16x32_bf16 a[188:191], a[140:143], a[4:7], a[188:191]
    ds_read_b64_tr_b16 a[132:133], v233 offset:16384
    ds_read_b64_tr_b16 a[134:135], v233 offset:20480
    v_mfma_f32_16x16x32_bf16 a[184:187], a[140:143], a[0:3], a[184:187]
    buffer_store_dwordx4 a[196:199], v252, s[16:19], s58 offen offset:1024 sc1
    s_waitcnt lgkmcnt(8)
    v_mfma_f32_16x16x32_bf16 a[160:163], a[144:147], a[8:11], a[160:163]
    ds_read_b64_tr_b16 a[136:137], v234 offset:16384
    ds_read_b64_tr_b16 a[138:139], v234 offset:20480
    v_mfma_f32_16x16x32_bf16 a[164:167], a[144:147], a[12:15], a[164:167]
    buffer_load_dwordx4 v[168:171], v2, s[16:19], s59 offen offset:0 sc1
    v_mfma_f32_16x16x32_bf16 a[172:175], a[148:151], a[12:15], a[172:175]
    ds_read_b64_tr_b16 a[140:141], v235 offset:16384
    ds_read_b64_tr_b16 a[142:143], v235 offset:20480
    v_mfma_f32_16x16x32_bf16 a[168:171], a[148:151], a[8:11], a[168:171]
    buffer_load_dwordx4 v[172:175], v3, s[16:19], s59 offen offset:0 sc1
    s_waitcnt lgkmcnt(8)
    v_mfma_f32_16x16x32_bf16 a[176:179], a[152:155], a[8:11], a[176:179]
    ds_read_b64_tr_b16 a[144:145], v232 offset:24576
    ds_read_b64_tr_b16 a[146:147], v232 offset:28672
    v_mfma_f32_16x16x32_bf16 a[180:183], a[152:155], a[12:15], a[180:183]
    buffer_load_dwordx4 v[176:179], v2, s[16:19], s59 offen offset:1024 sc1
    v_mfma_f32_16x16x32_bf16 a[188:191], a[156:159], a[12:15], a[188:191]
    ds_read_b64_tr_b16 a[148:149], v233 offset:24576
    ds_read_b64_tr_b16 a[150:151], v233 offset:28672
    v_mfma_f32_16x16x32_bf16 a[184:187], a[156:159], a[8:11], a[184:187]
    s_waitcnt lgkmcnt(8)
    v_mfma_f32_16x16x32_bf16 a[160:163], a[128:131], a[16:19], a[160:163]
    ds_read_b64_tr_b16 a[152:153], v234 offset:24576
    ds_read_b64_tr_b16 a[154:155], v234 offset:28672
    v_mfma_f32_16x16x32_bf16 a[164:167], a[128:131], a[20:23], a[164:167]
    buffer_store_dwordx4 a[200:203], v252, s[16:19], s58 offen offset:2048 sc1
    v_mfma_f32_16x16x32_bf16 a[172:175], a[132:135], a[20:23], a[172:175]
    ds_read_b64_tr_b16 a[156:157], v235 offset:24576
    ds_read_b64_tr_b16 a[158:159], v235 offset:28672
    v_mfma_f32_16x16x32_bf16 a[168:171], a[132:135], a[16:19], a[168:171]
    buffer_store_dwordx4 a[204:207], v252, s[16:19], s58 offen offset:3072 sc1
    s_mov_b32 s58, s49
    s_barrier
    s_waitcnt lgkmcnt(8)
    v_mfma_f32_16x16x32_bf16 a[176:179], a[136:139], a[16:19], a[176:179]
    ds_read_b64_tr_b16 a[128:129], v232 offset:32768
    ds_read_b64_tr_b16 a[130:131], v232 offset:36864
    v_mfma_f32_16x16x32_bf16 a[180:183], a[136:139], a[20:23], a[180:183]
    buffer_load_dwordx4 v[180:183], v3, s[16:19], s59 offen offset:1024 sc1
    v_mfma_f32_16x16x32_bf16 a[188:191], a[140:143], a[20:23], a[188:191]
    s_add_u32 m0, s38, 122880
    ds_read_b64_tr_b16 a[132:133], v233 offset:32768
    ds_read_b64_tr_b16 a[134:135], v233 offset:36864
    v_mfma_f32_16x16x32_bf16 a[184:187], a[140:143], a[16:19], a[184:187]
    buffer_load_dwordx4 v7, s[84:87], s60 offen lds
    s_add_u32 s60, s60, 65536
    s_waitcnt lgkmcnt(8)
    v_mfma_f32_16x16x32_bf16 a[160:163], a[144:147], a[24:27], a[160:163]
    s_add_u32 m0, s38, 126976
    ds_read_b64_tr_b16 a[136:137], v234 offset:32768
    ds_read_b64_tr_b16 a[138:139], v234 offset:36864
    v_mfma_f32_16x16x32_bf16 a[164:167], a[144:147], a[28:31], a[164:167]
    buffer_load_dwordx4 v7, s[84:87], s60 offen lds
    s_add_u32 s60, s60, 65536
    v_mfma_f32_16x16x32_bf16 a[172:175], a[148:151], a[28:31], a[172:175]
    ds_read_b64_tr_b16 a[140:141], v235 offset:32768
    ds_read_b64_tr_b16 a[142:143], v235 offset:36864
    v_mfma_f32_16x16x32_bf16 a[168:171], a[148:151], a[24:27], a[168:171]
    s_waitcnt lgkmcnt(8)
    v_mfma_f32_16x16x32_bf16 a[176:179], a[152:155], a[24:27], a[176:179]
    ds_read_b64_tr_b16 a[144:145], v232 offset:40960
    ds_read_b64_tr_b16 a[146:147], v232 offset:45056
    v_mfma_f32_16x16x32_bf16 a[180:183], a[152:155], a[28:31], a[180:183]
    buffer_load_dwordx4 v[184:187], v2, s[16:19], s59 offen offset:2048 sc1
    v_mfma_f32_16x16x32_bf16 a[188:191], a[156:159], a[28:31], a[188:191]
    ds_read_b64_tr_b16 a[148:149], v233 offset:40960
    ds_read_b64_tr_b16 a[150:151], v233 offset:45056
    v_mfma_f32_16x16x32_bf16 a[184:187], a[156:159], a[24:27], a[184:187]
    s_waitcnt lgkmcnt(8)
    v_mfma_f32_16x16x32_bf16 a[160:163], a[128:131], a[32:35], a[160:163]
    ds_read_b64_tr_b16 a[152:153], v234 offset:40960
    ds_read_b64_tr_b16 a[154:155], v234 offset:45056
    v_mfma_f32_16x16x32_bf16 a[164:167], a[128:131], a[36:39], a[164:167]
    buffer_store_dwordx4 a[208:211], v252, s[16:19], s58 offen offset:0 sc1
    v_mfma_f32_16x16x32_bf16 a[172:175], a[132:135], a[36:39], a[172:175]
    ds_read_b64_tr_b16 a[156:157], v235 offset:40960
    ds_read_b64_tr_b16 a[158:159], v235 offset:45056
    v_mfma_f32_16x16x32_bf16 a[168:171], a[132:135], a[32:35], a[168:171]
    buffer_store_dwordx4 a[212:215], v252, s[16:19], s58 offen offset:1024 sc1
    s_waitcnt lgkmcnt(8)
    v_mfma_f32_16x16x32_bf16 a[176:179], a[136:139], a[32:35], a[176:179]
    ds_read_b64_tr_b16 a[128:129], v232 offset:49152
    ds_read_b64_tr_b16 a[130:131], v232 offset:53248
    v_mfma_f32_16x16x32_bf16 a[180:183], a[136:139], a[36:39], a[180:183]
    buffer_load_dwordx4 v[188:191], v3, s[16:19], s59 offen offset:2048 sc1
    v_mfma_f32_16x16x32_bf16 a[188:191], a[140:143], a[36:39], a[188:191]
    ds_read_b64_tr_b16 a[132:133], v233 offset:49152
    ds_read_b64_tr_b16 a[134:135], v233 offset:53248
    v_mfma_f32_16x16x32_bf16 a[184:187], a[140:143], a[32:35], a[184:187]
    s_waitcnt lgkmcnt(8)
    v_mfma_f32_16x16x32_bf16 a[160:163], a[144:147], a[40:43], a[160:163]
    ds_read_b64_tr_b16 a[136:137], v234 offset:49152
    ds_read_b64_tr_b16 a[138:139], v234 offset:53248
    v_mfma_f32_16x16x32_bf16 a[164:167], a[144:147], a[44:47], a[164:167]
    buffer_load_dwordx4 v[192:195], v2, s[16:19], s59 offen offset:3072 sc1
    v_mfma_f32_16x16x32_bf16 a[172:175], a[148:151], a[44:47], a[172:175]
    ds_read_b64_tr_b16 a[140:141], v235 offset:49152
    ds_read_b64_tr_b16 a[142:143], v235 offset:53248
    v_mfma_f32_16x16x32_bf16 a[168:171], a[148:151], a[40:43], a[168:171]
    s_waitcnt lgkmcnt(8)
    v_mfma_f32_16x16x32_bf16 a[176:179], a[152:155], a[40:43], a[176:179]
    ds_read_b64_tr_b16 a[144:145], v232 offset:57344
    ds_read_b64_tr_b16 a[146:147], v232 offset:61440
    v_mfma_f32_16x16x32_bf16 a[180:183], a[152:155], a[44:47], a[180:183]
    buffer_load_dwordx4 v[196:199], v3, s[16:19], s59 offen offset:3072 sc1
    s_add_u32 s59, s59, 4096
    v_mfma_f32_16x16x32_bf16 a[188:191], a[156:159], a[44:47], a[188:191]
    ds_read_b64_tr_b16 a[148:149], v233 offset:57344
    ds_read_b64_tr_b16 a[150:151], v233 offset:61440
    v_mfma_f32_16x16x32_bf16 a[184:187], a[156:159], a[40:43], a[184:187]
    s_waitcnt lgkmcnt(8)
    v_mfma_f32_16x16x32_bf16 a[160:163], a[128:131], a[48:51], a[160:163]
    ds_read_b64_tr_b16 a[152:153], v234 offset:57344
    ds_read_b64_tr_b16 a[154:155], v234 offset:61440
    v_mfma_f32_16x16x32_bf16 a[164:167], a[128:131], a[52:55], a[164:167]
    buffer_store_dwordx4 a[216:219], v252, s[16:19], s58 offen offset:2048 sc1
    v_mfma_f32_16x16x32_bf16 a[172:175], a[132:135], a[52:55], a[172:175]
    ds_read_b64_tr_b16 a[156:157], v235 offset:57344
    ds_read_b64_tr_b16 a[158:159], v235 offset:61440
    v_mfma_f32_16x16x32_bf16 a[168:171], a[132:135], a[48:51], a[168:171]
    buffer_store_dwordx4 a[220:223], v252, s[16:19], s58 offen offset:3072 sc1
    s_waitcnt vmcnt(48)
    s_barrier
    s_waitcnt lgkmcnt(8)
    v_mfma_f32_16x16x32_bf16 a[176:179], a[136:139], a[48:51], a[176:179]
    s_add_u32 m0, s38, 0
    ds_read_b64_tr_b16 a[128:129], v32 offset:0
    ds_read_b64_tr_b16 a[130:131], v32 offset:2048
    v_mfma_f32_16x16x32_bf16 a[180:183], a[136:139], a[52:55], a[180:183]
    buffer_load_dwordx4 v7, s[84:87], s60 offen lds
    s_add_u32 s60, s60, 65536
    v_mfma_f32_16x16x32_bf16 a[188:191], a[140:143], a[52:55], a[188:191]
    s_add_u32 m0, s38, 4096
    ds_read_b64_tr_b16 a[132:133], v33 offset:0
    ds_read_b64_tr_b16 a[134:135], v33 offset:2048
    v_mfma_f32_16x16x32_bf16 a[184:187], a[140:143], a[48:51], a[184:187]
    s_waitcnt lgkmcnt(8)
    v_mfma_f32_16x16x32_bf16 a[160:163], a[144:147], a[56:59], a[160:163]
    ds_read_b64_tr_b16 a[136:137], v34 offset:0
    ds_read_b64_tr_b16 a[138:139], v34 offset:2048
    v_mfma_f32_16x16x32_bf16 a[164:167], a[144:147], a[60:63], a[164:167]
    buffer_load_dwordx4 v7, s[84:87], s60 offen lds
    s_add_u32 s60, s60, 65536
    v_mfma_f32_16x16x32_bf16 a[172:175], a[148:151], a[60:63], a[172:175]
    ds_read_b64_tr_b16 a[140:141], v35 offset:0
    ds_read_b64_tr_b16 a[142:143], v35 offset:2048
    v_mfma_f32_16x16x32_bf16 a[168:171], a[148:151], a[56:59], a[168:171]
    s_waitcnt lgkmcnt(8)
    v_mfma_f32_16x16x32_bf16 a[176:179], a[152:155], a[56:59], a[176:179]
    ds_read_b64_tr_b16 a[144:145], v32 offset:4096
    ds_read_b64_tr_b16 a[146:147], v32 offset:6144
    v_mfma_f32_16x16x32_bf16 a[180:183], a[152:155], a[60:63], a[180:183]
    buffer_load_dwordx4 v[200:203], v2, s[16:19], s59 offen offset:0 sc1
    v_mfma_f32_16x16x32_bf16 a[188:191], a[156:159], a[60:63], a[188:191]
    ds_read_b64_tr_b16 a[148:149], v33 offset:4096
    ds_read_b64_tr_b16 a[150:151], v33 offset:6144
    v_mfma_f32_16x16x32_bf16 a[184:187], a[156:159], a[56:59], a[184:187]
    s_waitcnt lgkmcnt(8)
    v_mfma_f32_16x16x32_bf16 a[160:163], a[128:131], v[72:75], a[160:163]
    ds_read_b64_tr_b16 a[152:153], v34 offset:4096
    ds_read_b64_tr_b16 a[154:155], v34 offset:6144
    v_mfma_f32_16x16x32_bf16 a[164:167], a[128:131], v[76:79], a[164:167]
    buffer_load_dwordx4 v[204:207], v3, s[16:19], s59 offen offset:0 sc1
    v_mfma_f32_16x16x32_bf16 a[172:175], a[132:135], v[76:79], a[172:175]
    ds_read_b64_tr_b16 a[156:157], v35 offset:4096
    ds_read_b64_tr_b16 a[158:159], v35 offset:6144
    v_mfma_f32_16x16x32_bf16 a[168:171], a[132:135], v[72:75], a[168:171]
    buffer_load_dwordx4 v[208:211], v2, s[16:19], s59 offen offset:1024 sc1
    s_waitcnt lgkmcnt(8)
    v_mfma_f32_16x16x32_bf16 a[176:179], a[136:139], v[72:75], a[176:179]
    ds_read_b64_tr_b16 a[128:129], v32 offset:8192
    ds_read_b64_tr_b16 a[130:131], v32 offset:10240
    v_mfma_f32_16x16x32_bf16 a[180:183], a[136:139], v[76:79], a[180:183]
    buffer_load_dwordx4 v[212:215], v3, s[16:19], s59 offen offset:1024 sc1
    v_mfma_f32_16x16x32_bf16 a[188:191], a[140:143], v[76:79], a[188:191]
    s_add_u32 m0, s38, 8192
    ds_read_b64_tr_b16 a[132:133], v33 offset:8192
    ds_read_b64_tr_b16 a[134:135], v33 offset:10240
    v_mfma_f32_16x16x32_bf16 a[184:187], a[140:143], v[72:75], a[184:187]
    s_waitcnt lgkmcnt(8)
    v_mfma_f32_16x16x32_bf16 a[160:163], a[144:147], v[80:83], a[160:163]
    ds_read_b64_tr_b16 a[136:137], v34 offset:8192
    ds_read_b64_tr_b16 a[138:139], v34 offset:10240
    v_mfma_f32_16x16x32_bf16 a[164:167], a[144:147], v[84:87], a[164:167]
    buffer_load_dwordx4 v7, s[84:87], s60 offen lds
    s_add_u32 s60, s60, 65536
    v_mfma_f32_16x16x32_bf16 a[172:175], a[148:151], v[84:87], a[172:175]
    s_add_u32 m0, s38, 12288
    ds_read_b64_tr_b16 a[140:141], v35 offset:8192
    ds_read_b64_tr_b16 a[142:143], v35 offset:10240
    v_mfma_f32_16x16x32_bf16 a[168:171], a[148:151], v[80:83], a[168:171]
    s_waitcnt lgkmcnt(8)
    v_mfma_f32_16x16x32_bf16 a[176:179], a[152:155], v[80:83], a[176:179]
    ds_read_b64_tr_b16 a[144:145], v32 offset:12288
    ds_read_b64_tr_b16 a[146:147], v32 offset:14336
    v_mfma_f32_16x16x32_bf16 a[180:183], a[152:155], v[84:87], a[180:183]
    buffer_load_dwordx4 v7, s[84:87], s60 offen lds
    s_add_u32 s60, s60, 65536
    v_mfma_f32_16x16x32_bf16 a[188:191], a[156:159], v[84:87], a[188:191]
    ds_read_b64_tr_b16 a[148:149], v33 offset:12288
    ds_read_b64_tr_b16 a[150:151], v33 offset:14336
    v_mfma_f32_16x16x32_bf16 a[184:187], a[156:159], v[80:83], a[184:187]
    s_waitcnt vmcnt(52)
    s_waitcnt lgkmcnt(8)
    v_mfma_f32_16x16x32_bf16 a[160:163], a[128:131], v[88:91], a[160:163]
    ds_read_b64_tr_b16 a[152:153], v34 offset:12288
    ds_read_b64_tr_b16 a[154:155], v34 offset:14336
    v_mfma_f32_16x16x32_bf16 a[164:167], a[128:131], v[92:95], a[164:167]
    buffer_load_dwordx4 v[216:219], v2, s[16:19], s59 offen offset:2048 sc1
    v_mfma_f32_16x16x32_bf16 a[172:175], a[132:135], v[92:95], a[172:175]
    ds_read_b64_tr_b16 a[156:157], v35 offset:12288
    ds_read_b64_tr_b16 a[158:159], v35 offset:14336
    v_mfma_f32_16x16x32_bf16 a[168:171], a[132:135], v[88:91], a[168:171]
    s_waitcnt vmcnt(45)
    s_barrier
    s_waitcnt lgkmcnt(8)
    v_mfma_f32_16x16x32_bf16 a[176:179], a[136:139], v[88:91], a[176:179]
    ds_read_b64_tr_b16 a[128:129], v32 offset:16384
    ds_read_b64_tr_b16 a[130:131], v32 offset:18432
    v_mfma_f32_16x16x32_bf16 a[180:183], a[136:139], v[92:95], a[180:183]
    buffer_load_dwordx4 v[220:223], v3, s[16:19], s59 offen offset:2048 sc1
    v_mfma_f32_16x16x32_bf16 a[188:191], a[140:143], v[92:95], a[188:191]
    ds_read_b64_tr_b16 a[132:133], v33 offset:16384
    ds_read_b64_tr_b16 a[134:135], v33 offset:18432
    v_mfma_f32_16x16x32_bf16 a[184:187], a[140:143], v[88:91], a[184:187]
    s_waitcnt lgkmcnt(8)
    v_mfma_f32_16x16x32_bf16 a[160:163], a[144:147], v[96:99], a[160:163]
    ds_read_b64_tr_b16 a[136:137], v34 offset:16384
    ds_read_b64_tr_b16 a[138:139], v34 offset:18432
    v_mfma_f32_16x16x32_bf16 a[164:167], a[144:147], v[100:103], a[164:167]
    buffer_load_dwordx4 v[224:227], v2, s[16:19], s59 offen offset:3072 sc1
    v_mfma_f32_16x16x32_bf16 a[172:175], a[148:151], v[100:103], a[172:175]
    ds_read_b64_tr_b16 a[140:141], v35 offset:16384
    ds_read_b64_tr_b16 a[142:143], v35 offset:18432
    v_mfma_f32_16x16x32_bf16 a[168:171], a[148:151], v[96:99], a[168:171]
    s_waitcnt lgkmcnt(8)
    v_mfma_f32_16x16x32_bf16 a[176:179], a[152:155], v[96:99], a[176:179]
    ds_read_b64_tr_b16 a[144:145], v32 offset:20480
    ds_read_b64_tr_b16 a[146:147], v32 offset:22528
    v_mfma_f32_16x16x32_bf16 a[180:183], a[152:155], v[100:103], a[180:183]
    buffer_load_dwordx4 v[228:231], v3, s[16:19], s59 offen offset:3072 sc1
    s_add_u32 s59, s59, 4096
    v_mfma_f32_16x16x32_bf16 a[188:191], a[156:159], v[100:103], a[188:191]
    ds_read_b64_tr_b16 a[148:149], v33 offset:20480
    ds_read_b64_tr_b16 a[150:151], v33 offset:22528
    v_mfma_f32_16x16x32_bf16 a[184:187], a[156:159], v[96:99], a[184:187]
    s_waitcnt lgkmcnt(8)
    v_mfma_f32_16x16x32_bf16 a[160:163], a[128:131], v[104:107], a[160:163]
    s_add_u32 m0, s38, 16384
    ds_read_b64_tr_b16 a[152:153], v34 offset:20480
    ds_read_b64_tr_b16 a[154:155], v34 offset:22528
    v_mfma_f32_16x16x32_bf16 a[164:167], a[128:131], v[108:111], a[164:167]
    buffer_load_dwordx4 v7, s[84:87], s60 offen lds
    s_add_u32 s60, s60, 65536
    v_mfma_f32_16x16x32_bf16 a[172:175], a[132:135], v[108:111], a[172:175]
    s_add_u32 m0, s38, 20480
    ds_read_b64_tr_b16 a[156:157], v35 offset:20480
    ds_read_b64_tr_b16 a[158:159], v35 offset:22528
    v_mfma_f32_16x16x32_bf16 a[168:171], a[132:135], v[104:107], a[168:171]
    s_waitcnt lgkmcnt(8)
    v_mfma_f32_16x16x32_bf16 a[176:179], a[136:139], v[104:107], a[176:179]
    ds_read_b64_tr_b16 a[128:129], v32 offset:24576
    ds_read_b64_tr_b16 a[130:131], v32 offset:26624
    v_mfma_f32_16x16x32_bf16 a[180:183], a[136:139], v[108:111], a[180:183]
    buffer_load_dwordx4 v7, s[84:87], s60 offen lds
    s_add_u32 s60, s60, 65536
    v_mfma_f32_16x16x32_bf16 a[188:191], a[140:143], v[108:111], a[188:191]
    ds_read_b64_tr_b16 a[132:133], v33 offset:24576
    ds_read_b64_tr_b16 a[134:135], v33 offset:26624
    v_mfma_f32_16x16x32_bf16 a[184:187], a[140:143], v[104:107], a[184:187]
    s_waitcnt lgkmcnt(8)
    v_mfma_f32_16x16x32_bf16 a[160:163], a[144:147], v[112:115], a[160:163]
    ds_read_b64_tr_b16 a[136:137], v34 offset:24576
    ds_read_b64_tr_b16 a[138:139], v34 offset:26624
    v_mfma_f32_16x16x32_bf16 a[164:167], a[144:147], v[116:119], a[164:167]
    buffer_load_dwordx4 a[64:67], v2, s[16:19], s59 offen offset:0 sc1
    v_mfma_f32_16x16x32_bf16 a[172:175], a[148:151], v[116:119], a[172:175]
    ds_read_b64_tr_b16 a[140:141], v35 offset:24576
    ds_read_b64_tr_b16 a[142:143], v35 offset:26624
    v_mfma_f32_16x16x32_bf16 a[168:171], a[148:151], v[112:115], a[168:171]
    s_waitcnt lgkmcnt(8)
    v_mfma_f32_16x16x32_bf16 a[176:179], a[152:155], v[112:115], a[176:179]
    ds_read_b64_tr_b16 a[144:145], v32 offset:28672
    ds_read_b64_tr_b16 a[146:147], v32 offset:30720
    v_mfma_f32_16x16x32_bf16 a[180:183], a[152:155], v[116:119], a[180:183]
    buffer_load_dwordx4 a[68:71], v3, s[16:19], s59 offen offset:0 sc1
    v_mfma_f32_16x16x32_bf16 a[188:191], a[156:159], v[116:119], a[188:191]
    ds_read_b64_tr_b16 a[148:149], v33 offset:28672
    ds_read_b64_tr_b16 a[150:151], v33 offset:30720
    v_mfma_f32_16x16x32_bf16 a[184:187], a[156:159], v[112:115], a[184:187]
    s_waitcnt vmcnt(48)
    s_waitcnt lgkmcnt(8)
    v_mfma_f32_16x16x32_bf16 a[160:163], a[128:131], v[120:123], a[160:163]
    ds_read_b64_tr_b16 a[152:153], v34 offset:28672
    ds_read_b64_tr_b16 a[154:155], v34 offset:30720
    v_mfma_f32_16x16x32_bf16 a[164:167], a[128:131], v[124:127], a[164:167]
    buffer_load_dwordx4 a[72:75], v2, s[16:19], s59 offen offset:1024 sc1
    v_mfma_f32_16x16x32_bf16 a[172:175], a[132:135], v[124:127], a[172:175]
    ds_read_b64_tr_b16 a[156:157], v35 offset:28672
    ds_read_b64_tr_b16 a[158:159], v35 offset:30720
    v_mfma_f32_16x16x32_bf16 a[168:171], a[132:135], v[120:123], a[168:171]
    buffer_load_dwordx4 a[76:79], v3, s[16:19], s59 offen offset:1024 sc1
    s_waitcnt vmcnt(18)
    s_barrier
    s_mov_b64 exec, 1
    buffer_store_dwordx2 v[250:251], off, s[16:19], s55 sc1
    s_mov_b64 exec, -1
    s_waitcnt lgkmcnt(8)
    v_mfma_f32_16x16x32_bf16 a[176:179], a[136:139], v[120:123], a[176:179]
    s_add_u32 m0, s38, 24576
    ds_read_b64_tr_b16 a[128:129], v32 offset:32768
    ds_read_b64_tr_b16 a[130:131], v32 offset:34816
    v_mfma_f32_16x16x32_bf16 a[180:183], a[136:139], v[124:127], a[180:183]
    buffer_load_dwordx4 v7, s[84:87], s60 offen lds
    s_add_u32 s60, s60, 65536
    v_mfma_f32_16x16x32_bf16 a[188:191], a[140:143], v[124:127], a[188:191]
    s_add_u32 m0, s38, 28672
    ds_read_b64_tr_b16 a[132:133], v33 offset:32768
    ds_read_b64_tr_b16 a[134:135], v33 offset:34816
    v_mfma_f32_16x16x32_bf16 a[184:187], a[140:143], v[120:123], a[184:187]
    s_waitcnt lgkmcnt(8)
    v_mfma_f32_16x16x32_bf16 a[160:163], a[144:147], v[128:131], a[160:163]
    ds_read_b64_tr_b16 a[136:137], v34 offset:32768
    ds_read_b64_tr_b16 a[138:139], v34 offset:34816
    v_mfma_f32_16x16x32_bf16 a[164:167], a[144:147], v[132:135], a[164:167]
    buffer_load_dwordx4 v7, s[84:87], s60 offen lds
    s_add_u32 s60, s60, 65536
    v_mfma_f32_16x16x32_bf16 a[172:175], a[148:151], v[132:135], a[172:175]
    ds_read_b64_tr_b16 a[140:141], v35 offset:32768
    ds_read_b64_tr_b16 a[142:143], v35 offset:34816
    v_mfma_f32_16x16x32_bf16 a[168:171], a[148:151], v[128:131], a[168:171]
    s_waitcnt lgkmcnt(8)
    v_mfma_f32_16x16x32_bf16 a[176:179], a[152:155], v[128:131], a[176:179]
    ds_read_b64_tr_b16 a[144:145], v32 offset:36864
    ds_read_b64_tr_b16 a[146:147], v32 offset:38912
    v_mfma_f32_16x16x32_bf16 a[180:183], a[152:155], v[132:135], a[180:183]
    buffer_load_dwordx4 a[80:83], v2, s[16:19], s59 offen offset:2048 sc1
    v_mfma_f32_16x16x32_bf16 a[188:191], a[156:159], v[132:135], a[188:191]
    ds_read_b64_tr_b16 a[148:149], v33 offset:36864
    ds_read_b64_tr_b16 a[150:151], v33 offset:38912
    v_mfma_f32_16x16x32_bf16 a[184:187], a[156:159], v[128:131], a[184:187]
    s_waitcnt lgkmcnt(8)
    v_mfma_f32_16x16x32_bf16 a[160:163], a[128:131], v[136:139], a[160:163]
    ds_read_b64_tr_b16 a[152:153], v34 offset:36864
    ds_read_b64_tr_b16 a[154:155], v34 offset:38912
    v_mfma_f32_16x16x32_bf16 a[164:167], a[128:131], v[140:143], a[164:167]
    buffer_load_dwordx4 a[84:87], v3, s[16:19], s59 offen offset:2048 sc1
    v_mfma_f32_16x16x32_bf16 a[172:175], a[132:135], v[140:143], a[172:175]
    ds_read_b64_tr_b16 a[156:157], v35 offset:36864
    ds_read_b64_tr_b16 a[158:159], v35 offset:38912
    v_mfma_f32_16x16x32_bf16 a[168:171], a[132:135], v[136:139], a[168:171]
    s_waitcnt lgkmcnt(8)
    v_mfma_f32_16x16x32_bf16 a[176:179], a[136:139], v[136:139], a[176:179]
    ds_read_b64_tr_b16 a[128:129], v32 offset:40960
    ds_read_b64_tr_b16 a[130:131], v32 offset:43008
    v_mfma_f32_16x16x32_bf16 a[180:183], a[136:139], v[140:143], a[180:183]
    buffer_load_dwordx4 a[88:91], v2, s[16:19], s59 offen offset:3072 sc1
    v_mfma_f32_16x16x32_bf16 a[188:191], a[140:143], v[140:143], a[188:191]
    ds_read_b64_tr_b16 a[132:133], v33 offset:40960
    ds_read_b64_tr_b16 a[134:135], v33 offset:43008
    v_mfma_f32_16x16x32_bf16 a[184:187], a[140:143], v[136:139], a[184:187]
    s_waitcnt lgkmcnt(8)
    v_mfma_f32_16x16x32_bf16 a[160:163], a[144:147], v[144:147], a[160:163]
    ds_read_b64_tr_b16 a[136:137], v34 offset:40960
    ds_read_b64_tr_b16 a[138:139], v34 offset:43008
    v_mfma_f32_16x16x32_bf16 a[164:167], a[144:147], v[148:151], a[164:167]
    buffer_load_dwordx4 a[92:95], v3, s[16:19], s59 offen offset:3072 sc1
    s_add_u32 s59, s59, 4096
    v_mfma_f32_16x16x32_bf16 a[172:175], a[148:151], v[148:151], a[172:175]
    s_add_u32 m0, s38, 32768
    ds_read_b64_tr_b16 a[140:141], v35 offset:40960
    ds_read_b64_tr_b16 a[142:143], v35 offset:43008
    v_mfma_f32_16x16x32_bf16 a[168:171], a[148:151], v[144:147], a[168:171]
    s_waitcnt lgkmcnt(8)
    v_mfma_f32_16x16x32_bf16 a[176:179], a[152:155], v[144:147], a[176:179]
    ds_read_b64_tr_b16 a[144:145], v32 offset:45056
    ds_read_b64_tr_b16 a[146:147], v32 offset:47104
    v_mfma_f32_16x16x32_bf16 a[180:183], a[152:155], v[148:151], a[180:183]
    buffer_load_dwordx4 v7, s[84:87], s60 offen lds
    s_add_u32 s60, s60, 65536
    v_mfma_f32_16x16x32_bf16 a[188:191], a[156:159], v[148:151], a[188:191]
    ds_read_b64_tr_b16 a[148:149], v33 offset:45056
    ds_read_b64_tr_b16 a[150:151], v33 offset:47104
    v_mfma_f32_16x16x32_bf16 a[184:187], a[156:159], v[144:147], a[184:187]
    s_waitcnt lgkmcnt(8)
    v_mfma_f32_16x16x32_bf16 a[160:163], a[128:131], v[152:155], a[160:163]
    s_add_u32 m0, s38, 36864
    ds_read_b64_tr_b16 a[152:153], v34 offset:45056
    ds_read_b64_tr_b16 a[154:155], v34 offset:47104
    v_mfma_f32_16x16x32_bf16 a[164:167], a[128:131], v[156:159], a[164:167]
    buffer_load_dwordx4 v7, s[84:87], s60 offen lds
    s_add_u32 s60, s60, 65536
    v_mfma_f32_16x16x32_bf16 a[172:175], a[132:135], v[156:159], a[172:175]
    ds_read_b64_tr_b16 a[156:157], v35 offset:45056
    ds_read_b64_tr_b16 a[158:159], v35 offset:47104
    v_mfma_f32_16x16x32_bf16 a[168:171], a[132:135], v[152:155], a[168:171]
    s_barrier
    s_waitcnt lgkmcnt(8)
    v_mfma_f32_16x16x32_bf16 a[176:179], a[136:139], v[152:155], a[176:179]
    ds_read_b64_tr_b16 a[128:129], v32 offset:49152
    ds_read_b64_tr_b16 a[130:131], v32 offset:51200
    v_mfma_f32_16x16x32_bf16 a[180:183], a[136:139], v[156:159], a[180:183]
    buffer_load_dwordx4 a[96:99], v2, s[16:19], s59 offen offset:0 sc1
    v_mfma_f32_16x16x32_bf16 a[188:191], a[140:143], v[156:159], a[188:191]
    ds_read_b64_tr_b16 a[132:133], v33 offset:49152
    ds_read_b64_tr_b16 a[134:135], v33 offset:51200
    v_mfma_f32_16x16x32_bf16 a[184:187], a[140:143], v[152:155], a[184:187]
    s_waitcnt lgkmcnt(8)
    v_mfma_f32_16x16x32_bf16 a[160:163], a[144:147], v[160:163], a[160:163]
    ds_read_b64_tr_b16 a[136:137], v34 offset:49152
    ds_read_b64_tr_b16 a[138:139], v34 offset:51200
    v_mfma_f32_16x16x32_bf16 a[164:167], a[144:147], v[164:167], a[164:167]
    buffer_load_dwordx4 a[100:103], v3, s[16:19], s59 offen offset:0 sc1
    v_mfma_f32_16x16x32_bf16 a[172:175], a[148:151], v[164:167], a[172:175]
    ds_read_b64_tr_b16 a[140:141], v35 offset:49152
    ds_read_b64_tr_b16 a[142:143], v35 offset:51200
    v_mfma_f32_16x16x32_bf16 a[168:171], a[148:151], v[160:163], a[168:171]
    s_waitcnt lgkmcnt(8)
    v_mfma_f32_16x16x32_bf16 a[176:179], a[152:155], v[160:163], a[176:179]
    ds_read_b64_tr_b16 a[144:145], v32 offset:53248
    ds_read_b64_tr_b16 a[146:147], v32 offset:55296
    v_mfma_f32_16x16x32_bf16 a[180:183], a[152:155], v[164:167], a[180:183]
    buffer_load_dwordx4 a[104:107], v2, s[16:19], s59 offen offset:1024 sc1
    v_mfma_f32_16x16x32_bf16 a[188:191], a[156:159], v[164:167], a[188:191]
    ds_read_b64_tr_b16 a[148:149], v33 offset:53248
    ds_read_b64_tr_b16 a[150:151], v33 offset:55296
    v_mfma_f32_16x16x32_bf16 a[184:187], a[156:159], v[160:163], a[184:187]
    s_waitcnt lgkmcnt(8)
    v_mfma_f32_16x16x32_bf16 a[160:163], a[128:131], v[168:171], a[160:163]
    ds_read_b64_tr_b16 a[152:153], v34 offset:53248
    ds_read_b64_tr_b16 a[154:155], v34 offset:55296
    v_mfma_f32_16x16x32_bf16 a[164:167], a[128:131], v[172:175], a[164:167]
    buffer_load_dwordx4 a[108:111], v3, s[16:19], s59 offen offset:1024 sc1
    v_mfma_f32_16x16x32_bf16 a[172:175], a[132:135], v[172:175], a[172:175]
    s_add_u32 m0, s38, 40960
    ds_read_b64_tr_b16 a[156:157], v35 offset:53248
    ds_read_b64_tr_b16 a[158:159], v35 offset:55296
    v_mfma_f32_16x16x32_bf16 a[168:171], a[132:135], v[168:171], a[168:171]
    s_waitcnt lgkmcnt(8)
    v_mfma_f32_16x16x32_bf16 a[176:179], a[136:139], v[168:171], a[176:179]
    ds_read_b64_tr_b16 a[128:129], v32 offset:57344
    ds_read_b64_tr_b16 a[130:131], v32 offset:59392
    v_mfma_f32_16x16x32_bf16 a[180:183], a[136:139], v[172:175], a[180:183]
    buffer_load_dwordx4 v7, s[84:87], s60 offen lds
    s_add_u32 s60, s60, 65536
    v_mfma_f32_16x16x32_bf16 a[188:191], a[140:143], v[172:175], a[188:191]
    s_add_u32 m0, s38, 45056
    ds_read_b64_tr_b16 a[132:133], v33 offset:57344
    ds_read_b64_tr_b16 a[134:135], v33 offset:59392
    v_mfma_f32_16x16x32_bf16 a[184:187], a[140:143], v[168:171], a[184:187]
    s_waitcnt lgkmcnt(8)
    v_mfma_f32_16x16x32_bf16 a[160:163], a[144:147], v[176:179], a[160:163]
    ds_read_b64_tr_b16 a[136:137], v34 offset:57344
    ds_read_b64_tr_b16 a[138:139], v34 offset:59392
    v_mfma_f32_16x16x32_bf16 a[164:167], a[144:147], v[180:183], a[164:167]
    buffer_load_dwordx4 v7, s[84:87], s60 offen lds
    s_add_u32 s60, s60, 65536
    v_mfma_f32_16x16x32_bf16 a[172:175], a[148:151], v[180:183], a[172:175]
    ds_read_b64_tr_b16 a[140:141], v35 offset:57344
    ds_read_b64_tr_b16 a[142:143], v35 offset:59392
    v_mfma_f32_16x16x32_bf16 a[168:171], a[148:151], v[176:179], a[168:171]
    s_waitcnt lgkmcnt(8)
    v_mfma_f32_16x16x32_bf16 a[176:179], a[152:155], v[176:179], a[176:179]
    ds_read_b64_tr_b16 a[144:145], v32 offset:61440
    ds_read_b64_tr_b16 a[146:147], v32 offset:63488
    v_mfma_f32_16x16x32_bf16 a[180:183], a[152:155], v[180:183], a[180:183]
    buffer_load_dwordx4 a[112:115], v2, s[16:19], s59 offen offset:2048 sc1
    v_mfma_f32_16x16x32_bf16 a[188:191], a[156:159], v[180:183], a[188:191]
    ds_read_b64_tr_b16 a[148:149], v33 offset:61440
    ds_read_b64_tr_b16 a[150:151], v33 offset:63488
    v_mfma_f32_16x16x32_bf16 a[184:187], a[156:159], v[176:179], a[184:187]
    s_waitcnt lgkmcnt(8)
    v_mfma_f32_16x16x32_bf16 a[160:163], a[128:131], v[184:187], a[160:163]
    ds_read_b64_tr_b16 a[152:153], v34 offset:61440
    ds_read_b64_tr_b16 a[154:155], v34 offset:63488
    v_mfma_f32_16x16x32_bf16 a[164:167], a[128:131], v[188:191], a[164:167]
    buffer_load_dwordx4 a[116:119], v3, s[16:19], s59 offen offset:2048 sc1
    v_mfma_f32_16x16x32_bf16 a[172:175], a[132:135], v[188:191], a[172:175]
    ds_read_b64_tr_b16 a[156:157], v35 offset:61440
    ds_read_b64_tr_b16 a[158:159], v35 offset:63488
    v_mfma_f32_16x16x32_bf16 a[168:171], a[132:135], v[184:187], a[168:171]
    buffer_load_dwordx4 a[120:123], v2, s[16:19], s59 offen offset:3072 sc1
    s_waitcnt vmcnt(28)
    s_barrier
    s_waitcnt lgkmcnt(8)
    v_mfma_f32_16x16x32_bf16 a[176:179], a[136:139], v[184:187], a[176:179]
    ds_read_b64_tr_b16 a[128:129], v28 offset:0
    ds_read_b64_tr_b16 a[130:131], v28 offset:2048
    v_mfma_f32_16x16x32_bf16 a[180:183], a[136:139], v[188:191], a[180:183]
    buffer_load_dwordx4 a[124:127], v3, s[16:19], s59 offen offset:3072 sc1
    s_add_u32 s59, s59, 4096
    v_mfma_f32_16x16x32_bf16 a[188:191], a[140:143], v[188:191], a[188:191]
    s_add_u32 m0, s38, 49152
    ds_read_b64_tr_b16 a[132:133], v29 offset:0
    ds_read_b64_tr_b16 a[134:135], v29 offset:2048
    v_mfma_f32_16x16x32_bf16 a[184:187], a[140:143], v[184:187], a[184:187]
    s_waitcnt lgkmcnt(8)
    v_mfma_f32_16x16x32_bf16 a[160:163], a[144:147], v[192:195], a[160:163]
    ds_read_b64_tr_b16 a[136:137], v30 offset:0
    ds_read_b64_tr_b16 a[138:139], v30 offset:2048
    v_mfma_f32_16x16x32_bf16 a[164:167], a[144:147], v[196:199], a[164:167]
    buffer_load_dwordx4 v7, s[84:87], s60 offen lds
    s_add_u32 s60, s60, 65536
    v_mfma_f32_16x16x32_bf16 a[172:175], a[148:151], v[196:199], a[172:175]
    s_add_u32 m0, s38, 53248
    ds_read_b64_tr_b16 a[140:141], v31 offset:0
    ds_read_b64_tr_b16 a[142:143], v31 offset:2048
    v_mfma_f32_16x16x32_bf16 a[168:171], a[148:151], v[192:195], a[168:171]
    s_waitcnt lgkmcnt(8)
    v_mfma_f32_16x16x32_bf16 a[176:179], a[152:155], v[192:195], a[176:179]
    ds_read_b64_tr_b16 a[144:145], v28 offset:4096
    ds_read_b64_tr_b16 a[146:147], v28 offset:6144
    v_mfma_f32_16x16x32_bf16 a[180:183], a[152:155], v[196:199], a[180:183]
    buffer_load_dwordx4 v7, s[84:87], s60 offen lds
    s_add_u32 s60, s60, 65536
    v_mfma_f32_16x16x32_bf16 a[188:191], a[156:159], v[196:199], a[188:191]
    ds_read_b64_tr_b16 a[148:149], v29 offset:4096
    ds_read_b64_tr_b16 a[150:151], v29 offset:6144
    v_mfma_f32_16x16x32_bf16 a[184:187], a[156:159], v[192:195], a[184:187]
    s_waitcnt lgkmcnt(8)
    v_mfma_f32_16x16x32_bf16 a[160:163], a[128:131], v[200:203], a[160:163]
    ds_read_b64_tr_b16 a[152:153], v30 offset:4096
    ds_read_b64_tr_b16 a[154:155], v30 offset:6144
    v_mfma_f32_16x16x32_bf16 a[164:167], a[128:131], v[204:207], a[164:167]
    buffer_load_dwordx2 v[8:9], v38, s[16:19], s56 offen sc1
    v_mfma_f32_16x16x32_bf16 a[172:175], a[132:135], v[204:207], a[172:175]
    ds_read_b64_tr_b16 a[156:157], v31 offset:4096
    ds_read_b64_tr_b16 a[158:159], v31 offset:6144
    v_mfma_f32_16x16x32_bf16 a[168:171], a[132:135], v[200:203], a[168:171]
    buffer_load_dwordx4 a[0:3], v2, s[16:19], s59 offen offset:0 sc1
    s_waitcnt lgkmcnt(8)
    v_mfma_f32_16x16x32_bf16 a[176:179], a[136:139], v[200:203], a[176:179]
    ds_read_b64_tr_b16 a[128:129], v28 offset:8192
    ds_read_b64_tr_b16 a[130:131], v28 offset:10240
    v_mfma_f32_16x16x32_bf16 a[180:183], a[136:139], v[204:207], a[180:183]
    buffer_load_dwordx4 a[4:7], v3, s[16:19], s59 offen offset:0 sc1
    v_mfma_f32_16x16x32_bf16 a[188:191], a[140:143], v[204:207], a[188:191]
    ds_read_b64_tr_b16 a[132:133], v29 offset:8192
    ds_read_b64_tr_b16 a[134:135], v29 offset:10240
    v_mfma_f32_16x16x32_bf16 a[184:187], a[140:143], v[200:203], a[184:187]
    v_lshlrev_b32 v12, 16, v58
    s_waitcnt lgkmcnt(8)
    v_mfma_f32_16x16x32_bf16 a[160:163], a[144:147], v[208:211], a[160:163]
    ds_read_b64_tr_b16 a[136:137], v30 offset:8192
    ds_read_b64_tr_b16 a[138:139], v30 offset:10240
    v_mfma_f32_16x16x32_bf16 a[164:167], a[144:147], v[212:215], a[164:167]
    buffer_load_dwordx4 a[8:11], v2, s[16:19], s59 offen offset:1024 sc1
    v_mfma_f32_16x16x32_bf16 a[172:175], a[148:151], v[212:215], a[172:175]
    ds_read_b64_tr_b16 a[140:141], v31 offset:8192
    ds_read_b64_tr_b16 a[142:143], v31 offset:10240
    v_mfma_f32_16x16x32_bf16 a[168:171], a[148:151], v[208:211], a[168:171]
    v_and_b32 v13, 0xffff0000, v58
    s_waitcnt lgkmcnt(8)
    v_mfma_f32_16x16x32_bf16 a[176:179], a[152:155], v[208:211], a[176:179]
    ds_read_b64_tr_b16 a[144:145], v28 offset:12288
    ds_read_b64_tr_b16 a[146:147], v28 offset:14336
    v_mfma_f32_16x16x32_bf16 a[180:183], a[152:155], v[212:215], a[180:183]
    buffer_load_dwordx4 a[12:15], v3, s[16:19], s59 offen offset:1024 sc1
    v_mfma_f32_16x16x32_bf16 a[188:191], a[156:159], v[212:215], a[188:191]
    ds_read_b64_tr_b16 a[148:149], v29 offset:12288
    ds_read_b64_tr_b16 a[150:151], v29 offset:14336
    v_mfma_f32_16x16x32_bf16 a[184:187], a[156:159], v[208:211], a[184:187]
    v_lshlrev_b32 v14, 16, v59
    s_waitcnt vmcnt(32)
    s_waitcnt lgkmcnt(8)
    v_mfma_f32_16x16x32_bf16 a[160:163], a[128:131], v[216:219], a[160:163]
    s_add_u32 m0, s38, 57344
    ds_read_b64_tr_b16 a[152:153], v30 offset:12288
    ds_read_b64_tr_b16 a[154:155], v30 offset:14336
    v_mfma_f32_16x16x32_bf16 a[164:167], a[128:131], v[220:223], a[164:167]
    buffer_load_dwordx4 v7, s[84:87], s60 offen lds
    s_add_u32 s60, s60, 65536
    v_mfma_f32_16x16x32_bf16 a[172:175], a[132:135], v[220:223], a[172:175]
    s_add_u32 m0, s38, 61440
    ds_read_b64_tr_b16 a[156:157], v31 offset:12288
    ds_read_b64_tr_b16 a[158:159], v31 offset:14336
    v_mfma_f32_16x16x32_bf16 a[168:171], a[132:135], v[216:219], a[168:171]
    v_and_b32 v15, 0xffff0000, v59
    s_waitcnt vmcnt(24)
    s_barrier
    s_waitcnt lgkmcnt(8)
    v_mfma_f32_16x16x32_bf16 a[176:179], a[136:139], v[216:219], a[176:179]
    ds_read_b64_tr_b16 a[128:129], v28 offset:16384
    ds_read_b64_tr_b16 a[130:131], v28 offset:18432
    v_mfma_f32_16x16x32_bf16 a[180:183], a[136:139], v[220:223], a[180:183]
    buffer_load_dwordx4 v7, s[84:87], s60 offen lds
    s_add_u32 s60, s60, 65536
    v_mfma_f32_16x16x32_bf16 a[188:191], a[140:143], v[220:223], a[188:191]
    ds_read_b64_tr_b16 a[132:133], v29 offset:16384
    ds_read_b64_tr_b16 a[134:135], v29 offset:18432
    v_mfma_f32_16x16x32_bf16 a[184:187], a[140:143], v[216:219], a[184:187]
    v_lshlrev_b32 v16, 16, v60
    s_waitcnt lgkmcnt(8)
    v_mfma_f32_16x16x32_bf16 a[160:163], a[144:147], v[224:227], a[160:163]
    ds_read_b64_tr_b16 a[136:137], v30 offset:16384
    ds_read_b64_tr_b16 a[138:139], v30 offset:18432
    v_mfma_f32_16x16x32_bf16 a[164:167], a[144:147], v[228:231], a[164:167]
    buffer_load_dwordx4 a[16:19], v2, s[16:19], s59 offen offset:2048 sc1
    v_mfma_f32_16x16x32_bf16 a[172:175], a[148:151], v[228:231], a[172:175]
    ds_read_b64_tr_b16 a[140:141], v31 offset:16384
    ds_read_b64_tr_b16 a[142:143], v31 offset:18432
    v_mfma_f32_16x16x32_bf16 a[168:171], a[148:151], v[224:227], a[168:171]
    v_and_b32 v17, 0xffff0000, v60
    s_waitcnt lgkmcnt(8)
    v_mfma_f32_16x16x32_bf16 a[176:179], a[152:155], v[224:227], a[176:179]
    ds_read_b64_tr_b16 a[144:145], v28 offset:20480
    ds_read_b64_tr_b16 a[146:147], v28 offset:22528
    v_mfma_f32_16x16x32_bf16 a[180:183], a[152:155], v[228:231], a[180:183]
    buffer_load_dwordx4 a[20:23], v3, s[16:19], s59 offen offset:2048 sc1
    v_mfma_f32_16x16x32_bf16 a[188:191], a[156:159], v[228:231], a[188:191]
    ds_read_b64_tr_b16 a[148:149], v29 offset:20480
    ds_read_b64_tr_b16 a[150:151], v29 offset:22528
    v_mfma_f32_16x16x32_bf16 a[184:187], a[156:159], v[224:227], a[184:187]
    v_lshlrev_b32 v18, 16, v61
    s_waitcnt vmcnt(8)
    v_cmp_ne_u32 vcc, s52, v8
    v_cmp_ne_u32 s[64:65], s53, v9
    s_nop 1
    s_or_b64 s[64:65], vcc, s[64:65]
    s_and_b32 s64, s64, 0x1
    s_cbranch_scc1 L_px_slow
L_px_ok:
    s_waitcnt lgkmcnt(8)
    v_mfma_f32_16x16x32_bf16 a[160:163], a[128:131], a[64:67], a[160:163]
    ds_read_b64_tr_b16 a[152:153], v30 offset:20480
    ds_read_b64_tr_b16 a[154:155], v30 offset:22528
    v_mfma_f32_16x16x32_bf16 a[164:167], a[128:131], a[68:71], a[164:167]
    buffer_load_dwordx4 v[72:75], v252, s[16:19], s57 offen offset:0 sc1
    v_mfma_f32_16x16x32_bf16 a[172:175], a[132:135], a[68:71], a[172:175]
    ds_read_b64_tr_b16 a[156:157], v31 offset:20480
    ds_read_b64_tr_b16 a[158:159], v31 offset:22528
    v_mfma_f32_16x16x32_bf16 a[168:171], a[132:135], a[64:67], a[168:171]
    buffer_load_dwordx4 v[76:79], v252, s[16:19], s57 offen offset:1024 sc1
    s_waitcnt lgkmcnt(8)
    v_mfma_f32_16x16x32_bf16 a[176:179], a[136:139], a[64:67], a[176:179]
    ds_read_b64_tr_b16 a[128:129], v28 offset:24576
    ds_read_b64_tr_b16 a[130:131], v28 offset:26624
    v_mfma_f32_16x16x32_bf16 a[180:183], a[136:139], a[68:71], a[180:183]
    buffer_load_dwordx4 v[80:83], v252, s[16:19], s57 offen offset:2048 sc1
    v_mfma_f32_16x16x32_bf16 a[188:191], a[140:143], a[68:71], a[188:191]
    ds_read_b64_tr_b16 a[132:133], v29 offset:24576
    ds_read_b64_tr_b16 a[134:135], v29 offset:26624
    v_mfma_f32_16x16x32_bf16 a[184:187], a[140:143], a[64:67], a[184:187]
    buffer_load_dwordx4 v[84:87], v252, s[16:19], s57 offen offset:3072 sc1
    s_mov_b32 s57, s48
    s_waitcnt lgkmcnt(8)
    v_mfma_f32_16x16x32_bf16 a[160:163], a[144:147], a[72:75], a[160:163]
    ds_read_b64_tr_b16 a[136:137], v30 offset:24576
    ds_read_b64_tr_b16 a[138:139], v30 offset:26624
    v_mfma_f32_16x16x32_bf16 a[164:167], a[144:147], a[76:79], a[164:167]
    buffer_load_dwordx4 a[24:27], v2, s[16:19], s59 offen offset:3072 sc1
    v_mfma_f32_16x16x32_bf16 a[172:175], a[148:151], a[76:79], a[172:175]
    ds_read_b64_tr_b16 a[140:141], v31 offset:24576
    ds_read_b64_tr_b16 a[142:143], v31 offset:26624
    v_mfma_f32_16x16x32_bf16 a[168:171], a[148:151], a[72:75], a[168:171]
    v_and_b32 v19, 0xffff0000, v61
    s_waitcnt lgkmcnt(8)
    v_mfma_f32_16x16x32_bf16 a[176:179], a[152:155], a[72:75], a[176:179]
    ds_read_b64_tr_b16 a[144:145], v28 offset:28672
    ds_read_b64_tr_b16 a[146:147], v28 offset:30720
    v_mfma_f32_16x16x32_bf16 a[180:183], a[152:155], a[76:79], a[180:183]
    buffer_load_dwordx4 a[28:31], v3, s[16:19], s59 offen offset:3072 sc1
    s_add_u32 s59, s59, 4096
    v_mfma_f32_16x16x32_bf16 a[188:191], a[156:159], a[76:79], a[188:191]
    ds_read_b64_tr_b16 a[148:149], v29 offset:28672
    ds_read_b64_tr_b16 a[150:151], v29 offset:30720
    v_mfma_f32_16x16x32_bf16 a[184:187], a[156:159], a[72:75], a[184:187]
    v_lshlrev_b32 v144, 16, v42
    s_waitcnt lgkmcnt(8)
    v_mfma_f32_16x16x32_bf16 a[160:163], a[128:131], a[80:83], a[160:163]
    ds_read_b64_tr_b16 a[152:153], v30 offset:28672
    ds_read_b64_tr_b16 a[154:155], v30 offset:30720
    v_mfma_f32_16x16x32_bf16 a[164:167], a[128:131], a[84:87], a[164:167]
    buffer_load_dwordx4 v[88:91], v252, s[16:19], s57 offen offset:0 sc1
    v_mfma_f32_16x16x32_bf16 a[172:175], a[132:135], a[84:87], a[172:175]
    ds_read_b64_tr_b16 a[156:157], v31 offset:28672
    ds_read_b64_tr_b16 a[158:159], v31 offset:30720
    v_mfma_f32_16x16x32_bf16 a[168:171], a[132:135], a[80:83], a[168:171]
    v_and_b32 v145, 0xffff0000, v42
    s_barrier
    s_waitcnt lgkmcnt(8)
    v_mfma_f32_16x16x32_bf16 a[176:179], a[136:139], a[80:83], a[176:179]
    ds_read_b64_tr_b16 a[128:129], v28 offset:32768
    ds_read_b64_tr_b16 a[130:131], v28 offset:34816
    v_mfma_f32_16x16x32_bf16 a[180:183], a[136:139], a[84:87], a[180:183]
    buffer_load_dwordx4 v[92:95], v252, s[16:19], s57 offen offset:1024 sc1
    v_mfma_f32_16x16x32_bf16 a[188:191], a[140:143], a[84:87], a[188:191]
    ds_read_b64_tr_b16 a[132:133], v29 offset:32768
    ds_read_b64_tr_b16 a[134:135], v29 offset:34816
    v_mfma_f32_16x16x32_bf16 a[184:187], a[140:143], a[80:83], a[184:187]
    v_lshlrev_b32 v146, 16, v43
    s_waitcnt lgkmcnt(8)
    v_mfma_f32_16x16x32_bf16 a[160:163], a[144:147], a[88:91], a[160:163]
    ds_read_b64_tr_b16 a[136:137], v30 offset:32768
    ds_read_b64_tr_b16 a[138:139], v30 offset:34816
    v_mfma_f32_16x16x32_bf16 a[164:167], a[144:147], a[92:95], a[164:167]
    buffer_load_dwordx4 v[96:99], v252, s[16:19], s57 offen offset:2048 sc1
    v_mfma_f32_16x16x32_bf16 a[172:175], a[148:151], a[92:95], a[172:175]
    ds_read_b64_tr_b16 a[140:141], v31 offset:32768
    ds_read_b64_tr_b16 a[142:143], v31 offset:34816
    v_mfma_f32_16x16x32_bf16 a[168:171], a[148:151], a[88:91], a[168:171]
    v_and_b32 v147, 0xffff0000, v43
    s_waitcnt lgkmcnt(8)
    v_mfma_f32_16x16x32_bf16 a[176:179], a[152:155], a[88:91], a[176:179]
    ds_read_b64_tr_b16 a[144:145], v28 offset:36864
    ds_read_b64_tr_b16 a[146:147], v28 offset:38912
    v_mfma_f32_16x16x32_bf16 a[180:183], a[152:155], a[92:95], a[180:183]
    buffer_load_dwordx4 v[100:103], v252, s[16:19], s57 offen offset:3072 sc1
    v_mfma_f32_16x16x32_bf16 a[188:191], a[156:159], a[92:95], a[188:191]
    ds_read_b64_tr_b16 a[148:149], v29 offset:36864
    ds_read_b64_tr_b16 a[150:151], v29 offset:38912
    v_mfma_f32_16x16x32_bf16 a[184:187], a[156:159], a[88:91], a[184:187]
    v_lshlrev_b32 v148, 16, v44
    s_waitcnt lgkmcnt(8)
    v_mfma_f32_16x16x32_bf16 a[160:163], a[128:131], a[96:99], a[160:163]
    ds_read_b64_tr_b16 a[152:153], v30 offset:36864
    ds_read_b64_tr_b16 a[154:155], v30 offset:38912
    v_mfma_f32_16x16x32_bf16 a[164:167], a[128:131], a[100:103], a[164:167]
    v_and_b32 v149, 0xffff0000, v44
    v_lshlrev_b32 v150, 16, v45
    v_mfma_f32_16x16x32_bf16 a[172:175], a[132:135], a[100:103], a[172:175]
    ds_read_b64_tr_b16 a[156:157], v31 offset:36864
    ds_read_b64_tr_b16 a[158:159], v31 offset:38912
    v_mfma_f32_16x16x32_bf16 a[168:171], a[132:135], a[96:99], a[168:171]
    v_and_b32 v151, 0xffff0000, v45
    s_waitcnt lgkmcnt(8)
    v_mfma_f32_16x16x32_bf16 a[176:179], a[136:139], a[96:99], a[176:179]
    ds_read_b64_tr_b16 a[128:129], v28 offset:40960
    ds_read_b64_tr_b16 a[130:131], v28 offset:43008
    v_mfma_f32_16x16x32_bf16 a[180:183], a[136:139], a[100:103], a[180:183]
    v_add_f32 v144, v144, v12
    v_add_f32 v145, v145, v13
    v_mfma_f32_16x16x32_bf16 a[188:191], a[140:143], a[100:103], a[188:191]
    ds_read_b64_tr_b16 a[132:133], v29 offset:40960
    ds_read_b64_tr_b16 a[134:135], v29 offset:43008
    v_mfma_f32_16x16x32_bf16 a[184:187], a[140:143], a[96:99], a[184:187]
    v_add_f32 v146, v146, v14
    s_waitcnt lgkmcnt(8)
    v_mfma_f32_16x16x32_bf16 a[160:163], a[144:147], a[104:107], a[160:163]
    ds_read_b64_tr_b16 a[136:137], v30 offset:40960
    ds_read_b64_tr_b16 a[138:139], v30 offset:43008
    v_mfma_f32_16x16x32_bf16 a[164:167], a[144:147], a[108:111], a[164:167]
    v_add_f32 v147, v147, v15
    v_add_f32 v148, v148, v16
    v_mfma_f32_16x16x32_bf16 a[172:175], a[148:151], a[108:111], a[172:175]
    ds_read_b64_tr_b16 a[140:141], v31 offset:40960
    ds_read_b64_tr_b16 a[142:143], v31 offset:43008
    v_mfma_f32_16x16x32_bf16 a[168:171], a[148:151], a[104:107], a[168:171]
    v_add_f32 v149, v149, v17
    s_waitcnt lgkmcnt(8)
    v_mfma_f32_16x16x32_bf16 a[176:179], a[152:155], a[104:107], a[176:179]
    ds_read_b64_tr_b16 a[144:145], v28 offset:45056
    ds_read_b64_tr_b16 a[146:147], v28 offset:47104
    v_mfma_f32_16x16x32_bf16 a[180:183], a[152:155], a[108:111], a[180:183]
    v_add_f32 v150, v150, v18
    v_add_f32 v151, v151, v19
    v_mfma_f32_16x16x32_bf16 a[188:191], a[156:159], a[108:111], a[188:191]
    ds_read_b64_tr_b16 a[148:149], v29 offset:45056
    ds_read_b64_tr_b16 a[150:151], v29 offset:47104
    v_mfma_f32_16x16x32_bf16 a[184:187], a[156:159], a[104:107], a[184:187]
    v_lshlrev_b32 v152, 16, v46
    s_waitcnt lgkmcnt(8)
    v_mfma_f32_16x16x32_bf16 a[160:163], a[128:131], a[112:115], a[160:163]
    ds_read_b64_tr_b16 a[152:153], v30 offset:45056
    ds_read_b64_tr_b16 a[154:155], v30 offset:47104
    v_mfma_f32_16x16x32_bf16 a[164:167], a[128:131], a[116:119], a[164:167]
    v_and_b32 v153, 0xffff0000, v46
    v_lshlrev_b32 v154, 16, v47
    v_mfma_f32_16x16x32_bf16 a[172:175], a[132:135], a[116:119], a[172:175]
    ds_read_b64_tr_b16 a[156:157], v31 offset:45056
    ds_read_b64_tr_b16 a[158:159], v31 offset:47104
    v_mfma_f32_16x16x32_bf16 a[168:171], a[132:135], a[112:115], a[168:171]
    v_and_b32 v155, 0xffff0000, v47
    s_waitcnt vmcnt(12)
    s_barrier
    s_waitcnt lgkmcnt(8)
    v_mfma_f32_16x16x32_bf16 a[176:179], a[136:139], a[112:115], a[176:179]
    ds_read_b64_tr_b16 a[128:129], v28 offset:49152
    ds_read_b64_tr_b16 a[130:131], v28 offset:51200
    v_mfma_f32_16x16x32_bf16 a[180:183], a[136:139], a[116:119], a[180:183]
    v_lshlrev_b32 v156, 16, v48
    v_and_b32 v157, 0xffff0000, v48
    v_mfma_f32_16x16x32_bf16 a[188:191], a[140:143], a[116:119], a[188:191]
    ds_read_b64_tr_b16 a[132:133], v29 offset:49152
    ds_read_b64_tr_b16 a[134:135], v29 offset:51200
    v_mfma_f32_16x16x32_bf16 a[184:187], a[140:143], a[112:115], a[184:187]
    v_lshlrev_b32 v158, 16, v49
    s_waitcnt lgkmcnt(8)
    v_mfma_f32_16x16x32_bf16 a[160:163], a[144:147], a[120:123], a[160:163]
    ds_read_b64_tr_b16 a[136:137], v30 offset:49152
    ds_read_b64_tr_b16 a[138:139], v30 offset:51200
    v_mfma_f32_16x16x32_bf16 a[164:167], a[144:147], a[124:127], a[164:167]
    v_and_b32 v159, 0xffff0000, v49
    v_add_f32 v152, v152, v12
    v_mfma_f32_16x16x32_bf16 a[172:175], a[148:151], a[124:127], a[172:175]
    ds_read_b64_tr_b16 a[140:141], v31 offset:49152
    ds_read_b64_tr_b16 a[142:143], v31 offset:51200
    v_mfma_f32_16x16x32_bf16 a[168:171], a[148:151], a[120:123], a[168:171]
    v_add_f32 v153, v153, v13
    s_waitcnt lgkmcnt(8)
    v_mfma_f32_16x16x32_bf16 a[176:179], a[152:155], a[120:123], a[176:179]
    ds_read_b64_tr_b16 a[144:145], v28 offset:53248
    ds_read_b64_tr_b16 a[146:147], v28 offset:55296
    v_mfma_f32_16x16x32_bf16 a[180:183], a[152:155], a[124:127], a[180:183]
    v_add_f32 v154, v154, v14
    v_add_f32 v155, v155, v15
    v_mfma_f32_16x16x32_bf16 a[188:191], a[156:159], a[124:127], a[188:191]
    ds_read_b64_tr_b16 a[148:149], v29 offset:53248
    ds_read_b64_tr_b16 a[150:151], v29 offset:55296
    v_mfma_f32_16x16x32_bf16 a[184:187], a[156:159], a[120:123], a[184:187]
    v_add_f32 v156, v156, v16
    s_waitcnt lgkmcnt(8)
    v_mfma_f32_16x16x32_bf16 a[160:163], a[128:131], a[0:3], a[160:163]
    ds_read_b64_tr_b16 a[152:153], v30 offset:53248
    ds_read_b64_tr_b16 a[154:155], v30 offset:55296
    v_mfma_f32_16x16x32_bf16 a[164:167], a[128:131], a[4:7], a[164:167]
    v_add_f32 v157, v157, v17
    v_add_f32 v158, v158, v18
    v_mfma_f32_16x16x32_bf16 a[172:175], a[132:135], a[4:7], a[172:175]
    ds_read_b64_tr_b16 a[156:157], v31 offset:53248
    ds_read_b64_tr_b16 a[158:159], v31 offset:55296
    v_mfma_f32_16x16x32_bf16 a[168:171], a[132:135], a[0:3], a[168:171]
    v_add_f32 v159, v159, v19
    s_waitcnt lgkmcnt(8)
    v_mfma_f32_16x16x32_bf16 a[176:179], a[136:139], a[0:3], a[176:179]
    ds_read_b64_tr_b16 a[128:129], v28 offset:57344
    ds_read_b64_tr_b16 a[130:131], v28 offset:59392
    v_mfma_f32_16x16x32_bf16 a[180:183], a[136:139], a[4:7], a[180:183]
    v_lshlrev_b32 v160, 16, v50
    v_and_b32 v161, 0xffff0000, v50
    v_mfma_f32_16x16x32_bf16 a[188:191], a[140:143], a[4:7], a[188:191]
    ds_read_b64_tr_b16 a[132:133], v29 offset:57344
    ds_read_b64_tr_b16 a[134:135], v29 offset:59392
    v_mfma_f32_16x16x32_bf16 a[184:187], a[140:143], a[0:3], a[184:187]
    v_lshlrev_b32 v162, 16, v51
    s_waitcnt lgkmcnt(8)
    v_mfma_f32_16x16x32_bf16 a[160:163], a[144:147], a[8:11], a[160:163]
    ds_read_b64_tr_b16 a[136:137], v30 offset:57344
    ds_read_b64_tr_b16 a[138:139], v30 offset:59392
    v_mfma_f32_16x16x32_bf16 a[164:167], a[144:147], a[12:15], a[164:167]
    v_and_b32 v163, 0xffff0000, v51
    v_lshlrev_b32 v164, 16, v52
    v_mfma_f32_16x16x32_bf16 a[172:175], a[148:151], a[12:15], a[172:175]
    ds_read_b64_tr_b16 a[140:141], v31 offset:57344
    ds_read_b64_tr_b16 a[142:143], v31 offset:59392
    v_mfma_f32_16x16x32_bf16 a[168:171], a[148:151], a[8:11], a[168:171]
    v_and_b32 v165, 0xffff0000, v52
    s_waitcnt lgkmcnt(8)
    v_mfma_f32_16x16x32_bf16 a[176:179], a[152:155], a[8:11], a[176:179]
    ds_read_b64_tr_b16 a[144:145], v28 offset:61440
    ds_read_b64_tr_b16 a[146:147], v28 offset:63488
    v_mfma_f32_16x16x32_bf16 a[180:183], a[152:155], a[12:15], a[180:183]
    v_lshlrev_b32 v166, 16, v53
    v_and_b32 v167, 0xffff0000, v53
    v_mfma_f32_16x16x32_bf16 a[188:191], a[156:159], a[12:15], a[188:191]
    ds_read_b64_tr_b16 a[148:149], v29 offset:61440
    ds_read_b64_tr_b16 a[150:151], v29 offset:63488
    v_mfma_f32_16x16x32_bf16 a[184:187], a[156:159], a[8:11], a[184:187]
    v_add_f32 v160, v160, v12
    s_waitcnt vmcnt(4)
    s_waitcnt lgkmcnt(8)
    v_mfma_f32_16x16x32_bf16 a[160:163], a[128:131], a[16:19], a[160:163]
    ds_read_b64_tr_b16 a[152:153], v30 offset:61440
    ds_read_b64_tr_b16 a[154:155], v30 offset:63488
    v_mfma_f32_16x16x32_bf16 a[164:167], a[128:131], a[20:23], a[164:167]
    v_add_f32 v161, v161, v13
    v_add_f32 v162, v162, v14
    v_mfma_f32_16x16x32_bf16 a[172:175], a[132:135], a[20:23], a[172:175]
    ds_read_b64_tr_b16 a[156:157], v31 offset:61440
    ds_read_b64_tr_b16 a[158:159], v31 offset:63488
    v_mfma_f32_16x16x32_bf16 a[168:171], a[132:135], a[16:19], a[168:171]
    v_add_f32 v163, v163, v15
    s_waitcnt lgkmcnt(8)
    v_mfma_f32_16x16x32_bf16 a[176:179], a[136:139], a[16:19], a[176:179]
    v_mfma_f32_16x16x32_bf16 a[180:183], a[136:139], a[20:23], a[180:183]
    v_add_f32 v164, v164, v16
    v_add_f32 v165, v165, v17
    v_mfma_f32_16x16x32_bf16 a[188:191], a[140:143], a[20:23], a[188:191]
    v_mfma_f32_16x16x32_bf16 a[184:187], a[140:143], a[16:19], a[184:187]
    v_add_f32 v166, v166, v18
    s_waitcnt lgkmcnt(4)
    v_mfma_f32_16x16x32_bf16 a[160:163], a[144:147], a[24:27], a[160:163]
    v_mfma_f32_16x16x32_bf16 a[164:167], a[144:147], a[28:31], a[164:167]
    v_add_f32 v167, v167, v19
    v_lshlrev_b32 v168, 16, v54
    v_mfma_f32_16x16x32_bf16 a[172:175], a[148:151], a[28:31], a[172:175]
    v_mfma_f32_16x16x32_bf16 a[168:171], a[148:151], a[24:27], a[168:171]
    v_and_b32 v169, 0xffff0000, v54
    s_waitcnt lgkmcnt(0)
    v_mfma_f32_16x16x32_bf16 a[176:179], a[152:155], a[24:27], a[176:179]
    v_mfma_f32_16x16x32_bf16 a[180:183], a[152:155], a[28:31], a[180:183]
    v_lshlrev_b32 v170, 16, v55
    v_and_b32 v171, 0xffff0000, v55
    v_mfma_f32_16x16x32_bf16 a[188:191], a[156:159], a[28:31], a[188:191]
    v_mfma_f32_16x16x32_bf16 a[184:187], a[156:159], a[24:27], a[184:187]
    v_lshlrev_b32 v172, 16, v56
    v_and_b32 v173, 0xffff0000, v56
    v_lshlrev_b32 v174, 16, v57
    v_and_b32 v175, 0xffff0000, v57
    v_add_f32 v168, v168, v12
    v_add_f32 v169, v169, v13
    v_add_f32 v170, v170, v14
    v_add_f32 v171, v171, v15
    v_add_f32 v172, v172, v16
    v_add_f32 v173, v173, v17
    v_add_f32 v174, v174, v18
    v_add_f32 v175, v175, v19
    s_nop 3
    s_waitcnt vmcnt(0)
    v_accvgpr_read_b32 v104, a160
    v_accvgpr_read_b32 v105, a161
    v_accvgpr_read_b32 v106, a162
    v_accvgpr_read_b32 v107, a163
    v_pk_add_f32 v[72:73], v[72:73], v[104:105]
    v_pk_add_f32 v[74:75], v[74:75], v[106:107]
    ds_write_b128 v36, v[72:75] offset:0
    v_accvgpr_read_b32 v108, a164
    v_accvgpr_read_b32 v109, a165
    v_accvgpr_read_b32 v110, a166
    v_accvgpr_read_b32 v111, a167
    v_pk_add_f32 v[76:77], v[76:77], v[108:109]
    v_pk_add_f32 v[78:79], v[78:79], v[110:111]
    ds_write_b128 v36, v[76:79] offset:4352
    v_accvgpr_read_b32 v104, a168
    v_accvgpr_read_b32 v105, a169
    v_accvgpr_read_b32 v106, a170
    v_accvgpr_read_b32 v107, a171
    v_pk_add_f32 v[80:81], v[80:81], v[104:105]
    v_pk_add_f32 v[82:83], v[82:83], v[106:107]
    ds_write_b128 v36, v[80:83] offset:64
    v_accvgpr_read_b32 v108, a172
    v_accvgpr_read_b32 v109, a173
    v_accvgpr_read_b32 v110, a174
    v_accvgpr_read_b32 v111, a175
    v_pk_add_f32 v[84:85], v[84:85], v[108:109]
    v_pk_add_f32 v[86:87], v[86:87], v[110:111]
    ds_write_b128 v36, v[84:87] offset:4416
    v_accvgpr_read_b32 v104, a176
    v_accvgpr_read_b32 v105, a177
    v_accvgpr_read_b32 v106, a178
    v_accvgpr_read_b32 v107, a179
    v_pk_add_f32 v[88:89], v[88:89], v[104:105]
    v_pk_add_f32 v[90:91], v[90:91], v[106:107]
    ds_write_b128 v36, v[88:91] offset:128
    v_accvgpr_read_b32 v108, a180
    v_accvgpr_read_b32 v109, a181
    v_accvgpr_read_b32 v110, a182
    v_accvgpr_read_b32 v111, a183
    v_pk_add_f32 v[92:93], v[92:93], v[108:109]
    v_pk_add_f32 v[94:95], v[94:95], v[110:111]
    ds_write_b128 v36, v[92:95] offset:4480
    v_accvgpr_read_b32 v104, a184
    v_accvgpr_read_b32 v105, a185
    v_accvgpr_read_b32 v106, a186
    v_accvgpr_read_b32 v107, a187
    v_pk_add_f32 v[96:97], v[96:97], v[104:105]
    v_pk_add_f32 v[98:99], v[98:99], v[106:107]
    ds_write_b128 v36, v[96:99] offset:192
    v_accvgpr_read_b32 v108, a188
    v_accvgpr_read_b32 v109, a189
    v_accvgpr_read_b32 v110, a190
    v_accvgpr_read_b32 v111, a191
    v_pk_add_f32 v[100:101], v[100:101], v[108:109]
    v_pk_add_f32 v[102:103], v[102:103], v[110:111]
    ds_write_b128 v36, v[100:103] offset:4544
    s_waitcnt lgkmcnt(0)
    ds_read_b128 v[112:115], v37 offset:0
    ds_read_b128 v[116:119], v37 offset:16
    ds_read_b128 v[120:123], v37 offset:2176
    ds_read_b128 v[124:127], v37 offset:2192
    ds_read_b128 v[128:131], v37 offset:4352
    ds_read_b128 v[132:135], v37 offset:4368
    ds_read_b128 v[136:139], v37 offset:6528
    ds_read_b128 v[140:143], v37 offset:6544
    s_waitcnt lgkmcnt(6)
    v_pk_add_f32 v[144:145], v[144:145], v[112:113]
    v_pk_add_f32 v[146:147], v[146:147], v[114:115]
    v_pk_add_f32 v[148:149], v[148:149], v[116:117]
    v_pk_add_f32 v[150:151], v[150:151], v[118:119]
    v_cvt_pk_bf16_f32 v42, v144, v145
    v_cvt_pk_bf16_f32 v43, v146, v147
    v_cvt_pk_bf16_f32 v44, v148, v149
    v_cvt_pk_bf16_f32 v45, v150, v151
    buffer_store_dwordx4 v[42:45], v26, s[24:27], 0 offen
    s_waitcnt lgkmcnt(4)
    v_pk_add_f32 v[152:153], v[152:153], v[120:121]
    v_pk_add_f32 v[154:155], v[154:155], v[122:123]
    v_pk_add_f32 v[156:157], v[156:157], v[124:125]
    v_pk_add_f32 v[158:159], v[158:159], v[126:127]
    v_cvt_pk_bf16_f32 v46, v152, v153
    v_cvt_pk_bf16_f32 v47, v154, v155
    v_cvt_pk_bf16_f32 v48, v156, v157
    v_cvt_pk_bf16_f32 v49, v158, v159
    buffer_store_dwordx4 v[46:49], v26, s[24:27], s3 offen
    s_waitcnt lgkmcnt(2)
    v_pk_add_f32 v[160:161], v[160:161], v[128:129]
    v_pk_add_f32 v[162:163], v[162:163], v[130:131]
    v_pk_add_f32 v[164:165], v[164:165], v[132:133]
    v_pk_add_f32 v[166:167], v[166:167], v[134:135]
    v_cvt_pk_bf16_f32 v50, v160, v161
    v_cvt_pk_bf16_f32 v51, v162, v163
    v_cvt_pk_bf16_f32 v52, v164, v165
    v_cvt_pk_bf16_f32 v53, v166, v167
    buffer_store_dwordx4 v[50:53], v26, s[24:27], s40 offen
    s_waitcnt lgkmcnt(0)
    v_pk_add_f32 v[168:169], v[168:169], v[136:137]
    v_pk_add_f32 v[170:171], v[170:171], v[138:139]
    v_pk_add_f32 v[172:173], v[172:173], v[140:141]
    v_pk_add_f32 v[174:175], v[174:175], v[142:143]
    v_cvt_pk_bf16_f32 v54, v168, v169
    v_cvt_pk_bf16_f32 v55, v170, v171
    v_cvt_pk_bf16_f32 v56, v172, v173
    v_cvt_pk_bf16_f32 v57, v174, v175
    buffer_store_dwordx4 v[54:57], v26, s[24:27], s41 offen
    s_lshl_b32 s62, s34, 29
    s_add_u32 s62, s62, 50331648
    s_cmp_eq_u32 s2, 0
    s_cselect_b32 s62, s62, 0x80000000
    s_mov_b64 exec, 1
    buffer_store_dwordx2 v[250:251], off, s[16:19], s62 sc1
    s_mov_b64 exec, -1
    s_endpgm
L_qkv_slow:
    s_mov_b32 s62, 20000
L_qkv_spin:
    s_sub_u32 s62, s62, 1
    s_cmp_eq_u32 s62, 0
    s_cbranch_scc1 L_qkv_ok
    s_sleep 1
    buffer_load_dwordx2 v[8:9], v7, s[16:19], s66 offen sc1
    s_waitcnt vmcnt(0)
    v_cmp_ne_u32 vcc, s52, v8
    v_cmp_ne_u32 s[64:65], s53, v9
    s_nop 1
    s_or_b64 s[64:65], vcc, s[64:65]
    s_and_b32 s64, s64, 0xffffff
    s_cbranch_scc1 L_qkv_spin
    s_branch L_qkv_ok
L_h_slow:
    s_mov_b32 s62, 20000
L_h_spin:
    s_sub_u32 s62, s62, 1
    s_cmp_eq_u32 s62, 0
    s_cbranch_scc1 L_h_ok
    s_sleep 1
    buffer_load_dwordx2 v[8:9], v6, s[16:19], s74 offen sc1
    s_waitcnt vmcnt(0)
    v_cmp_ne_u32 vcc, s52, v8
    v_cmp_ne_u32 s[64:65], s53, v9
    s_nop 1
    s_or_b64 s[64:65], vcc, s[64:65]
    s_and_b32 s64, s64, 0xffffffff
    s_cbranch_scc1 L_h_spin
    s_branch L_h_ok
L_at_redo:
    s_waitcnt vmcnt(0)
    s_barrier
    s_mov_b32 s44, 1
    s_mov_b32 s68, 0x80000000
    s_mov_b32 s69, 0x80000000
    s_mov_b32 s46, s70
    s_mov_b32 s47, 64
    v_mov_b32 v36, 0xff800000
    v_mov_b32 v37, 0xff800000
L_at_max:
    buffer_load_dwordx4 v[12:15], v252, s[16:19], s46 offen offset:0 sc1
    buffer_load_dwordx4 v[16:19], v252, s[16:19], s46 offen offset:1024 sc1
    s_waitcnt vmcnt(0)
    v_mfma_f32_32x32x16_bf16 v[112:127], v[12:15], v[64:67], 0
    v_mfma_f32_32x32x16_bf16 v[112:127], v[16:19], v[68:71], v[112:127]
    v_mfma_f32_32x32x16_bf16 v[128:143], v[12:15], v[72:75], 0
    v_mfma_f32_32x32x16_bf16 v[128:143], v[16:19], v[76:79], v[128:143]
    s_nop 15
    v_max3_f32 v36, v36, v112, v113
    v_max3_f32 v36, v36, v114, v115
    v_max3_f32 v36, v36, v116, v117
    v_max3_f32 v36, v36, v118, v119
    v_max3_f32 v36, v36, v120, v121
    v_max3_f32 v36, v36, v122, v123
    v_max3_f32 v36, v36, v124, v125
    v_max3_f32 v36, v36, v126, v127
    v_max3_f32 v37, v37, v128, v129
    v_max3_f32 v37, v37, v130, v131
    v_max3_f32 v37, v37, v132, v133
    v_max3_f32 v37, v37, v134, v135
    v_max3_f32 v37, v37, v136, v137
    v_max3_f32 v37, v37, v138, v139
    v_max3_f32 v37, v37, v140, v141
    v_max3_f32 v37, v37, v142, v143
    s_add_u32 s46, s46, 2048
    s_sub_u32 s47, s47, 1
    s_cmp_lg_u32 s47, 0
    s_cbranch_scc1 L_at_max
    buffer_load_dwordx4 v[12:15], v252, s[16:19], s70 offen offset:0 sc1
    buffer_load_dwordx4 v[16:19], v252, s[16:19], s70 offen offset:1024 sc1
    s_mov_b32 s42, s70
    s_mov_b32 s43, s71
    s_add_u32 m0, s38, 131072
    s_nop 0
    buffer_load_dwordx4 v253, s[16:19], s42 offen sc1 lds
    s_add_u32 m0, s38, 135168
    s_nop 0
    buffer_load_dwordx4 v33, s[16:19], s42 offen sc1 lds
    s_add_u32 m0, s38, 139264
    s_nop 0
    buffer_load_dwordx4 v253, s[16:19], s43 offen sc1 lds
    s_add_u32 m0, s38, 143360
    s_nop 0
    buffer_load_dwordx4 v33, s[16:19], s43 offen sc1 lds
    s_add_u32 s42, s42, 8192
    s_add_u32 s43, s43, 8192
    s_add_u32 m0, s38, 114688
    s_nop 0
    buffer_load_dwordx4 v253, s[16:19], s42 offen sc1 lds
    s_add_u32 m0, s38, 118784
    s_nop 0
    buffer_load_dwordx4 v33, s[16:19], s42 offen sc1 lds
    s_add_u32 m0, s38, 122880
    s_nop 0
    buffer_load_dwordx4 v253, s[16:19], s43 offen sc1 lds
    s_add_u32 m0, s38, 126976
    s_nop 0
    buffer_load_dwordx4 v33, s[16:19], s43 offen sc1 lds
    s_add_u32 s42, s42, 8192
    s_add_u32 s43, s43, 8192
    s_waitcnt vmcnt(0)
    v_mov_b32 v38, v36
    v_mov_b32 v39, v37
    s_nop 1
    v_permlane32_swap_b32 v36, v38
    v_permlane32_swap_b32 v37, v39
    s_nop 1
    v_max_f32 v36, v36, v38
    v_sub_f32 v80, 0, v36
    v_sub_f32 v81, 0, v36
    v_sub_f32 v82, 0, v36
    v_sub_f32 v83, 0, v36
    v_sub_f32 v84, 0, v36
    v_sub_f32 v85, 0, v36
    v_sub_f32 v86, 0, v36
    v_sub_f32 v87, 0, v36
    v_sub_f32 v88, 0, v36
    v_sub_f32 v89, 0, v36
    v_sub_f32 v90, 0, v36
    v_sub_f32 v91, 0, v36
    v_sub_f32 v92, 0, v36
    v_sub_f32 v93, 0, v36
    v_sub_f32 v94, 0, v36
    v_sub_f32 v95, 0, v36
    v_max_f32 v37, v37, v39
    v_sub_f32 v96, 0, v37
    v_sub_f32 v97, 0, v37
    v_sub_f32 v98, 0, v37
    v_sub_f32 v99, 0, v37
    v_sub_f32 v100, 0, v37
    v_sub_f32 v101, 0, v37
    v_sub_f32 v102, 0, v37
    v_sub_f32 v103, 0, v37
    v_sub_f32 v104, 0, v37
    v_sub_f32 v105, 0, v37
    v_sub_f32 v106, 0, v37
    v_sub_f32 v107, 0, v37
    v_sub_f32 v108, 0, v37
    v_sub_f32 v109, 0, v37
    v_sub_f32 v110, 0, v37
    v_sub_f32 v111, 0, v37
    v_mfma_f32_32x32x16_bf16 v[112:127], v[12:15], v[64:67], v[80:95]
    v_mfma_f32_32x32x16_bf16 v[112:127], v[16:19], v[68:71], v[112:127]
    s_nop 15
    s_branch L_at_start
L_o_slow:
    s_mov_b32 s62, 20000
L_o_spin:
    s_sub_u32 s62, s62, 1
    s_cmp_eq_u32 s62, 0
    s_cbranch_scc1 L_o_ok
    s_sleep 1
    buffer_load_dwordx2 v[8:9], v6, s[16:19], s66 offen sc1
    s_waitcnt vmcnt(0)
    v_cmp_ne_u32 vcc, s52, v8
    v_cmp_ne_u32 s[64:65], s53, v9
    s_nop 1
    s_or_b64 s[64:65], vcc, s[64:65]
    s_and_b32 s64, s64, 0xffffffff
    s_cbranch_scc1 L_o_spin
    s_branch L_o_ok
L_px_slow:
    s_mov_b32 s62, 20000
L_px_spin:
    s_sub_u32 s62, s62, 1
    s_cmp_eq_u32 s62, 0
    s_cbranch_scc1 L_px_ok
    s_sleep 1
    buffer_load_dwordx2 v[8:9], v38, s[16:19], s56 offen sc1
    s_waitcnt vmcnt(0)
    v_cmp_ne_u32 vcc, s52, v8
    v_cmp_ne_u32 s[64:65], s53, v9
    s_nop 1
    s_or_b64 s[64:65], vcc, s[64:65]
    s_and_b32 s64, s64, 0x1
    s_cbranch_scc1 L_px_spin
    s_branch L_px_ok
L_end:
    s_endpgm
.section .rodata,"a"
.p2align 6
.amdhsa_kernel parallel_sum__softmax_full_mha__dense_activation_gelu__prompt_kernel
  .amdhsa_next_free_vgpr 484
  .amdhsa_next_free_sgpr 96
  .amdhsa_accum_offset 256
  .amdhsa_group_segment_fixed_size 0
  .amdhsa_kernarg_size 88
  .amdhsa_user_sgpr_count 2
  .amdhsa_user_sgpr_kernarg_segment_ptr 1
  .amdhsa_system_sgpr_workgroup_id_x 1
  .amdhsa_float_denorm_mode_32 3
  .amdhsa_float_denorm_mode_16_64 3
.end_amdhsa_kernel
```
